```python
import torch

def _softmax(x, axis=-1):
    return torch.softmax(x, dim=axis)
def _gelu(x):
    return torch.nn.functional.gelu(x, approximate="tanh")
def _silu(x):
    return torch.nn.functional.silu(x)
def _sigmoid(x):
    return torch.sigmoid(x)
def _layernorm(x, axis=-1, eps=1e-5):
    m = x.mean(dim=axis, keepdim=True)
    v = x.var(dim=axis, keepdim=True, unbiased=False)
    return (x - m) / torch.sqrt(v + eps)
def _scatter_add(tgt, idx, src, axis=0):
    return tgt.clone().index_add_(axis, idx, src)
def _segment_sum(src, seg, n):
    out = torch.zeros((n,) + src.shape[1:], dtype=src.dtype)
    return out.index_add_(0, seg, src)
def _pad(x, pw):
    flat = tuple(v for pair in reversed(pw) for v in pair)
    return torch.nn.functional.pad(x, flat)

kernel_name = 'parallel_sum__spectral_fnet__geglu_ffn__prompt'

def setup_inputs():

    _w = (lambda a: (lambda t: t.to(torch.bfloat16) if t.is_floating_point() else t)(torch.as_tensor(a)))
    def _A_setup():
        B, S, D = 1, 2048, 576
        ns = torch.arange(S)[:, None] * torch.arange(S)[None, :]
        nd = torch.arange(D)[:, None] * torch.arange(D)[None, :]
        Ws_re = torch.cos(-2.0 * torch.pi * ns / S).to(float)
        Ws_im = torch.sin(-2.0 * torch.pi * ns / S).to(float)
        Wd_re = torch.cos(-2.0 * torch.pi * nd / D).to(float)
        Wd_im = torch.sin(-2.0 * torch.pi * nd / D).to(float)
        return {
            "x": _w((lambda *s: torch.randn(*s, dtype=torch.bfloat16) * 0.05)(B, S, D)),
            "dft_seq_re": _w(Ws_re),
            "dft_seq_im": _w(Ws_im),
            "dft_hid_re": _w(Wd_re),
            "dft_hid_im": _w(Wd_im),
        }
    _A_in = _A_setup()

    def _B_setup():
        B, S, D, F = 1, 2048, 576, 4608
        return {
            "x": _w((lambda *s: torch.randn(*s, dtype=torch.bfloat16) * 0.05)(B, S, D)),
            "w_gate": _w((lambda *s: torch.randn(*s, dtype=torch.bfloat16) * 0.2)(D, F)),
            "w_up": _w((lambda *s: torch.randn(*s, dtype=torch.bfloat16) * 0.2)(D, F)),
            "w_down": _w((lambda *s: torch.randn(*s, dtype=torch.bfloat16) * 0.2)(F, D)),
        }
    _B_in = _B_setup()

    return {
        "A_x": _A_in["x"],
        "A_dft_seq_re": _A_in["dft_seq_re"],
        "A_dft_seq_im": _A_in["dft_seq_im"],
        "A_dft_hid_re": _A_in["dft_hid_re"],
        "A_dft_hid_im": _A_in["dft_hid_im"],
        "B_x": _B_in["x"],
        "B_w_gate": _B_in["w_gate"],
        "B_w_up": _B_in["w_up"],
        "B_w_down": _B_in["w_down"],
    }

def reference(A_x, A_dft_seq_re, A_dft_seq_im, A_dft_hid_re, A_dft_hid_im, B_x, B_w_gate, B_w_up, B_w_down):
    def _A_ref(x, dft_seq_re, dft_seq_im, dft_hid_re, dft_hid_im):
        a = torch.einsum("bsd,ed->bse", x, dft_hid_re)
        b = torch.einsum("bsd,ed->bse", x, dft_hid_im)
        y = torch.einsum("ts,bse->bte", dft_seq_re, a) - torch.einsum("ts,bse->bte", dft_seq_im, b)
        return y

    def _B_ref(x, w_gate, w_up, w_down):
        return (_gelu(x @ w_gate) * (x @ w_up)) @ w_down

    x = A_x
    xn = _layernorm(x, axis=-1)
    return x + _A_ref(xn, A_dft_seq_re, A_dft_seq_im, A_dft_hid_re, A_dft_hid_im) + _B_ref(xn, B_w_gate, B_w_up, B_w_down)
```

```asm
; @launch grid=(256,1,1) block=(256,1,1) lds=163840
.amdgcn_target "amdgcn-amd-amdhsa--gfx950"
.text
.globl parallel_sum__spectral_fnet__geglu_ffn__prompt_kernel
.p2align 8
.type parallel_sum__spectral_fnet__geglu_ffn__prompt_kernel,@function
parallel_sum__spectral_fnet__geglu_ffn__prompt_kernel:
    s_load_dwordx16 s[16:31], s[0:1], 0
    s_load_dwordx8 s[32:39], s[0:1], 64
    s_cmp_ge_u32 s2, 256
    s_cbranch_scc1 L_end
    v_lshrrev_b32 v2, 6, v0
    v_and_b32 v0, 63, v0
    s_nop 0
    v_readfirstlane_b32 s64, v2
    s_and_b32 s66, s2, 3
    s_lshl_b32 s66, s66, 2
    s_bfe_u32 s76, s2, 0x20003
    s_or_b32 s66, s66, s76
    s_bfe_u32 s65, s2, 0x10002
    s_lshl_b32 s65, s65, 3
    s_lshr_b32 s76, s2, 5
    s_or_b32 s65, s65, s76
    s_mul_i32 s67, s64, 36864
    s_mul_i32 s68, s64, 9216
    v_lshlrev_b32 v1, 4, v0
    s_getpc_b64 s[82:83]
L_pc:
    s_lshr_b32 s76, s2, 3
    s_lshl_b32 s76, s76, 2
    s_add_u32 s76, s76, s64
    s_lshl_b32 s76, s76, 9
    v_and_b32 v2, 3, v0
    v_lshlrev_b32 v2, 7, v2
    v_add_u32 v2, s76, v2
    v_mov_b32 v4, L_end-L_pc
    v_cmp_gt_u32 vcc, 4, v0
    v_cmp_gt_u32 s[80:81], v4, v2
    s_nop 1
    s_and_b64 vcc, vcc, s[80:81]
    s_and_saveexec_b64 s[80:81], vcc
    s_cbranch_execz L_nocpf
    global_load_dword v252, v2, s[82:83]
L_nocpf:
    s_mov_b64 exec, s[80:81]
    v_lshrrev_b32 v2, 3, v0
    v_and_b32 v3, 7, v0
    v_lshrrev_b32 v4, 1, v2
    v_xor_b32 v3, v3, v4
    v_lshlrev_b32 v3, 4, v3
    v_xor_b32 v4, 64, v3
    s_lshl_b32 s76, s65, 5
    s_lshl_b32 s77, s64, 3
    s_add_u32 s76, s76, s77
    v_add_u32 v5, s76, v2
    v_sub_u32 v6, 1024, v5
    v_add_u32 v7, 1024, v5
    v_sub_u32 v8, 2048, v5
    v_cmp_eq_u32 vcc, 0, v5
    v_mov_b32 v9, 512
    s_nop 0
    v_cndmask_b32 v7, v7, v9, vcc
    v_mov_b32 v9, 1536
    s_nop 0
    v_cndmask_b32 v8, v8, v9, vcc
    s_movk_i32 s77, 1152
    v_mad_u32_u24 v240, v5, s77, v3
    v_mad_u32_u24 v241, v6, s77, v4
    v_mad_u32_u24 v242, v7, s77, v3
    v_mad_u32_u24 v243, v8, s77, v4
    s_waitcnt lgkmcnt(0)
    s_mov_b32 s40, s16
    s_and_b32 s41, s17, 0xffff
    s_mov_b32 s42, 2359296
    s_mov_b32 s43, 0x00020000
    s_add_u32 m0, s67, 0
    s_nop 0
    buffer_load_dwordx4 v240, s[40:43], 0 offen offset:0 lds
    s_add_u32 m0, s67, 1024
    s_nop 0
    buffer_load_dwordx4 v241, s[40:43], 0 offen offset:0 lds
    s_add_u32 m0, s67, 2048
    s_nop 0
    buffer_load_dwordx4 v242, s[40:43], 0 offen offset:0 lds
    s_add_u32 m0, s67, 3072
    s_nop 0
    buffer_load_dwordx4 v243, s[40:43], 0 offen offset:0 lds
    s_add_u32 m0, s67, 3968
    s_nop 0
    buffer_load_dwordx4 v240, s[40:43], 0 offen offset:128 lds
    s_add_u32 m0, s67, 4992
    s_nop 0
    buffer_load_dwordx4 v241, s[40:43], 0 offen offset:128 lds
    s_add_u32 m0, s67, 6016
    s_nop 0
    buffer_load_dwordx4 v242, s[40:43], 0 offen offset:128 lds
    s_add_u32 m0, s67, 7040
    s_nop 0
    buffer_load_dwordx4 v243, s[40:43], 0 offen offset:128 lds
    s_add_u32 m0, s67, 7936
    s_nop 0
    buffer_load_dwordx4 v240, s[40:43], 0 offen offset:256 lds
    s_add_u32 m0, s67, 8960
    s_nop 0
    buffer_load_dwordx4 v241, s[40:43], 0 offen offset:256 lds
    s_add_u32 m0, s67, 9984
    s_nop 0
    buffer_load_dwordx4 v242, s[40:43], 0 offen offset:256 lds
    s_mov_b32 s44, s28
    s_and_b32 s45, s29, 0xffff
    s_mov_b32 s46, 5308416
    s_mov_b32 s47, 0x00020000
    s_mov_b32 s48, s30
    s_add_u32 m0, s67, 11008
    s_nop 0
    buffer_load_dwordx4 v243, s[40:43], 0 offen offset:256 lds
    s_and_b32 s49, s31, 0xffff
    s_mov_b32 s50, 5308416
    s_mov_b32 s51, 0x00020000
    s_mov_b32 s52, s32
    s_and_b32 s53, s33, 0xffff
    s_add_u32 m0, s67, 11904
    s_nop 0
    buffer_load_dwordx4 v240, s[40:43], 0 offen offset:384 lds
    s_mov_b32 s54, 5308416
    s_mov_b32 s55, 0x00020000
    s_mov_b32 s56, s38
    s_and_b32 s57, s39, 0xffff
    s_mov_b32 s58, 268435456
    s_add_u32 m0, s67, 12928
    s_nop 0
    buffer_load_dwordx4 v241, s[40:43], 0 offen offset:384 lds
    s_mov_b32 s59, 0x00020000
    s_mov_b32 s60, s34
    s_and_b32 s61, s35, 0xffff
    s_mov_b32 s62, 2359296
    s_mov_b32 s63, 0x00020000
    s_add_u32 m0, s67, 13952
    s_nop 0
    buffer_load_dwordx4 v242, s[40:43], 0 offen offset:384 lds
    s_mov_b32 s4, s18
    s_and_b32 s5, s19, 0xffff
    s_mov_b32 s6, 8388608
    s_mov_b32 s7, 0x00020000
    s_mov_b32 s8, s20
    s_add_u32 m0, s67, 14976
    s_nop 0
    buffer_load_dwordx4 v243, s[40:43], 0 offen offset:384 lds
    s_and_b32 s9, s21, 0xffff
    s_mov_b32 s10, 8388608
    s_mov_b32 s11, 0x00020000
    s_lshl_b32 s76, s64, 6
    v_add_u32 v2, s76, v0
    s_add_u32 m0, s67, 15872
    s_nop 0
    buffer_load_dwordx4 v240, s[40:43], 0 offen offset:512 lds
    v_cmp_eq_u32 vcc, 0, v2
    v_mov_b32 v3, 0x40000000
    v_mov_b32 v4, 0
    v_cndmask_b32 v253, v3, v4, vcc
    s_lshl_b32 s33, s65, 4
    s_add_u32 s33, s33, s66
    s_and_b32 s78, s66, 1
    s_mul_i32 s76, s66, 288
    s_add_u32 m0, s67, 16896
    s_nop 0
    buffer_load_dwordx4 v241, s[40:43], 0 offen offset:512 lds
    s_mul_i32 s77, s78, 224
    s_add_u32 s77, s76, s77
    s_cmp_eq_u32 s78, 0
    s_cselect_b32 s79, 64, -64
    s_cselect_b32 s80, 256, 0
    s_add_u32 s80, s80, s76
    s_mul_i32 s81, s79, 0
    s_add_u32 m0, s67, 17920
    s_nop 0
    buffer_load_dwordx4 v242, s[40:43], 0 offen offset:512 lds
    s_add_u32 s81, s81, s77
    s_lshl_b32 s69, s81, 1
    s_mul_i32 s84, s81, 1152
    s_add_u32 s85, s84, 36864
    s_mul_i32 s81, s79, 1
    s_add_u32 m0, s67, 18944
    s_nop 0
    buffer_load_dwordx4 v243, s[40:43], 0 offen offset:512 lds
    s_add_u32 s81, s81, s77
    s_lshl_b32 s70, s81, 1
    s_mul_i32 s86, s81, 1152
    s_add_u32 s87, s86, 36864
    s_mul_i32 s81, s79, 2
    s_add_u32 m0, s67, 19840
    s_nop 0
    buffer_load_dwordx4 v240, s[40:43], 0 offen offset:640 lds
    s_add_u32 s81, s81, s77
    s_lshl_b32 s71, s81, 1
    s_mul_i32 s88, s81, 1152
    s_add_u32 s89, s88, 36864
    s_mul_i32 s81, s79, 3
    s_add_u32 m0, s67, 20864
    s_nop 0
    buffer_load_dwordx4 v241, s[40:43], 0 offen offset:640 lds
    s_add_u32 s81, s81, s77
    s_lshl_b32 s72, s81, 1
    s_mul_i32 s90, s81, 1152
    s_add_u32 s91, s90, 36864
    s_lshl_b32 s73, s80, 1
    s_add_u32 m0, s67, 21888
    s_nop 0
    buffer_load_dwordx4 v242, s[40:43], 0 offen offset:640 lds
    s_mul_i32 s92, s80, 1152
    s_mov_b32 s94, s69
    s_mul_i32 s81, s64, 663552
    s_add_u32 s69, s69, s81
    s_add_u32 s70, s70, s81
    s_add_u32 m0, s67, 22912
    s_nop 0
    buffer_load_dwordx4 v243, s[40:43], 0 offen offset:640 lds
    s_add_u32 s71, s71, s81
    s_add_u32 s72, s72, s81
    s_lshl_b32 s81, s81, 1
    s_add_u32 s73, s73, s81
    s_lshr_b32 s76, s66, 1
    s_add_u32 m0, s67, 23808
    s_nop 0
    buffer_load_dwordx4 v240, s[40:43], 0 offen offset:768 lds
    s_mul_i32 s75, s76, 2359296
    s_lshl_b32 s76, s65, 2
    s_add_u32 s76, s76, s64
    s_mul_i32 s76, s76, 36864
    s_add_u32 s75, s75, s76
    s_add_u32 m0, s67, 24832
    s_nop 0
    buffer_load_dwordx4 v241, s[40:43], 0 offen offset:768 lds
    s_lshl_b32 s76, s33, 2
    s_add_u32 s76, s76, s64
    s_mul_i32 s32, s76, 18432
    s_add_u32 s32, s32, 20971520
    v_lshrrev_b32 v2, 3, v0
    s_add_u32 m0, s67, 25856
    s_nop 0
    buffer_load_dwordx4 v242, s[40:43], 0 offen offset:768 lds
    v_and_b32 v3, 7, v0
    v_bfe_u32 v4, v0, 4, 1
    v_lshlrev_b32 v4, 2, v4
    v_xor_b32 v3, v3, v4
    v_lshlrev_b32 v3, 4, v3
    s_add_u32 m0, s67, 26880
    s_nop 0
    buffer_load_dwordx4 v243, s[40:43], 0 offen offset:768 lds
    v_mul_u32_u24 v2, 9216, v2
    v_add_u32 v10, v2, v3
    v_add_u32 v11, 72704, v10
    v_add_u32 v12, 145408, v10
    v_add_u32 v13, 218112, v10
    s_add_u32 m0, s67, 27776
    s_nop 0
    buffer_load_dwordx4 v240, s[40:43], 0 offen offset:896 lds
    v_and_b32 v2, 31, v0
    v_bfe_u32 v3, v0, 1, 3
    v_lshrrev_b32 v4, 5, v0
    v_xor_b32 v3, v3, v4
    v_lshlrev_b32 v3, 4, v3
    s_add_u32 m0, s67, 28800
    s_nop 0
    buffer_load_dwordx4 v241, s[40:43], 0 offen offset:896 lds
    v_lshlrev_b32 v2, 7, v2
    v_add_u32 v2, v2, v3
    v_add_u32 v248, s67, v2
    v_xor_b32 v249, 32, v248
    v_xor_b32 v250, 64, v248
    s_add_u32 m0, s67, 29824
    s_nop 0
    buffer_load_dwordx4 v242, s[40:43], 0 offen offset:896 lds
    v_xor_b32 v251, 96, v248
    v_and_b32 v2, 15, v0
    v_and_b32 v3, 3, v2
    v_bfe_u32 v4, v2, 2, 1
    s_add_u32 m0, s67, 30848
    s_nop 0
    buffer_load_dwordx4 v243, s[40:43], 0 offen offset:896 lds
    v_bfe_u32 v5, v2, 3, 1
    v_lshlrev_b32 v4, 3, v4
    v_lshlrev_b32 v5, 2, v5
    v_or_b32 v3, v3, v4
    s_add_u32 m0, s67, 31744
    s_nop 0
    buffer_load_dwordx4 v240, s[40:43], 0 offen offset:1024 lds
    v_or_b32 v3, v3, v5
    v_lshrrev_b32 v4, 3, v3
    v_lshrrev_b32 v5, 5, v0
    v_and_b32 v6, 1, v3
    s_add_u32 m0, s67, 32768
    s_nop 0
    buffer_load_dwordx4 v241, s[40:43], 0 offen offset:1024 lds
    v_lshlrev_b32 v6, 4, v6
    v_mov_b32 v7, 0x3f80
    v_lshlrev_b32 v7, v6, v7
    v_mov_b32 v8, 0
    s_add_u32 m0, s67, 33792
    s_nop 0
    buffer_load_dwordx4 v242, s[40:43], 0 offen offset:1024 lds
    v_cmp_eq_u32 vcc, v4, v5
    v_nop
    v_nop
    v_cndmask_b32 v7, v8, v7, vcc
    v_bfe_u32 v6, v3, 1, 2
    v_bfe_u32 v9, v0, 4, 1
    v_cmp_eq_u32 vcc, 0, v6
    v_nop
    v_nop
    v_cndmask_b32 v224, v8, v7, vcc
    s_add_u32 m0, s67, 34816
    s_nop 0
    buffer_load_dwordx4 v243, s[40:43], 0 offen offset:1024 lds
    v_cmp_eq_u32 vcc, 1, v6
    v_nop
    v_nop
    v_cndmask_b32 v225, v8, v7, vcc
    v_cmp_eq_u32 vcc, 2, v6
    v_nop
    v_nop
    v_cndmask_b32 v226, v8, v7, vcc
    v_cmp_eq_u32 vcc, 3, v6
    v_nop
    v_nop
    v_cndmask_b32 v227, v8, v7, vcc
    v_cmp_eq_u32 vcc, 1, v9
    v_nop
    v_nop
    v_cndmask_b32 v228, v8, v224, vcc
    v_cndmask_b32 v229, v8, v225, vcc
    v_cndmask_b32 v230, v8, v226, vcc
    v_cndmask_b32 v231, v8, v227, vcc
    v_cndmask_b32 v224, v224, v8, vcc
    v_cndmask_b32 v225, v225, v8, vcc
    v_cndmask_b32 v226, v226, v8, vcc
    v_cndmask_b32 v227, v227, v8, vcc
    v_mov_b32 v4, 0
    s_lshl_b32 s76, s33, 7
    s_add_u32 s76, s76, 48234496
    buffer_store_dword v4, v253, s[56:59], s76 offen sc1
    s_cmp_lt_u32 s66, 9
    s_cselect_b32 s12, s22, s24
    s_cselect_b32 s13, s23, s25
    s_cselect_b32 s83, 0, 9
    s_and_b32 s13, s13, 0xffff
    s_mov_b32 s14, 663552
    s_mov_b32 s15, 0x00020000
    s_sub_u32 s83, s66, s83
    s_lshl_b32 s83, s83, 5
    s_and_b32 s76, s65, 7
    s_mul_i32 s76, s76, 36
    s_mul_i32 s77, s64, 9
    s_add_u32 s76, s76, s77
    v_add_u32 v2, s76, v0
    v_mov_b32 v4, 0x40000000
    s_mov_b32 s77, 477218589
    v_mul_hi_u32 v5, v2, s77
    v_mul_u32_u24 v6, 9, v5
    v_sub_u32 v6, v2, v6
    v_add_u32 v5, s83, v5
    v_mul_u32_u24 v5, 1152, v5
    v_lshlrev_b32 v6, 7, v6
    v_add_u32 v5, v5, v6
    v_mul_u32_u24 v3, 9216, v2
    v_cmp_gt_u32 vcc, 9, v0
    s_nop 1
    v_cndmask_b32 v3, v4, v3, vcc
    v_cndmask_b32 v5, v4, v5, vcc
    buffer_load_dword v252, v5, s[12:15], 0 offen
    s_cmp_lt_u32 s66, 2
    s_cbranch_scc0 L_nopf2
    s_mov_b32 s76, 258048
    v_add_u32 v6, s76, v5
    v_cmp_gt_u32 vcc, 9, v0
    s_and_saveexec_b64 s[82:83], vcc
    global_load_dword v252, v6, s[24:25]
    s_mov_b64 exec, s[82:83]
L_nopf2:
    s_add_u32 s82, s94, 0
    buffer_load_dword v252, v3, s[44:47], s82 offen
    s_add_u32 s82, s94, 2654208
    buffer_load_dword v252, v3, s[44:47], s82 offen
    s_add_u32 s82, s94, 0
    buffer_load_dword v252, v3, s[48:51], s82 offen
    s_add_u32 s82, s94, 2654208
    buffer_load_dword v252, v3, s[48:51], s82 offen
    v_mov_b32 v16, 0
    v_mov_b32 v17, 0
    v_mov_b32 v18, 0
    v_mov_b32 v19, 0
    v_mov_b32 v20, 0
    v_mov_b32 v21, 0
    v_mov_b32 v22, 0
    v_mov_b32 v23, 0
    s_mov_b32 s81, 0x3f803f80
    s_waitcnt vmcnt(38)
    ds_read_b128 v[80:83], v248 offset:0
    ds_read_b128 v[84:87], v249 offset:0
    ds_read_b128 v[88:91], v250 offset:0
    ds_read_b128 v[92:95], v251 offset:0
    s_waitcnt vmcnt(34)
    ds_read_b128 v[96:99], v248 offset:4096
    ds_read_b128 v[100:103], v249 offset:4096
    ds_read_b128 v[104:107], v250 offset:4096
    ds_read_b128 v[108:111], v251 offset:4096
    s_waitcnt lgkmcnt(7)
    v_dot2c_f32_bf16 v16, s81, v80
    v_dot2c_f32_bf16 v20, v80, v80
    v_dot2c_f32_bf16 v17, s81, v81
    v_dot2c_f32_bf16 v21, v81, v81
    v_dot2c_f32_bf16 v18, s81, v82
    v_dot2c_f32_bf16 v22, v82, v82
    v_dot2c_f32_bf16 v19, s81, v83
    v_dot2c_f32_bf16 v23, v83, v83
    s_waitcnt lgkmcnt(6)
    v_dot2c_f32_bf16 v16, s81, v84
    v_dot2c_f32_bf16 v20, v84, v84
    v_dot2c_f32_bf16 v17, s81, v85
    v_dot2c_f32_bf16 v21, v85, v85
    v_dot2c_f32_bf16 v18, s81, v86
    v_dot2c_f32_bf16 v22, v86, v86
    v_dot2c_f32_bf16 v19, s81, v87
    v_dot2c_f32_bf16 v23, v87, v87
    s_waitcnt lgkmcnt(5)
    v_dot2c_f32_bf16 v16, s81, v88
    v_dot2c_f32_bf16 v20, v88, v88
    v_dot2c_f32_bf16 v17, s81, v89
    v_dot2c_f32_bf16 v21, v89, v89
    v_dot2c_f32_bf16 v18, s81, v90
    v_dot2c_f32_bf16 v22, v90, v90
    v_dot2c_f32_bf16 v19, s81, v91
    v_dot2c_f32_bf16 v23, v91, v91
    s_waitcnt lgkmcnt(4)
    v_dot2c_f32_bf16 v16, s81, v92
    v_dot2c_f32_bf16 v20, v92, v92
    v_dot2c_f32_bf16 v17, s81, v93
    v_dot2c_f32_bf16 v21, v93, v93
    v_dot2c_f32_bf16 v18, s81, v94
    v_dot2c_f32_bf16 v22, v94, v94
    v_dot2c_f32_bf16 v19, s81, v95
    v_dot2c_f32_bf16 v23, v95, v95
    s_waitcnt vmcnt(30)
    ds_read_b128 v[112:115], v248 offset:8192
    ds_read_b128 v[116:119], v249 offset:8192
    ds_read_b128 v[120:123], v250 offset:8192
    ds_read_b128 v[124:127], v251 offset:8192
    s_waitcnt lgkmcnt(7)
    v_dot2c_f32_bf16 v16, s81, v96
    v_dot2c_f32_bf16 v20, v96, v96
    v_dot2c_f32_bf16 v17, s81, v97
    v_dot2c_f32_bf16 v21, v97, v97
    v_dot2c_f32_bf16 v18, s81, v98
    v_dot2c_f32_bf16 v22, v98, v98
    v_dot2c_f32_bf16 v19, s81, v99
    v_dot2c_f32_bf16 v23, v99, v99
    s_waitcnt lgkmcnt(6)
    v_dot2c_f32_bf16 v16, s81, v100
    v_dot2c_f32_bf16 v20, v100, v100
    v_dot2c_f32_bf16 v17, s81, v101
    v_dot2c_f32_bf16 v21, v101, v101
    v_dot2c_f32_bf16 v18, s81, v102
    v_dot2c_f32_bf16 v22, v102, v102
    v_dot2c_f32_bf16 v19, s81, v103
    v_dot2c_f32_bf16 v23, v103, v103
    s_waitcnt lgkmcnt(5)
    v_dot2c_f32_bf16 v16, s81, v104
    v_dot2c_f32_bf16 v20, v104, v104
    v_dot2c_f32_bf16 v17, s81, v105
    v_dot2c_f32_bf16 v21, v105, v105
    v_dot2c_f32_bf16 v18, s81, v106
    v_dot2c_f32_bf16 v22, v106, v106
    v_dot2c_f32_bf16 v19, s81, v107
    v_dot2c_f32_bf16 v23, v107, v107
    s_waitcnt lgkmcnt(4)
    v_dot2c_f32_bf16 v16, s81, v108
    v_dot2c_f32_bf16 v20, v108, v108
    v_dot2c_f32_bf16 v17, s81, v109
    v_dot2c_f32_bf16 v21, v109, v109
    v_dot2c_f32_bf16 v18, s81, v110
    v_dot2c_f32_bf16 v22, v110, v110
    v_dot2c_f32_bf16 v19, s81, v111
    v_dot2c_f32_bf16 v23, v111, v111
    s_waitcnt vmcnt(26)
    ds_read_b128 v[128:131], v248 offset:12288
    ds_read_b128 v[132:135], v249 offset:12288
    ds_read_b128 v[136:139], v250 offset:12288
    ds_read_b128 v[140:143], v251 offset:12288
    s_waitcnt lgkmcnt(7)
    v_dot2c_f32_bf16 v16, s81, v112
    v_dot2c_f32_bf16 v20, v112, v112
    v_dot2c_f32_bf16 v17, s81, v113
    v_dot2c_f32_bf16 v21, v113, v113
    v_dot2c_f32_bf16 v18, s81, v114
    v_dot2c_f32_bf16 v22, v114, v114
    v_dot2c_f32_bf16 v19, s81, v115
    v_dot2c_f32_bf16 v23, v115, v115
    s_waitcnt lgkmcnt(6)
    v_dot2c_f32_bf16 v16, s81, v116
    v_dot2c_f32_bf16 v20, v116, v116
    v_dot2c_f32_bf16 v17, s81, v117
    v_dot2c_f32_bf16 v21, v117, v117
    v_dot2c_f32_bf16 v18, s81, v118
    v_dot2c_f32_bf16 v22, v118, v118
    v_dot2c_f32_bf16 v19, s81, v119
    v_dot2c_f32_bf16 v23, v119, v119
    s_waitcnt lgkmcnt(5)
    v_dot2c_f32_bf16 v16, s81, v120
    v_dot2c_f32_bf16 v20, v120, v120
    v_dot2c_f32_bf16 v17, s81, v121
    v_dot2c_f32_bf16 v21, v121, v121
    v_dot2c_f32_bf16 v18, s81, v122
    v_dot2c_f32_bf16 v22, v122, v122
    v_dot2c_f32_bf16 v19, s81, v123
    v_dot2c_f32_bf16 v23, v123, v123
    s_waitcnt lgkmcnt(4)
    v_dot2c_f32_bf16 v16, s81, v124
    v_dot2c_f32_bf16 v20, v124, v124
    v_dot2c_f32_bf16 v17, s81, v125
    v_dot2c_f32_bf16 v21, v125, v125
    v_dot2c_f32_bf16 v18, s81, v126
    v_dot2c_f32_bf16 v22, v126, v126
    v_dot2c_f32_bf16 v19, s81, v127
    v_dot2c_f32_bf16 v23, v127, v127
    s_waitcnt vmcnt(22)
    ds_read_b128 v[144:147], v248 offset:16384
    ds_read_b128 v[148:151], v249 offset:16384
    ds_read_b128 v[152:155], v250 offset:16384
    ds_read_b128 v[156:159], v251 offset:16384
    s_waitcnt lgkmcnt(7)
    v_dot2c_f32_bf16 v16, s81, v128
    v_dot2c_f32_bf16 v20, v128, v128
    v_dot2c_f32_bf16 v17, s81, v129
    v_dot2c_f32_bf16 v21, v129, v129
    v_dot2c_f32_bf16 v18, s81, v130
    v_dot2c_f32_bf16 v22, v130, v130
    v_dot2c_f32_bf16 v19, s81, v131
    v_dot2c_f32_bf16 v23, v131, v131
    s_waitcnt lgkmcnt(6)
    v_dot2c_f32_bf16 v16, s81, v132
    v_dot2c_f32_bf16 v20, v132, v132
    v_dot2c_f32_bf16 v17, s81, v133
    v_dot2c_f32_bf16 v21, v133, v133
    v_dot2c_f32_bf16 v18, s81, v134
    v_dot2c_f32_bf16 v22, v134, v134
    v_dot2c_f32_bf16 v19, s81, v135
    v_dot2c_f32_bf16 v23, v135, v135
    s_waitcnt lgkmcnt(5)
    v_dot2c_f32_bf16 v16, s81, v136
    v_dot2c_f32_bf16 v20, v136, v136
    v_dot2c_f32_bf16 v17, s81, v137
    v_dot2c_f32_bf16 v21, v137, v137
    v_dot2c_f32_bf16 v18, s81, v138
    v_dot2c_f32_bf16 v22, v138, v138
    v_dot2c_f32_bf16 v19, s81, v139
    v_dot2c_f32_bf16 v23, v139, v139
    s_waitcnt lgkmcnt(4)
    v_dot2c_f32_bf16 v16, s81, v140
    v_dot2c_f32_bf16 v20, v140, v140
    v_dot2c_f32_bf16 v17, s81, v141
    v_dot2c_f32_bf16 v21, v141, v141
    v_dot2c_f32_bf16 v18, s81, v142
    v_dot2c_f32_bf16 v22, v142, v142
    v_dot2c_f32_bf16 v19, s81, v143
    v_dot2c_f32_bf16 v23, v143, v143
    s_waitcnt vmcnt(18)
    ds_read_b128 v[160:163], v248 offset:20480
    ds_read_b128 v[164:167], v249 offset:20480
    ds_read_b128 v[168:171], v250 offset:20480
    ds_read_b128 v[172:175], v251 offset:20480
    s_waitcnt lgkmcnt(7)
    v_dot2c_f32_bf16 v16, s81, v144
    v_dot2c_f32_bf16 v20, v144, v144
    v_dot2c_f32_bf16 v17, s81, v145
    v_dot2c_f32_bf16 v21, v145, v145
    v_dot2c_f32_bf16 v18, s81, v146
    v_dot2c_f32_bf16 v22, v146, v146
    v_dot2c_f32_bf16 v19, s81, v147
    v_dot2c_f32_bf16 v23, v147, v147
    s_waitcnt lgkmcnt(6)
    v_dot2c_f32_bf16 v16, s81, v148
    v_dot2c_f32_bf16 v20, v148, v148
    v_dot2c_f32_bf16 v17, s81, v149
    v_dot2c_f32_bf16 v21, v149, v149
    v_dot2c_f32_bf16 v18, s81, v150
    v_dot2c_f32_bf16 v22, v150, v150
    v_dot2c_f32_bf16 v19, s81, v151
    v_dot2c_f32_bf16 v23, v151, v151
    s_waitcnt lgkmcnt(5)
    v_dot2c_f32_bf16 v16, s81, v152
    v_dot2c_f32_bf16 v20, v152, v152
    v_dot2c_f32_bf16 v17, s81, v153
    v_dot2c_f32_bf16 v21, v153, v153
    v_dot2c_f32_bf16 v18, s81, v154
    v_dot2c_f32_bf16 v22, v154, v154
    v_dot2c_f32_bf16 v19, s81, v155
    v_dot2c_f32_bf16 v23, v155, v155
    s_waitcnt lgkmcnt(4)
    v_dot2c_f32_bf16 v16, s81, v156
    v_dot2c_f32_bf16 v20, v156, v156
    v_dot2c_f32_bf16 v17, s81, v157
    v_dot2c_f32_bf16 v21, v157, v157
    v_dot2c_f32_bf16 v18, s81, v158
    v_dot2c_f32_bf16 v22, v158, v158
    v_dot2c_f32_bf16 v19, s81, v159
    v_dot2c_f32_bf16 v23, v159, v159
    s_waitcnt vmcnt(14)
    ds_read_b128 v[176:179], v248 offset:24576
    ds_read_b128 v[180:183], v249 offset:24576
    ds_read_b128 v[184:187], v250 offset:24576
    ds_read_b128 v[188:191], v251 offset:24576
    s_waitcnt lgkmcnt(7)
    v_dot2c_f32_bf16 v16, s81, v160
    v_dot2c_f32_bf16 v20, v160, v160
    v_dot2c_f32_bf16 v17, s81, v161
    v_dot2c_f32_bf16 v21, v161, v161
    v_dot2c_f32_bf16 v18, s81, v162
    v_dot2c_f32_bf16 v22, v162, v162
    v_dot2c_f32_bf16 v19, s81, v163
    v_dot2c_f32_bf16 v23, v163, v163
    s_waitcnt lgkmcnt(6)
    v_dot2c_f32_bf16 v16, s81, v164
    v_dot2c_f32_bf16 v20, v164, v164
    v_dot2c_f32_bf16 v17, s81, v165
    v_dot2c_f32_bf16 v21, v165, v165
    v_dot2c_f32_bf16 v18, s81, v166
    v_dot2c_f32_bf16 v22, v166, v166
    v_dot2c_f32_bf16 v19, s81, v167
    v_dot2c_f32_bf16 v23, v167, v167
    s_waitcnt lgkmcnt(5)
    v_dot2c_f32_bf16 v16, s81, v168
    v_dot2c_f32_bf16 v20, v168, v168
    v_dot2c_f32_bf16 v17, s81, v169
    v_dot2c_f32_bf16 v21, v169, v169
    v_dot2c_f32_bf16 v18, s81, v170
    v_dot2c_f32_bf16 v22, v170, v170
    v_dot2c_f32_bf16 v19, s81, v171
    v_dot2c_f32_bf16 v23, v171, v171
    s_waitcnt lgkmcnt(4)
    v_dot2c_f32_bf16 v16, s81, v172
    v_dot2c_f32_bf16 v20, v172, v172
    v_dot2c_f32_bf16 v17, s81, v173
    v_dot2c_f32_bf16 v21, v173, v173
    v_dot2c_f32_bf16 v18, s81, v174
    v_dot2c_f32_bf16 v22, v174, v174
    v_dot2c_f32_bf16 v19, s81, v175
    v_dot2c_f32_bf16 v23, v175, v175
    s_waitcnt vmcnt(10)
    ds_read_b128 v[192:195], v248 offset:28672
    ds_read_b128 v[196:199], v249 offset:28672
    ds_read_b128 v[200:203], v250 offset:28672
    ds_read_b128 v[204:207], v251 offset:28672
    s_waitcnt lgkmcnt(7)
    v_dot2c_f32_bf16 v16, s81, v176
    v_dot2c_f32_bf16 v20, v176, v176
    v_dot2c_f32_bf16 v17, s81, v177
    v_dot2c_f32_bf16 v21, v177, v177
    v_dot2c_f32_bf16 v18, s81, v178
    v_dot2c_f32_bf16 v22, v178, v178
    v_dot2c_f32_bf16 v19, s81, v179
    v_dot2c_f32_bf16 v23, v179, v179
    s_waitcnt lgkmcnt(6)
    v_dot2c_f32_bf16 v16, s81, v180
    v_dot2c_f32_bf16 v20, v180, v180
    v_dot2c_f32_bf16 v17, s81, v181
    v_dot2c_f32_bf16 v21, v181, v181
    v_dot2c_f32_bf16 v18, s81, v182
    v_dot2c_f32_bf16 v22, v182, v182
    v_dot2c_f32_bf16 v19, s81, v183
    v_dot2c_f32_bf16 v23, v183, v183
    s_waitcnt lgkmcnt(5)
    v_dot2c_f32_bf16 v16, s81, v184
    v_dot2c_f32_bf16 v20, v184, v184
    v_dot2c_f32_bf16 v17, s81, v185
    v_dot2c_f32_bf16 v21, v185, v185
    v_dot2c_f32_bf16 v18, s81, v186
    v_dot2c_f32_bf16 v22, v186, v186
    v_dot2c_f32_bf16 v19, s81, v187
    v_dot2c_f32_bf16 v23, v187, v187
    s_waitcnt lgkmcnt(4)
    v_dot2c_f32_bf16 v16, s81, v188
    v_dot2c_f32_bf16 v20, v188, v188
    v_dot2c_f32_bf16 v17, s81, v189
    v_dot2c_f32_bf16 v21, v189, v189
    v_dot2c_f32_bf16 v18, s81, v190
    v_dot2c_f32_bf16 v22, v190, v190
    v_dot2c_f32_bf16 v19, s81, v191
    v_dot2c_f32_bf16 v23, v191, v191
    s_waitcnt vmcnt(6)
    ds_read_b128 v[208:211], v248 offset:32768
    ds_read_b128 v[212:215], v249 offset:32768
    ds_read_b128 v[216:219], v250 offset:32768
    ds_read_b128 v[220:223], v251 offset:32768
    s_waitcnt lgkmcnt(7)
    v_dot2c_f32_bf16 v16, s81, v192
    v_dot2c_f32_bf16 v20, v192, v192
    v_dot2c_f32_bf16 v17, s81, v193
    v_dot2c_f32_bf16 v21, v193, v193
    v_dot2c_f32_bf16 v18, s81, v194
    v_dot2c_f32_bf16 v22, v194, v194
    v_dot2c_f32_bf16 v19, s81, v195
    v_dot2c_f32_bf16 v23, v195, v195
    s_waitcnt lgkmcnt(6)
    v_dot2c_f32_bf16 v16, s81, v196
    v_dot2c_f32_bf16 v20, v196, v196
    v_dot2c_f32_bf16 v17, s81, v197
    v_dot2c_f32_bf16 v21, v197, v197
    v_dot2c_f32_bf16 v18, s81, v198
    v_dot2c_f32_bf16 v22, v198, v198
    v_dot2c_f32_bf16 v19, s81, v199
    v_dot2c_f32_bf16 v23, v199, v199
    s_waitcnt lgkmcnt(5)
    v_dot2c_f32_bf16 v16, s81, v200
    v_dot2c_f32_bf16 v20, v200, v200
    v_dot2c_f32_bf16 v17, s81, v201
    v_dot2c_f32_bf16 v21, v201, v201
    v_dot2c_f32_bf16 v18, s81, v202
    v_dot2c_f32_bf16 v22, v202, v202
    v_dot2c_f32_bf16 v19, s81, v203
    v_dot2c_f32_bf16 v23, v203, v203
    s_waitcnt lgkmcnt(4)
    v_dot2c_f32_bf16 v16, s81, v204
    v_dot2c_f32_bf16 v20, v204, v204
    v_dot2c_f32_bf16 v17, s81, v205
    v_dot2c_f32_bf16 v21, v205, v205
    v_dot2c_f32_bf16 v18, s81, v206
    v_dot2c_f32_bf16 v22, v206, v206
    v_dot2c_f32_bf16 v19, s81, v207
    v_dot2c_f32_bf16 v23, v207, v207
    s_waitcnt lgkmcnt(3)
    v_dot2c_f32_bf16 v16, s81, v208
    v_dot2c_f32_bf16 v20, v208, v208
    v_dot2c_f32_bf16 v17, s81, v209
    v_dot2c_f32_bf16 v21, v209, v209
    v_dot2c_f32_bf16 v18, s81, v210
    v_dot2c_f32_bf16 v22, v210, v210
    v_dot2c_f32_bf16 v19, s81, v211
    v_dot2c_f32_bf16 v23, v211, v211
    s_waitcnt lgkmcnt(2)
    v_dot2c_f32_bf16 v16, s81, v212
    v_dot2c_f32_bf16 v20, v212, v212
    v_dot2c_f32_bf16 v17, s81, v213
    v_dot2c_f32_bf16 v21, v213, v213
    v_dot2c_f32_bf16 v18, s81, v214
    v_dot2c_f32_bf16 v22, v214, v214
    v_dot2c_f32_bf16 v19, s81, v215
    v_dot2c_f32_bf16 v23, v215, v215
    s_waitcnt lgkmcnt(1)
    v_dot2c_f32_bf16 v16, s81, v216
    v_dot2c_f32_bf16 v20, v216, v216
    v_dot2c_f32_bf16 v17, s81, v217
    v_dot2c_f32_bf16 v21, v217, v217
    v_dot2c_f32_bf16 v18, s81, v218
    v_dot2c_f32_bf16 v22, v218, v218
    v_dot2c_f32_bf16 v19, s81, v219
    v_dot2c_f32_bf16 v23, v219, v219
    s_waitcnt lgkmcnt(0)
    v_dot2c_f32_bf16 v16, s81, v220
    v_dot2c_f32_bf16 v20, v220, v220
    v_dot2c_f32_bf16 v17, s81, v221
    v_dot2c_f32_bf16 v21, v221, v221
    v_dot2c_f32_bf16 v18, s81, v222
    v_dot2c_f32_bf16 v22, v222, v222
    v_dot2c_f32_bf16 v19, s81, v223
    v_dot2c_f32_bf16 v23, v223, v223
    s_barrier
    s_mov_b32 s94, s66
    s_add_u32 s95, s66, 16
    s_cmp_lt_u32 s94, 9
    s_cselect_b32 s12, s22, s24
    s_cselect_b32 s13, s23, s25
    s_cselect_b32 s83, 0, 9
    s_and_b32 s13, s13, 0xffff
    s_mov_b32 s14, 663552
    s_mov_b32 s15, 0x00020000
    s_sub_u32 s83, s94, s83
    s_lshl_b32 s83, s83, 5
    s_lshl_b32 s77, s64, 3
    s_add_u32 s76, s83, s77
    v_lshrrev_b32 v240, 3, v0
    v_and_b32 v241, 7, v0
    v_lshrrev_b32 v242, 1, v240
    v_xor_b32 v241, v241, v242
    s_and_b32 s77, s64, 1
    s_lshl_b32 s77, s77, 2
    v_xor_b32 v241, s77, v241
    v_lshlrev_b32 v241, 4, v241
    v_add_u32 v240, s76, v240
    s_movk_i32 s77, 1152
    v_mad_u32_u24 v240, v240, s77, v241
    s_lshl_b32 s77, s64, 10
    s_add_u32 s77, s77, 73728
    s_add_u32 m0, s77, 0
    s_nop 0
    buffer_load_dwordx4 v240, s[12:15], 0 offen offset:0 lds
    s_add_u32 m0, s77, 3968
    s_nop 0
    buffer_load_dwordx4 v240, s[12:15], 0 offen offset:128 lds
    s_add_u32 m0, s77, 7936
    s_nop 0
    buffer_load_dwordx4 v240, s[12:15], 0 offen offset:256 lds
    s_add_u32 m0, s77, 11904
    s_nop 0
    buffer_load_dwordx4 v240, s[12:15], 0 offen offset:384 lds
    s_add_u32 m0, s77, 15872
    s_nop 0
    buffer_load_dwordx4 v240, s[12:15], 0 offen offset:512 lds
    s_add_u32 m0, s77, 19840
    s_nop 0
    buffer_load_dwordx4 v240, s[12:15], 0 offen offset:640 lds
    s_add_u32 m0, s77, 23808
    s_nop 0
    buffer_load_dwordx4 v240, s[12:15], 0 offen offset:768 lds
    s_add_u32 m0, s77, 27776
    s_nop 0
    buffer_load_dwordx4 v240, s[12:15], 0 offen offset:896 lds
    s_add_u32 m0, s77, 31744
    s_nop 0
    buffer_load_dwordx4 v240, s[12:15], 0 offen offset:1024 lds
    s_cmp_lt_u32 s66, 2
    s_cbranch_scc0 L_noz2a
    s_cmp_lt_u32 s95, 9
    s_cselect_b32 s12, s22, s24
    s_cselect_b32 s13, s23, s25
    s_cselect_b32 s83, 0, 9
    s_and_b32 s13, s13, 0xffff
    s_mov_b32 s14, 663552
    s_mov_b32 s15, 0x00020000
    s_sub_u32 s83, s95, s83
    s_lshl_b32 s83, s83, 5
    s_lshl_b32 s77, s64, 3
    s_add_u32 s76, s83, s77
    v_lshrrev_b32 v240, 3, v0
    v_and_b32 v241, 7, v0
    v_lshrrev_b32 v242, 1, v240
    v_xor_b32 v241, v241, v242
    s_and_b32 s77, s64, 1
    s_lshl_b32 s77, s77, 2
    v_xor_b32 v241, s77, v241
    v_lshlrev_b32 v241, 4, v241
    v_add_u32 v240, s76, v240
    s_movk_i32 s77, 1152
    v_mad_u32_u24 v240, v240, s77, v241
    s_lshl_b32 s77, s64, 10
    s_add_u32 s77, s77, 110592
    s_add_u32 m0, s77, 0
    s_nop 0
    buffer_load_dwordx4 v240, s[12:15], 0 offen offset:0 lds
    s_add_u32 m0, s77, 3968
    s_nop 0
    buffer_load_dwordx4 v240, s[12:15], 0 offen offset:128 lds
    s_add_u32 m0, s77, 7936
    s_nop 0
    buffer_load_dwordx4 v240, s[12:15], 0 offen offset:256 lds
    s_add_u32 m0, s77, 11904
    s_nop 0
    buffer_load_dwordx4 v240, s[12:15], 0 offen offset:384 lds
    s_add_u32 m0, s77, 15872
    s_nop 0
    buffer_load_dwordx4 v240, s[12:15], 0 offen offset:512 lds
    s_add_u32 m0, s77, 19840
    s_nop 0
    buffer_load_dwordx4 v240, s[12:15], 0 offen offset:640 lds
    s_add_u32 m0, s77, 23808
    s_nop 0
    buffer_load_dwordx4 v240, s[12:15], 0 offen offset:768 lds
    s_add_u32 m0, s77, 27776
    s_nop 0
    buffer_load_dwordx4 v240, s[12:15], 0 offen offset:896 lds
    s_add_u32 m0, s77, 31744
    s_nop 0
    buffer_load_dwordx4 v240, s[12:15], 0 offen offset:1024 lds
L_noz2a:
    s_add_u32 m0, s68, 0
    s_add_u32 s3, s69, 0
    buffer_load_dwordx4 v10, s[44:47], s3 offen offset:0 lds
    s_nop 2
    v_add_f32 v16, v16, v17
    v_add_f32 v18, v18, v19
    v_add_f32 v20, v20, v21
    buffer_load_dwordx4 v11, s[44:47], s3 offen offset:1024 lds
    v_add_f32 v22, v22, v23
    v_add_f32 v24, v16, v18
    v_add_f32 v26, v20, v22
    v_mov_b32 v25, v24
    buffer_load_dwordx4 v12, s[44:47], s3 offen offset:2048 lds
    v_mov_b32 v27, v26
    s_nop 1
    v_permlane32_swap_b32 v24, v25
    v_permlane32_swap_b32 v26, v27
    buffer_load_dwordx4 v13, s[44:47], s3 offen offset:3072 lds
    s_nop 1
    v_add_f32 v24, v24, v25
    v_add_f32 v26, v26, v27
    s_mov_b32 s81, 0x3ae38e39
    s_add_u32 m0, s68, 4096
    s_add_u32 s3, s69, 294912
    buffer_load_dwordx4 v10, s[44:47], s3 offen offset:0 lds
    v_mul_f32 v24, s81, v24
    v_mul_f32 v26, s81, v26
    v_fma_f32 v26, -v24, v24, v26
    v_max_f32 v26, 0, v26
    buffer_load_dwordx4 v11, s[44:47], s3 offen offset:1024 lds
    v_cvt_pk_bf16_f32 v24, v24, v26
    v_and_b32 v26, 0xffff0000, v24
    v_lshlrev_b32 v24, 16, v24
    v_xor_b32 v64, 0x80000000, v24
    buffer_load_dwordx4 v12, s[44:47], s3 offen offset:2048 lds
    v_mov_b32 v65, v64
    v_mov_b32 v66, v64
    v_mov_b32 v67, v64
    v_mov_b32 v68, v64
    buffer_load_dwordx4 v13, s[44:47], s3 offen offset:3072 lds
    v_mov_b32 v69, v64
    v_mov_b32 v70, v64
    v_mov_b32 v71, v64
    v_mov_b32 v72, v64
    s_add_u32 m0, s68, 8192
    s_add_u32 s3, s69, 589824
    buffer_load_dwordx4 v10, s[44:47], s3 offen offset:0 lds
    v_mov_b32 v73, v64
    v_mov_b32 v74, v64
    v_mov_b32 v75, v64
    v_mov_b32 v76, v64
    s_add_u32 m0, s68, 36864
    s_add_u32 s3, s69, 2654208
    buffer_load_dwordx4 v10, s[44:47], s3 offen offset:0 lds
    v_mov_b32 v77, v64
    v_mov_b32 v78, v64
    v_mov_b32 v79, v64
    v_add_f32 v26, 0x3727c5ac, v26
    buffer_load_dwordx4 v11, s[44:47], s3 offen offset:1024 lds
    v_cvt_pk_bf16_f32 v26, v26, v26
    v_lshlrev_b32 v26, 16, v26
    v_sqrt_f32 v26, v26
    s_nop 0
    buffer_load_dwordx4 v12, s[44:47], s3 offen offset:2048 lds
    v_cvt_pk_bf16_f32 v26, v26, v26
    v_lshlrev_b32 v26, 16, v26
    v_rcp_f32 v27, v26
    v_mul_f32 v254, v26, v26
    buffer_load_dwordx4 v13, s[44:47], s3 offen offset:3072 lds
    v_mul_f32 v14, 0xc0135761, v27
    v_mul_f32 v28, v27, v27
    v_mul_f32 v28, v28, v27
    v_mul_f32 v15, 0xbdd2d3e8, v28
    s_add_u32 m0, s68, 40960
    s_add_u32 s3, s69, 2949120
    buffer_load_dwordx4 v10, s[44:47], s3 offen offset:0 lds
    v_and_b32 v28, 31, v0
    v_lshlrev_b32 v28, 2, v28
    s_lshl_b32 s76, s64, 12
    s_add_u32 s76, s76, 147456
    buffer_load_dwordx4 v11, s[44:47], s3 offen offset:1024 lds
    v_add_u32 v28, s76, v28
    ds_write_b32 v28, v27
    buffer_load_dwordx4 v12, s[44:47], s3 offen offset:2048 lds
    buffer_load_dwordx4 v13, s[44:47], s3 offen offset:3072 lds
    s_add_u32 m0, s68, 45056
    s_add_u32 s3, s69, 3244032
    buffer_load_dwordx4 v10, s[44:47], s3 offen offset:0 lds
    s_lshl_b32 s97, s33, 2
    s_add_u32 s97, s97, s64
    s_mul_i32 s97, s97, 41
    v_add_u32 v240, s97, v0
    v_lshlrev_b32 v240, 7, v240
    v_cmp_gt_u32 vcc, 41, v0
    s_nop 1
    v_cndmask_b32 v240, v253, v240, vcc
    buffer_load_dword v252, v240, s[44:47], 0 offen
    buffer_load_dword v252, v240, s[48:51], 0 offen
    v_subrev_u32 v248, s67, v248
    v_subrev_u32 v249, s67, v249
    v_subrev_u32 v250, s67, v250
    v_subrev_u32 v251, s67, v251
    v_add_u32 v248, 73728, v248
    v_add_u32 v249, 73728, v249
    v_add_u32 v250, 73728, v250
    v_add_u32 v251, 73728, v251
    v_mfma_f32_32x32x16_bf16 v[16:31], v[224:227], v[80:83], v[64:79]
    v_mfma_f32_32x32x16_bf16 v[16:31], v[228:231], v[84:87], v[16:31]
    v_mfma_f32_32x32x16_bf16 v[32:47], v[224:227], v[88:91], v[64:79]
    s_nop 4
    v_mfma_f32_32x32x16_bf16 v[32:47], v[228:231], v[92:95], v[32:47]
    s_nop 4
    v_mfma_f32_32x32x16_bf16 v[80:95], v[224:227], v[96:99], v[64:79]
    v_cvt_pk_bf16_f32 v2, v16, v17
    v_accvgpr_write_b32 a0, v2
    v_cvt_pk_bf16_f32 v3, v18, v19
    v_mfma_f32_32x32x16_bf16 v[80:95], v[228:231], v[100:103], v[80:95]
    v_accvgpr_write_b32 a1, v3
    v_cvt_pk_bf16_f32 v2, v20, v21
    v_accvgpr_write_b32 a2, v2
    s_waitcnt vmcnt(20)
    s_cmp_eq_u32 s94, 9
    s_cbranch_scc0 L_h_nospa
    s_cmp_eq_u32 s64, 0
    s_cbranch_scc0 L_h_nospa
    v_mov_b32 v232, 0xbf803f80
    v_mov_b32 v233, v232
    v_mov_b32 v234, v232
    v_mov_b32 v235, v232
    v_lshrrev_b32 v240, 3, v0
    v_lshlrev_b32 v240, 12, v240
    v_and_b32 v241, 7, v0
    v_lshlrev_b32 v241, 4, v241
    v_add_u32 v240, v240, v241
    v_add_u32 v240, 73728, v240
    v_add_u32 v241, 73728, v241
    ds_write_b128 v240, v[232:235]
    ds_write_b128 v241, v[232:235] offset:32768
    s_waitcnt lgkmcnt(0)
L_h_nospa:
    s_waitcnt lgkmcnt(0)
    s_barrier
    v_mfma_f32_32x32x16_bf16 v[48:63], v[224:227], v[104:107], v[64:79]
    ds_read_b128 a[144:147], v248 offset:0
    v_cvt_pk_bf16_f32 v3, v22, v23
    v_accvgpr_write_b32 a3, v3
    v_cvt_pk_bf16_f32 v4, v32, v33
    v_mfma_f32_32x32x16_bf16 v[48:63], v[228:231], v[108:111], v[48:63]
    ds_read_b128 a[148:151], v249 offset:0
    v_cvt_pk_bf16_f32 v2, v24, v25
    v_accvgpr_write_b32 a4, v2
    v_accvgpr_write_b32 a8, v4
    v_cvt_pk_bf16_f32 v5, v34, v35
    v_mfma_f32_32x32x16_bf16 v[96:111], v[224:227], v[112:115], v[64:79]
    v_cvt_pk_bf16_f32 v3, v26, v27
    v_accvgpr_write_b32 a5, v3
    v_cvt_pk_bf16_f32 v2, v28, v29
    v_accvgpr_write_b32 a9, v5
    v_cvt_pk_bf16_f32 v6, v80, v81
    v_mfma_f32_32x32x16_bf16 v[96:111], v[228:231], v[116:119], v[96:111]
    v_accvgpr_write_b32 a6, v2
    v_cvt_pk_bf16_f32 v3, v30, v31
    v_accvgpr_write_b32 a7, v3
    v_cvt_pk_bf16_f32 v4, v36, v37
    v_accvgpr_write_b32 a16, v6
    v_mfma_f32_32x32x16_bf16 v[16:31], v[224:227], v[120:123], v[64:79]
    ds_read_b128 a[152:155], v250 offset:0
    v_accvgpr_write_b32 a10, v4
    v_cvt_pk_bf16_f32 v5, v38, v39
    v_cvt_pk_bf16_f32 v7, v82, v83
    v_cvt_pk_bf16_f32 v8, v48, v49
    v_mfma_f32_32x32x16_bf16 v[16:31], v[228:231], v[124:127], v[16:31]
    s_waitcnt lgkmcnt(1)
    ds_read_b128 a[156:159], v251 offset:0
    v_accvgpr_write_b32 a11, v5
    v_cvt_pk_bf16_f32 v4, v40, v41
    v_accvgpr_write_b32 a17, v7
    v_accvgpr_write_b32 a24, v8
    v_mfma_f32_32x32x16_bf16 v[232:247], a[0:3], a[144:147], 0
    v_accvgpr_write_b32 a12, v4
    v_cvt_pk_bf16_f32 v5, v42, v43
    v_cvt_pk_bf16_f32 v6, v84, v85
    v_cvt_pk_bf16_f32 v9, v50, v51
    v_cvt_pk_bf16_f32 v2, v96, v97
    v_mfma_f32_32x32x16_bf16 v[232:247], a[4:7], a[148:151], v[232:247]
    v_accvgpr_write_b32 a13, v5
    v_cvt_pk_bf16_f32 v4, v44, v45
    v_accvgpr_write_b32 a14, v4
    v_accvgpr_write_b32 a18, v6
    v_accvgpr_write_b32 a25, v9
    v_accvgpr_write_b32 a32, v2
    v_mfma_f32_32x32x16_bf16 v[112:127], v[224:227], v[128:131], v[64:79]
    ds_read_b128 a[160:163], v248 offset:4096
    v_cvt_pk_bf16_f32 v5, v46, v47
    v_accvgpr_write_b32 a15, v5
    v_cvt_pk_bf16_f32 v7, v86, v87
    v_accvgpr_write_b32 a19, v7
    v_cvt_pk_bf16_f32 v8, v52, v53
    v_mfma_f32_32x32x16_bf16 v[112:127], v[228:231], v[132:135], v[112:127]
    s_waitcnt lgkmcnt(1)
    ds_read_b128 a[164:167], v249 offset:4096
    v_cvt_pk_bf16_f32 v6, v88, v89
    v_accvgpr_write_b32 a26, v8
    v_cvt_pk_bf16_f32 v3, v98, v99
    v_cvt_pk_bf16_f32 v4, v16, v17
    v_mfma_f32_32x32x16_bf16 v[232:247], a[8:11], a[152:155], v[232:247]
    v_accvgpr_write_b32 a20, v6
    v_cvt_pk_bf16_f32 v7, v90, v91
    v_accvgpr_write_b32 a21, v7
    v_cvt_pk_bf16_f32 v9, v54, v55
    v_accvgpr_write_b32 a27, v9
    v_accvgpr_write_b32 a33, v3
    v_mfma_f32_32x32x16_bf16 v[232:247], a[12:15], a[156:159], v[232:247]
    v_cvt_pk_bf16_f32 v6, v92, v93
    v_accvgpr_write_b32 a22, v6
    v_cvt_pk_bf16_f32 v8, v56, v57
    v_accvgpr_write_b32 a28, v8
    v_cvt_pk_bf16_f32 v2, v100, v101
    v_accvgpr_write_b32 a40, v4
    v_mfma_f32_32x32x16_bf16 v[32:47], v[224:227], v[136:139], v[64:79]
    ds_read_b128 a[168:171], v250 offset:4096
    v_cvt_pk_bf16_f32 v7, v94, v95
    v_accvgpr_write_b32 a23, v7
    v_cvt_pk_bf16_f32 v9, v58, v59
    v_accvgpr_write_b32 a34, v2
    v_cvt_pk_bf16_f32 v5, v18, v19
    v_mfma_f32_32x32x16_bf16 v[32:47], v[228:231], v[140:143], v[32:47]
    s_waitcnt lgkmcnt(1)
    ds_read_b128 a[172:175], v251 offset:4096
    v_accvgpr_write_b32 a29, v9
    v_cvt_pk_bf16_f32 v8, v60, v61
    v_cvt_pk_bf16_f32 v3, v102, v103
    v_cvt_pk_bf16_f32 v6, v112, v113
    v_mfma_f32_32x32x16_bf16 v[232:247], a[16:19], a[160:163], v[232:247]
    v_accvgpr_write_b32 a30, v8
    v_cvt_pk_bf16_f32 v9, v62, v63
    v_accvgpr_write_b32 a31, v9
    v_accvgpr_write_b32 a35, v3
    v_cvt_pk_bf16_f32 v2, v104, v105
    v_accvgpr_write_b32 a41, v5
    v_mfma_f32_32x32x16_bf16 v[232:247], a[20:23], a[164:167], v[232:247]
    v_accvgpr_write_b32 a36, v2
    v_cvt_pk_bf16_f32 v3, v106, v107
    v_accvgpr_write_b32 a37, v3
    v_cvt_pk_bf16_f32 v2, v108, v109
    v_cvt_pk_bf16_f32 v4, v20, v21
    v_accvgpr_write_b32 a42, v4
    v_mfma_f32_32x32x16_bf16 v[128:143], v[224:227], v[144:147], v[64:79]
    ds_read_b128 a[144:147], v248 offset:8192
    v_accvgpr_write_b32 a38, v2
    v_cvt_pk_bf16_f32 v3, v110, v111
    v_accvgpr_write_b32 a39, v3
    v_cvt_pk_bf16_f32 v5, v22, v23
    v_accvgpr_write_b32 a43, v5
    v_mfma_f32_32x32x16_bf16 v[128:143], v[228:231], v[148:151], v[128:143]
    s_waitcnt lgkmcnt(1)
    ds_read_b128 a[148:151], v249 offset:8192
    v_cvt_pk_bf16_f32 v4, v24, v25
    v_accvgpr_write_b32 a44, v4
    v_cvt_pk_bf16_f32 v5, v26, v27
    v_cvt_pk_bf16_f32 v8, v32, v33
    v_mfma_f32_32x32x16_bf16 v[232:247], a[24:27], a[168:171], v[232:247]
    v_accvgpr_write_b32 a45, v5
    v_cvt_pk_bf16_f32 v4, v28, v29
    v_accvgpr_write_b32 a46, v4
    v_cvt_pk_bf16_f32 v5, v30, v31
    v_accvgpr_write_b32 a47, v5
    v_accvgpr_write_b32 a48, v6
    v_mfma_f32_32x32x16_bf16 v[232:247], a[28:31], a[172:175], v[232:247]
    v_cvt_pk_bf16_f32 v7, v114, v115
    v_accvgpr_write_b32 a49, v7
    v_cvt_pk_bf16_f32 v6, v116, v117
    v_accvgpr_write_b32 a50, v6
    v_accvgpr_write_b32 a56, v8
    v_mfma_f32_32x32x16_bf16 v[48:63], v[224:227], v[152:155], v[64:79]
    ds_read_b128 a[152:155], v250 offset:8192
    v_cvt_pk_bf16_f32 v7, v118, v119
    v_accvgpr_write_b32 a51, v7
    v_cvt_pk_bf16_f32 v6, v120, v121
    v_cvt_pk_bf16_f32 v9, v34, v35
    v_mfma_f32_32x32x16_bf16 v[48:63], v[228:231], v[156:159], v[48:63]
    s_waitcnt lgkmcnt(1)
    ds_read_b128 a[156:159], v251 offset:8192
    v_accvgpr_write_b32 a52, v6
    v_cvt_pk_bf16_f32 v7, v122, v123
    v_accvgpr_write_b32 a53, v7
    v_cvt_pk_bf16_f32 v2, v128, v129
    v_mfma_f32_32x32x16_bf16 v[232:247], a[32:35], a[144:147], v[232:247]
    v_cvt_pk_bf16_f32 v6, v124, v125
    v_accvgpr_write_b32 a54, v6
    v_cvt_pk_bf16_f32 v7, v126, v127
    v_accvgpr_write_b32 a55, v7
    v_accvgpr_write_b32 a57, v9
    v_mfma_f32_32x32x16_bf16 v[232:247], a[36:39], a[148:151], v[232:247]
    v_cvt_pk_bf16_f32 v8, v36, v37
    v_accvgpr_write_b32 a58, v8
    v_cvt_pk_bf16_f32 v9, v38, v39
    v_accvgpr_write_b32 a59, v9
    v_accvgpr_write_b32 a64, v2
    v_mfma_f32_32x32x16_bf16 v[144:159], v[224:227], v[160:163], v[64:79]
    ds_read_b128 a[160:163], v248 offset:12288
    v_cvt_pk_bf16_f32 v8, v40, v41
    v_accvgpr_write_b32 a60, v8
    v_cvt_pk_bf16_f32 v3, v130, v131
    v_accvgpr_write_b32 a65, v3
    v_mfma_f32_32x32x16_bf16 v[144:159], v[228:231], v[164:167], v[144:159]
    s_waitcnt lgkmcnt(1)
    ds_read_b128 a[164:167], v249 offset:12288
    v_cvt_pk_bf16_f32 v9, v42, v43
    v_accvgpr_write_b32 a61, v9
    v_cvt_pk_bf16_f32 v8, v44, v45
    v_cvt_pk_bf16_f32 v4, v48, v49
    v_mfma_f32_32x32x16_bf16 v[232:247], a[40:43], a[152:155], v[232:247]
    v_accvgpr_write_b32 a62, v8
    v_cvt_pk_bf16_f32 v9, v46, v47
    v_accvgpr_write_b32 a63, v9
    v_cvt_pk_bf16_f32 v2, v132, v133
    v_accvgpr_write_b32 a66, v2
    v_mfma_f32_32x32x16_bf16 v[232:247], a[44:47], a[156:159], v[232:247]
    v_cvt_pk_bf16_f32 v3, v134, v135
    v_accvgpr_write_b32 a67, v3
    v_cvt_pk_bf16_f32 v2, v136, v137
    v_accvgpr_write_b32 a72, v4
    v_cvt_pk_bf16_f32 v5, v50, v51
    v_mfma_f32_32x32x16_bf16 v[16:31], v[224:227], v[168:171], v[64:79]
    ds_read_b128 a[168:171], v250 offset:12288
    v_accvgpr_write_b32 a68, v2
    v_cvt_pk_bf16_f32 v3, v138, v139
    v_accvgpr_write_b32 a73, v5
    v_cvt_pk_bf16_f32 v6, v144, v145
    v_mfma_f32_32x32x16_bf16 v[16:31], v[228:231], v[172:175], v[16:31]
    s_waitcnt lgkmcnt(1)
    ds_read_b128 a[172:175], v251 offset:12288
    v_accvgpr_write_b32 a69, v3
    v_cvt_pk_bf16_f32 v2, v140, v141
    v_cvt_pk_bf16_f32 v4, v52, v53
    v_mfma_f32_32x32x16_bf16 v[232:247], a[48:51], a[160:163], v[232:247]
    v_accvgpr_write_b32 a70, v2
    v_cvt_pk_bf16_f32 v3, v142, v143
    v_accvgpr_write_b32 a71, v3
    v_accvgpr_write_b32 a74, v4
    v_accvgpr_write_b32 a80, v6
    v_mfma_f32_32x32x16_bf16 v[232:247], a[52:55], a[164:167], v[232:247]
    v_cvt_pk_bf16_f32 v5, v54, v55
    v_accvgpr_write_b32 a75, v5
    v_cvt_pk_bf16_f32 v4, v56, v57
    v_cvt_pk_bf16_f32 v7, v146, v147
    v_mfma_f32_32x32x16_bf16 v[160:175], v[224:227], v[176:179], v[64:79]
    ds_read_b128 a[144:147], v248 offset:16384
    v_accvgpr_write_b32 a76, v4
    v_cvt_pk_bf16_f32 v5, v58, v59
    v_accvgpr_write_b32 a81, v7
    v_cvt_pk_bf16_f32 v6, v148, v149
    v_mfma_f32_32x32x16_bf16 v[160:175], v[228:231], v[180:183], v[160:175]
    s_waitcnt lgkmcnt(1)
    ds_read_b128 a[148:151], v249 offset:16384
    v_accvgpr_write_b32 a77, v5
    v_cvt_pk_bf16_f32 v4, v60, v61
    v_accvgpr_write_b32 a82, v6
    v_cvt_pk_bf16_f32 v8, v16, v17
    v_mfma_f32_32x32x16_bf16 v[232:247], a[56:59], a[168:171], v[232:247]
    v_accvgpr_write_b32 a78, v4
    v_cvt_pk_bf16_f32 v5, v62, v63
    v_accvgpr_write_b32 a79, v5
    v_cvt_pk_bf16_f32 v7, v150, v151
    v_accvgpr_write_b32 a88, v8
    v_mfma_f32_32x32x16_bf16 v[232:247], a[60:63], a[172:175], v[232:247]
    v_accvgpr_write_b32 a83, v7
    v_cvt_pk_bf16_f32 v6, v152, v153
    v_accvgpr_write_b32 a84, v6
    v_cvt_pk_bf16_f32 v9, v18, v19
    v_mfma_f32_32x32x16_bf16 v[32:47], v[224:227], v[184:187], v[64:79]
    ds_read_b128 a[152:155], v250 offset:16384
    v_cvt_pk_bf16_f32 v7, v154, v155
    v_accvgpr_write_b32 a85, v7
    v_accvgpr_write_b32 a89, v9
    v_cvt_pk_bf16_f32 v2, v160, v161
    v_mfma_f32_32x32x16_bf16 v[32:47], v[228:231], v[188:191], v[32:47]
    s_waitcnt lgkmcnt(1)
    ds_read_b128 a[156:159], v251 offset:16384
    v_cvt_pk_bf16_f32 v6, v156, v157
    v_cvt_pk_bf16_f32 v8, v20, v21
    v_accvgpr_write_b32 a90, v8
    v_mfma_f32_32x32x16_bf16 v[232:247], a[64:67], a[144:147], v[232:247]
    v_accvgpr_write_b32 a86, v6
    v_cvt_pk_bf16_f32 v7, v158, v159
    v_accvgpr_write_b32 a87, v7
    v_cvt_pk_bf16_f32 v9, v22, v23
    v_accvgpr_write_b32 a96, v2
    v_mfma_f32_32x32x16_bf16 v[232:247], a[68:71], a[148:151], v[232:247]
    v_accvgpr_write_b32 a91, v9
    v_cvt_pk_bf16_f32 v8, v24, v25
    v_accvgpr_write_b32 a92, v8
    v_cvt_pk_bf16_f32 v3, v162, v163
    v_mfma_f32_32x32x16_bf16 v[176:191], v[224:227], v[192:195], v[64:79]
    ds_read_b128 a[160:163], v248 offset:20480
    v_cvt_pk_bf16_f32 v9, v26, v27
    v_accvgpr_write_b32 a93, v9
    v_accvgpr_write_b32 a97, v3
    v_cvt_pk_bf16_f32 v2, v164, v165
    v_mfma_f32_32x32x16_bf16 v[176:191], v[228:231], v[196:199], v[176:191]
    s_waitcnt lgkmcnt(1)
    ds_read_b128 a[164:167], v249 offset:20480
    v_cvt_pk_bf16_f32 v8, v28, v29
    v_accvgpr_write_b32 a98, v2
    v_cvt_pk_bf16_f32 v4, v32, v33
    v_mfma_f32_32x32x16_bf16 v[232:247], a[72:75], a[152:155], v[232:247]
    v_accvgpr_write_b32 a94, v8
    v_cvt_pk_bf16_f32 v9, v30, v31
    v_accvgpr_write_b32 a95, v9
    v_cvt_pk_bf16_f32 v3, v166, v167
    v_accvgpr_write_b32 a104, v4
    v_mfma_f32_32x32x16_bf16 v[232:247], a[76:79], a[156:159], v[232:247]
    v_accvgpr_write_b32 a99, v3
    v_cvt_pk_bf16_f32 v2, v168, v169
    v_accvgpr_write_b32 a100, v2
    v_cvt_pk_bf16_f32 v5, v34, v35
    v_mfma_f32_32x32x16_bf16 v[48:63], v[224:227], v[200:203], v[64:79]
    ds_read_b128 a[168:171], v250 offset:20480
    v_cvt_pk_bf16_f32 v3, v170, v171
    v_accvgpr_write_b32 a101, v3
    v_accvgpr_write_b32 a105, v5
    v_cvt_pk_bf16_f32 v4, v36, v37
    v_mfma_f32_32x32x16_bf16 v[48:63], v[228:231], v[204:207], v[48:63]
    s_waitcnt lgkmcnt(1)
    ds_read_b128 a[172:175], v251 offset:20480
    v_cvt_pk_bf16_f32 v2, v172, v173
    v_accvgpr_write_b32 a106, v4
    v_cvt_pk_bf16_f32 v6, v176, v177
    v_mfma_f32_32x32x16_bf16 v[232:247], a[80:83], a[160:163], v[232:247]
    v_accvgpr_write_b32 a102, v2
    v_cvt_pk_bf16_f32 v3, v174, v175
    v_accvgpr_write_b32 a103, v3
    v_cvt_pk_bf16_f32 v5, v38, v39
    v_accvgpr_write_b32 a112, v6
    v_mfma_f32_32x32x16_bf16 v[232:247], a[84:87], a[164:167], v[232:247]
    v_accvgpr_write_b32 a107, v5
    v_cvt_pk_bf16_f32 v4, v40, v41
    v_accvgpr_write_b32 a108, v4
    v_cvt_pk_bf16_f32 v7, v178, v179
    v_accvgpr_write_b32 a113, v7
    v_mfma_f32_32x32x16_bf16 v[192:207], v[224:227], v[208:211], v[64:79]
    ds_read_b128 a[144:147], v248 offset:24576
    v_cvt_pk_bf16_f32 v5, v42, v43
    v_accvgpr_write_b32 a109, v5
    v_cvt_pk_bf16_f32 v6, v180, v181
    v_cvt_pk_bf16_f32 v8, v48, v49
    v_mfma_f32_32x32x16_bf16 v[192:207], v[228:231], v[212:215], v[192:207]
    s_waitcnt lgkmcnt(1)
    ds_read_b128 a[148:151], v249 offset:24576
    v_cvt_pk_bf16_f32 v4, v44, v45
    v_accvgpr_write_b32 a110, v4
    v_accvgpr_write_b32 a114, v6
    v_mfma_f32_32x32x16_bf16 v[232:247], a[88:91], a[168:171], v[232:247]
    ds_read_b128 a[152:155], v250 offset:24576
    v_cvt_pk_bf16_f32 v5, v46, v47
    v_accvgpr_write_b32 a111, v5
    v_cvt_pk_bf16_f32 v7, v182, v183
    v_accvgpr_write_b32 a120, v8
    v_mfma_f32_32x32x16_bf16 v[232:247], a[92:95], a[172:175], v[232:247]
    ds_read_b128 a[156:159], v251 offset:24576
    v_accvgpr_write_b32 a115, v7
    v_cvt_pk_bf16_f32 v6, v184, v185
    v_accvgpr_write_b32 a116, v6
    v_cvt_pk_bf16_f32 v9, v50, v51
    v_mfma_f32_32x32x16_bf16 v[16:31], v[224:227], v[216:219], v[64:79]
    ds_read_b128 a[160:163], v248 offset:28672
    v_cvt_pk_bf16_f32 v7, v186, v187
    v_accvgpr_write_b32 a117, v7
    v_accvgpr_write_b32 a121, v9
    v_cvt_pk_bf16_f32 v8, v52, v53
    v_cvt_pk_bf16_f32 v2, v192, v193
    v_mfma_f32_32x32x16_bf16 v[16:31], v[228:231], v[220:223], v[16:31]
    s_waitcnt lgkmcnt(3)
    ds_read_b128 a[164:167], v249 offset:28672
    v_cvt_pk_bf16_f32 v6, v188, v189
    v_accvgpr_write_b32 a118, v6
    v_accvgpr_write_b32 a122, v8
    v_mfma_f32_32x32x16_bf16 v[232:247], a[96:99], a[144:147], v[232:247]
    ds_read_b128 a[168:171], v250 offset:28672
    v_cvt_pk_bf16_f32 v7, v190, v191
    v_accvgpr_write_b32 a119, v7
    v_cvt_pk_bf16_f32 v9, v54, v55
    v_accvgpr_write_b32 a128, v2
    v_cvt_pk_bf16_f32 v3, v194, v195
    v_mfma_f32_32x32x16_bf16 v[232:247], a[100:103], a[148:151], v[232:247]
    s_waitcnt lgkmcnt(3)
    ds_read_b128 a[172:175], v251 offset:28672
    v_accvgpr_write_b32 a123, v9
    v_cvt_pk_bf16_f32 v8, v56, v57
    v_accvgpr_write_b32 a129, v3
    v_mfma_f32_32x32x16_bf16 v[232:247], a[104:107], a[152:155], v[232:247]
    ds_read_b128 a[144:147], v248 offset:32768
    v_accvgpr_write_b32 a124, v8
    v_cvt_pk_bf16_f32 v9, v58, v59
    v_accvgpr_write_b32 a125, v9
    v_cvt_pk_bf16_f32 v2, v196, v197
    v_accvgpr_write_b32 a130, v2
    v_mfma_f32_32x32x16_bf16 v[232:247], a[108:111], a[156:159], v[232:247]
    s_waitcnt lgkmcnt(3)
    ds_read_b128 a[148:151], v249 offset:32768
    v_cvt_pk_bf16_f32 v8, v60, v61
    v_accvgpr_write_b32 a126, v8
    v_cvt_pk_bf16_f32 v3, v198, v199
    v_cvt_pk_bf16_f32 v4, v16, v17
    v_mfma_f32_32x32x16_bf16 v[232:247], a[112:115], a[160:163], v[232:247]
    ds_read_b128 a[152:155], v250 offset:32768
    v_cvt_pk_bf16_f32 v9, v62, v63
    v_accvgpr_write_b32 a127, v9
    v_accvgpr_write_b32 a131, v3
    v_cvt_pk_bf16_f32 v2, v200, v201
    v_accvgpr_write_b32 a136, v4
    v_mfma_f32_32x32x16_bf16 v[232:247], a[116:119], a[164:167], v[232:247]
    s_waitcnt lgkmcnt(3)
    ds_read_b128 a[156:159], v251 offset:32768
    v_accvgpr_write_b32 a132, v2
    v_cvt_pk_bf16_f32 v3, v202, v203
    v_accvgpr_write_b32 a133, v3
    v_cvt_pk_bf16_f32 v5, v18, v19
    v_mfma_f32_32x32x16_bf16 v[232:247], a[120:123], a[168:171], v[232:247]
    v_cvt_pk_bf16_f32 v2, v204, v205
    v_accvgpr_write_b32 a134, v2
    v_cvt_pk_bf16_f32 v3, v206, v207
    v_accvgpr_write_b32 a135, v3
    v_accvgpr_write_b32 a137, v5
    v_cvt_pk_bf16_f32 v4, v20, v21
    v_mfma_f32_32x32x16_bf16 v[232:247], a[124:127], a[172:175], v[232:247]
    s_waitcnt lgkmcnt(2)
    v_accvgpr_write_b32 a138, v4
    v_cvt_pk_bf16_f32 v5, v22, v23
    v_accvgpr_write_b32 a139, v5
    v_cvt_pk_bf16_f32 v4, v24, v25
    v_accvgpr_write_b32 a140, v4
    v_mfma_f32_32x32x16_bf16 v[232:247], a[128:131], a[144:147], v[232:247]
    v_cvt_pk_bf16_f32 v5, v26, v27
    v_accvgpr_write_b32 a141, v5
    v_cvt_pk_bf16_f32 v4, v28, v29
    v_accvgpr_write_b32 a142, v4
    v_cvt_pk_bf16_f32 v5, v30, v31
    v_accvgpr_write_b32 a143, v5
    v_mfma_f32_32x32x16_bf16 v[232:247], a[132:135], a[148:151], v[232:247]
    s_waitcnt lgkmcnt(0)
    v_mfma_f32_32x32x16_bf16 v[232:247], a[136:139], a[152:155], v[232:247]
    v_mfma_f32_32x32x16_bf16 v[232:247], a[140:143], a[156:159], v[232:247]
    s_cmp_lt_u32 s66, 2
    s_cbranch_scc0 L_noz2b
    v_add_u32 v64, 36864, v248
    v_add_u32 v65, 36864, v249
    v_add_u32 v66, 36864, v250
    v_add_u32 v67, 36864, v251
    s_waitcnt vmcnt(20)
    s_barrier
    ds_read_b128 a[144:147], v64 offset:0
    ds_read_b128 a[148:151], v65 offset:0
    ds_read_b128 a[152:155], v66 offset:0
    ds_read_b128 a[156:159], v67 offset:0
    ds_read_b128 a[160:163], v64 offset:4096
    ds_read_b128 a[164:167], v65 offset:4096
    s_waitcnt lgkmcnt(5)
    v_mfma_f32_32x32x16_bf16 v[128:143], a[0:3], a[144:147], 0
    ds_read_b128 a[168:171], v66 offset:4096
    s_waitcnt lgkmcnt(5)
    v_mfma_f32_32x32x16_bf16 v[128:143], a[4:7], a[148:151], v[128:143]
    ds_read_b128 a[172:175], v67 offset:4096
    s_waitcnt lgkmcnt(5)
    v_mfma_f32_32x32x16_bf16 v[128:143], a[8:11], a[152:155], v[128:143]
    ds_read_b128 a[144:147], v64 offset:8192
    s_waitcnt lgkmcnt(5)
    v_mfma_f32_32x32x16_bf16 v[128:143], a[12:15], a[156:159], v[128:143]
    ds_read_b128 a[148:151], v65 offset:8192
    s_waitcnt lgkmcnt(5)
    v_mfma_f32_32x32x16_bf16 v[128:143], a[16:19], a[160:163], v[128:143]
    ds_read_b128 a[152:155], v66 offset:8192
    s_waitcnt lgkmcnt(5)
    v_mfma_f32_32x32x16_bf16 v[128:143], a[20:23], a[164:167], v[128:143]
    ds_read_b128 a[156:159], v67 offset:8192
    s_waitcnt lgkmcnt(5)
    v_mfma_f32_32x32x16_bf16 v[128:143], a[24:27], a[168:171], v[128:143]
    ds_read_b128 a[160:163], v64 offset:12288
    s_waitcnt lgkmcnt(5)
    v_mfma_f32_32x32x16_bf16 v[128:143], a[28:31], a[172:175], v[128:143]
    ds_read_b128 a[164:167], v65 offset:12288
    s_waitcnt lgkmcnt(5)
    v_mfma_f32_32x32x16_bf16 v[128:143], a[32:35], a[144:147], v[128:143]
    ds_read_b128 a[168:171], v66 offset:12288
    s_waitcnt lgkmcnt(5)
    v_mfma_f32_32x32x16_bf16 v[128:143], a[36:39], a[148:151], v[128:143]
    ds_read_b128 a[172:175], v67 offset:12288
    s_waitcnt lgkmcnt(5)
    v_mfma_f32_32x32x16_bf16 v[128:143], a[40:43], a[152:155], v[128:143]
    ds_read_b128 a[144:147], v64 offset:16384
    s_waitcnt lgkmcnt(5)
    v_mfma_f32_32x32x16_bf16 v[128:143], a[44:47], a[156:159], v[128:143]
    ds_read_b128 a[148:151], v65 offset:16384
    s_waitcnt lgkmcnt(5)
    v_mfma_f32_32x32x16_bf16 v[128:143], a[48:51], a[160:163], v[128:143]
    ds_read_b128 a[152:155], v66 offset:16384
    s_waitcnt lgkmcnt(5)
    v_mfma_f32_32x32x16_bf16 v[128:143], a[52:55], a[164:167], v[128:143]
    ds_read_b128 a[156:159], v67 offset:16384
    s_waitcnt lgkmcnt(5)
    v_mfma_f32_32x32x16_bf16 v[128:143], a[56:59], a[168:171], v[128:143]
    ds_read_b128 a[160:163], v64 offset:20480
    s_waitcnt lgkmcnt(5)
    v_mfma_f32_32x32x16_bf16 v[128:143], a[60:63], a[172:175], v[128:143]
    ds_read_b128 a[164:167], v65 offset:20480
    s_waitcnt lgkmcnt(5)
    v_mfma_f32_32x32x16_bf16 v[128:143], a[64:67], a[144:147], v[128:143]
    ds_read_b128 a[168:171], v66 offset:20480
    s_waitcnt lgkmcnt(5)
    v_mfma_f32_32x32x16_bf16 v[128:143], a[68:71], a[148:151], v[128:143]
    ds_read_b128 a[172:175], v67 offset:20480
    s_waitcnt lgkmcnt(5)
    v_mfma_f32_32x32x16_bf16 v[128:143], a[72:75], a[152:155], v[128:143]
    ds_read_b128 a[144:147], v64 offset:24576
    s_waitcnt lgkmcnt(5)
    v_mfma_f32_32x32x16_bf16 v[128:143], a[76:79], a[156:159], v[128:143]
    ds_read_b128 a[148:151], v65 offset:24576
    s_waitcnt lgkmcnt(5)
    v_mfma_f32_32x32x16_bf16 v[128:143], a[80:83], a[160:163], v[128:143]
    ds_read_b128 a[152:155], v66 offset:24576
    s_waitcnt lgkmcnt(5)
    v_mfma_f32_32x32x16_bf16 v[128:143], a[84:87], a[164:167], v[128:143]
    ds_read_b128 a[156:159], v67 offset:24576
    s_waitcnt lgkmcnt(5)
    v_mfma_f32_32x32x16_bf16 v[128:143], a[88:91], a[168:171], v[128:143]
    ds_read_b128 a[160:163], v64 offset:28672
    s_waitcnt lgkmcnt(5)
    v_mfma_f32_32x32x16_bf16 v[128:143], a[92:95], a[172:175], v[128:143]
    ds_read_b128 a[164:167], v65 offset:28672
    s_waitcnt lgkmcnt(5)
    v_mfma_f32_32x32x16_bf16 v[128:143], a[96:99], a[144:147], v[128:143]
    ds_read_b128 a[168:171], v66 offset:28672
    s_waitcnt lgkmcnt(5)
    v_mfma_f32_32x32x16_bf16 v[128:143], a[100:103], a[148:151], v[128:143]
    ds_read_b128 a[172:175], v67 offset:28672
    s_waitcnt lgkmcnt(5)
    v_mfma_f32_32x32x16_bf16 v[128:143], a[104:107], a[152:155], v[128:143]
    ds_read_b128 a[144:147], v64 offset:32768
    s_waitcnt lgkmcnt(5)
    v_mfma_f32_32x32x16_bf16 v[128:143], a[108:111], a[156:159], v[128:143]
    ds_read_b128 a[148:151], v65 offset:32768
    s_waitcnt lgkmcnt(5)
    v_mfma_f32_32x32x16_bf16 v[128:143], a[112:115], a[160:163], v[128:143]
    ds_read_b128 a[152:155], v66 offset:32768
    s_waitcnt lgkmcnt(5)
    v_mfma_f32_32x32x16_bf16 v[128:143], a[116:119], a[164:167], v[128:143]
    ds_read_b128 a[156:159], v67 offset:32768
    s_waitcnt lgkmcnt(5)
    v_mfma_f32_32x32x16_bf16 v[128:143], a[120:123], a[168:171], v[128:143]
    s_waitcnt lgkmcnt(4)
    v_mfma_f32_32x32x16_bf16 v[128:143], a[124:127], a[172:175], v[128:143]
    s_waitcnt lgkmcnt(3)
    v_mfma_f32_32x32x16_bf16 v[128:143], a[128:131], a[144:147], v[128:143]
    s_waitcnt lgkmcnt(2)
    v_mfma_f32_32x32x16_bf16 v[128:143], a[132:135], a[148:151], v[128:143]
    s_waitcnt lgkmcnt(1)
    v_mfma_f32_32x32x16_bf16 v[128:143], a[136:139], a[152:155], v[128:143]
    s_waitcnt lgkmcnt(0)
    v_mfma_f32_32x32x16_bf16 v[128:143], a[140:143], a[156:159], v[128:143]
L_noz2b:
    s_cmp_lt_u32 s66, 2
    s_cselect_b32 s95, s95, 0x4000
    v_lshrrev_b32 v16, 5, v0
    v_lshlrev_b32 v16, 10, v16
    v_bfe_u32 v17, v0, 2, 2
    v_lshlrev_b32 v17, 7, v17
    v_add_u32 v16, v16, v17
    v_bfe_u32 v17, v0, 3, 1
    v_lshlrev_b32 v17, 6, v17
    v_add_u32 v16, v16, v17
    v_bfe_u32 v17, v0, 4, 1
    v_lshlrev_b32 v17, 5, v17
    v_add_u32 v16, v16, v17
    v_and_b32 v17, 3, v0
    v_lshlrev_b32 v17, 3, v17
    v_add_u32 v2, v16, v17
    v_add_u32 v3, 36864, v2
    v_add_u32 v4, 73728, v2
    v_add_u32 v5, 110592, v2
    v_xor_b32 v6, 64, v2
    v_xor_b32 v7, 64, v3
    v_xor_b32 v8, 64, v4
    v_xor_b32 v9, 64, v5
    s_mov_b32 s12, s36
    s_and_b32 s13, s37, 0xffff
    s_mov_b32 s14, 256
    s_mov_b32 s15, 0x00020000
    s_waitcnt vmcnt(11)
    s_barrier
    ds_read_b64_tr_b16 a[144:145], v2 offset:0
    ds_read_b64_tr_b16 a[146:147], v2 offset:512
    ds_read_b64_tr_b16 a[148:149], v2 offset:2048
    ds_read_b64_tr_b16 a[150:151], v2 offset:2560
    ds_read_b64_tr_b16 a[152:153], v2 offset:4096
    ds_read_b64_tr_b16 a[154:155], v2 offset:4608
    ds_read_b64_tr_b16 a[156:157], v2 offset:6144
    ds_read_b64_tr_b16 a[158:159], v2 offset:6656
    ds_read_b64_tr_b16 a[160:161], v2 offset:8192
    ds_read_b64_tr_b16 a[162:163], v2 offset:8704
    ds_read_b64_tr_b16 a[164:165], v2 offset:10240
    ds_read_b64_tr_b16 a[166:167], v2 offset:10752
    ds_read_b64_tr_b16 a[168:169], v2 offset:12288
    ds_read_b64_tr_b16 a[170:171], v2 offset:12800
    s_waitcnt lgkmcnt(10)
    v_mfma_f32_32x32x16_bf16 v[16:31], a[144:147], a[0:3], 0
    s_add_u32 m0, s68, 73728
    s_add_u32 s3, s69, 0
    ds_read_b64_tr_b16 a[172:173], v2 offset:14336
    ds_read_b64_tr_b16 a[174:175], v2 offset:14848
    buffer_load_dwordx4 v10, s[48:51], s3 offen offset:0 lds
    v_mfma_f32_32x32x16_bf16 v[16:31], a[148:151], a[4:7], v[16:31]
    s_waitcnt lgkmcnt(8)
    ds_read_b64_tr_b16 a[144:145], v2 offset:16384
    ds_read_b64_tr_b16 a[146:147], v2 offset:16896
    v_mfma_f32_32x32x16_bf16 v[16:31], a[152:155], a[8:11], v[16:31]
    ds_read_b64_tr_b16 a[148:149], v2 offset:18432
    ds_read_b64_tr_b16 a[150:151], v2 offset:18944
    buffer_load_dwordx4 v11, s[48:51], s3 offen offset:1024 lds
    v_mov_b32 v231, 1
    v_mfma_f32_32x32x16_bf16 v[16:31], a[156:159], a[12:15], v[16:31]
    s_waitcnt lgkmcnt(8)
    ds_read_b64_tr_b16 a[152:153], v2 offset:20480
    ds_read_b64_tr_b16 a[154:155], v2 offset:20992
    v_mfma_f32_32x32x16_bf16 v[16:31], a[160:163], a[16:19], v[16:31]
    ds_read_b64_tr_b16 a[156:157], v2 offset:22528
    ds_read_b64_tr_b16 a[158:159], v2 offset:23040
    buffer_load_dwordx4 v12, s[48:51], s3 offen offset:2048 lds
    v_mfma_f32_32x32x16_bf16 v[16:31], a[164:167], a[20:23], v[16:31]
    s_waitcnt lgkmcnt(8)
    ds_read_b64_tr_b16 a[160:161], v2 offset:24576
    ds_read_b64_tr_b16 a[162:163], v2 offset:25088
    v_mfma_f32_32x32x16_bf16 v[16:31], a[168:171], a[24:27], v[16:31]
    ds_read_b64_tr_b16 a[164:165], v2 offset:26624
    ds_read_b64_tr_b16 a[166:167], v2 offset:27136
    buffer_load_dwordx4 v13, s[48:51], s3 offen offset:3072 lds
    v_mfma_f32_32x32x16_bf16 v[16:31], a[172:175], a[28:31], v[16:31]
    s_waitcnt lgkmcnt(8)
    ds_read_b64_tr_b16 a[168:169], v2 offset:28672
    ds_read_b64_tr_b16 a[170:171], v2 offset:29184
    v_mfma_f32_32x32x16_bf16 v[16:31], a[144:147], a[32:35], v[16:31]
    s_add_u32 m0, s68, 77824
    s_add_u32 s3, s69, 294912
    ds_read_b64_tr_b16 a[172:173], v2 offset:30720
    ds_read_b64_tr_b16 a[174:175], v2 offset:31232
    buffer_load_dwordx4 v10, s[48:51], s3 offen offset:0 lds
    v_mfma_f32_32x32x16_bf16 v[16:31], a[148:151], a[36:39], v[16:31]
    s_waitcnt lgkmcnt(8)
    ds_read_b64_tr_b16 a[144:145], v2 offset:32768
    ds_read_b64_tr_b16 a[146:147], v2 offset:33280
    v_mfma_f32_32x32x16_bf16 v[16:31], a[152:155], a[40:43], v[16:31]
    ds_read_b64_tr_b16 a[148:149], v2 offset:34816
    ds_read_b64_tr_b16 a[150:151], v2 offset:35328
    buffer_load_dwordx4 v11, s[48:51], s3 offen offset:1024 lds
    v_mfma_f32_32x32x16_bf16 v[16:31], a[156:159], a[44:47], v[16:31]
    s_waitcnt lgkmcnt(8)
    ds_read_b64_tr_b16 a[152:153], v6 offset:0
    ds_read_b64_tr_b16 a[154:155], v6 offset:512
    v_mfma_f32_32x32x16_bf16 v[16:31], a[160:163], a[48:51], v[16:31]
    ds_read_b64_tr_b16 a[156:157], v6 offset:2048
    ds_read_b64_tr_b16 a[158:159], v6 offset:2560
    buffer_load_dwordx4 v12, s[48:51], s3 offen offset:2048 lds
    v_lshrrev_b32 v112, 5, v0
    v_lshlrev_b32 v112, 4, v112
    v_mfma_f32_32x32x16_bf16 v[16:31], a[164:167], a[52:55], v[16:31]
    s_waitcnt lgkmcnt(8)
    s_lshl_b32 s96, s64, 12
    s_add_u32 s96, s96, 147456
    ds_read_b64_tr_b16 a[160:161], v6 offset:4096
    ds_read_b64_tr_b16 a[162:163], v6 offset:4608
    v_add_u32 v112, s96, v112
    v_mfma_f32_32x32x16_bf16 v[16:31], a[168:171], a[56:59], v[16:31]
    ds_read_b64_tr_b16 a[164:165], v6 offset:6144
    ds_read_b64_tr_b16 a[166:167], v6 offset:6656
    ds_read_b128 v[48:51], v112 offset:0
    ds_read_b128 v[52:55], v112 offset:32
    ds_read_b128 v[56:59], v112 offset:64
    ds_read_b128 v[60:63], v112 offset:96
    buffer_load_dwordx4 v13, s[48:51], s3 offen offset:3072 lds
    v_mfma_f32_32x32x16_bf16 v[16:31], a[172:175], a[60:63], v[16:31]
    s_waitcnt lgkmcnt(12)
    s_waitcnt lgkmcnt(0)
    s_cmp_lt_u32 s94, 9
    s_cselect_b32 s34, 1.0, -1.0
    ds_read_b64_tr_b16 a[168:169], v6 offset:8192
    ds_read_b64_tr_b16 a[170:171], v6 offset:8704
    v_mov_b32 v72, s34
    v_mfma_f32_32x32x16_bf16 v[16:31], a[144:147], a[64:67], v[16:31]
    s_cmp_eq_u32 s94, 9
    s_cselect_b32 s34, 0, 99
    s_add_u32 m0, s68, 81920
    s_add_u32 s3, s69, 589824
    ds_read_b64_tr_b16 a[172:173], v6 offset:10240
    ds_read_b64_tr_b16 a[174:175], v6 offset:10752
    buffer_load_dwordx4 v10, s[48:51], s3 offen offset:0 lds
    v_and_b32 v73, 31, v0
    v_cmp_eq_u32 vcc, s34, v73
    v_mov_b32 v74, 1.0
    v_nop
    v_cndmask_b32 v72, v72, v74, vcc
    v_mfma_f32_32x32x16_bf16 v[16:31], a[148:151], a[68:71], v[16:31]
    s_or_b32 s34, s65, s64
    s_cmp_eq_u32 s34, 0
    s_cselect_b32 s34, 32, 0
    ds_read_b64_tr_b16 a[144:145], v6 offset:12288
    ds_read_b64_tr_b16 a[146:147], v6 offset:12800
    v_mfma_f32_32x32x16_bf16 v[32:47], a[152:155], a[0:3], 0
    s_add_u32 m0, s68, 110592
    s_add_u32 s3, s69, 2654208
    ds_read_b64_tr_b16 a[148:149], v6 offset:14336
    ds_read_b64_tr_b16 a[150:151], v6 offset:14848
    buffer_load_dwordx4 v10, s[48:51], s3 offen offset:0 lds
    v_cmp_gt_u32 vcc, s34, v0
    v_mov_b32 v64, 0
    v_mov_b32 v65, 1.0
    v_cndmask_b32 v73, v72, v65, vcc
    v_cndmask_b32 v74, v65, v64, vcc
    v_cndmask_b32 v75, v72, v64, vcc
    v_mfma_f32_32x32x16_bf16 v[32:47], a[156:159], a[4:7], v[32:47]
    ds_read_b64_tr_b16 a[152:153], v6 offset:16384
    ds_read_b64_tr_b16 a[154:155], v6 offset:16896
    v_mul_f32 v232, v232, v48
    v_mul_f32 v233, v233, v49
    v_mfma_f32_32x32x16_bf16 v[32:47], a[160:163], a[8:11], v[32:47]
    ds_read_b64_tr_b16 a[156:157], v6 offset:18432
    ds_read_b64_tr_b16 a[158:159], v6 offset:18944
    buffer_load_dwordx4 v11, s[48:51], s3 offen offset:1024 lds
    v_mul_f32 v234, v234, v50
    v_mul_f32 v235, v235, v51
    v_mul_f32 v236, v236, v52
    v_mul_f32 v237, v237, v53
    v_mul_f32 v238, v238, v54
    v_mfma_f32_32x32x16_bf16 v[32:47], a[164:167], a[12:15], v[32:47]
    s_waitcnt lgkmcnt(8)
    ds_read_b64_tr_b16 a[160:161], v6 offset:20480
    ds_read_b64_tr_b16 a[162:163], v6 offset:20992
    v_mul_f32 v239, v239, v55
    v_mul_f32 v240, v240, v56
    v_mul_f32 v241, v241, v57
    v_mfma_f32_32x32x16_bf16 v[32:47], a[168:171], a[16:19], v[32:47]
    ds_read_b64_tr_b16 a[164:165], v6 offset:22528
    ds_read_b64_tr_b16 a[166:167], v6 offset:23040
    buffer_load_dwordx4 v12, s[48:51], s3 offen offset:2048 lds
    v_mul_f32 v242, v242, v58
    v_mul_f32 v243, v243, v59
    v_mul_f32 v244, v244, v60
    v_mul_f32 v245, v245, v61
    v_mul_f32 v246, v246, v62
    v_mfma_f32_32x32x16_bf16 v[32:47], a[172:175], a[20:23], v[32:47]
    s_waitcnt lgkmcnt(8)
    ds_read_b64_tr_b16 a[168:169], v6 offset:24576
    ds_read_b64_tr_b16 a[170:171], v6 offset:25088
    v_mul_f32 v247, v247, v63
    v_add_f32 v76, v240, v244
    v_sub_f32 v77, v240, v244
    v_mfma_f32_32x32x16_bf16 v[32:47], a[144:147], a[24:27], v[32:47]
    ds_read_b64_tr_b16 a[172:173], v6 offset:26624
    ds_read_b64_tr_b16 a[174:175], v6 offset:27136
    buffer_load_dwordx4 v13, s[48:51], s3 offen offset:3072 lds
    v_mov_b32 v78, 0
    v_cmp_lt_f32 vcc, 0, v72
    v_nop
    v_nop
    v_cndmask_b32 v76, v78, v76, vcc
    v_cndmask_b32 v77, v77, v78, vcc
    v_mfma_f32_32x32x16_bf16 v[32:47], a[148:151], a[28:31], v[32:47]
    s_waitcnt lgkmcnt(8)
    ds_read_b64_tr_b16 a[144:145], v6 offset:28672
    ds_read_b64_tr_b16 a[146:147], v6 offset:29184
    v_mul_f32 v240, v240, v74
    v_fma_f32 v232, v244, v75, v232
    v_mfma_f32_32x32x16_bf16 v[32:47], a[152:155], a[32:35], v[32:47]
    s_add_u32 m0, s68, 114688
    s_add_u32 s3, s69, 2949120
    ds_read_b64_tr_b16 a[148:149], v6 offset:30720
    ds_read_b64_tr_b16 a[150:151], v6 offset:31232
    buffer_load_dwordx4 v10, s[48:51], s3 offen offset:0 lds
    v_fma_f32 v236, v236, v73, v240
    v_add_f32 v64, v232, v236
    v_sub_f32 v68, v232, v236
    v_fma_f32 v233, v245, v72, v233
    v_mfma_f32_32x32x16_bf16 v[32:47], a[156:159], a[36:39], v[32:47]
    s_waitcnt lgkmcnt(8)
    ds_read_b64_tr_b16 a[152:153], v6 offset:32768
    ds_read_b64_tr_b16 a[154:155], v6 offset:33280
    v_fma_f32 v237, v237, v72, v241
    v_add_f32 v65, v233, v237
    v_sub_f32 v69, v233, v237
    v_fma_f32 v234, v246, v72, v234
    v_mfma_f32_32x32x16_bf16 v[32:47], a[160:163], a[40:43], v[32:47]
    ds_read_b64_tr_b16 a[156:157], v6 offset:34816
    ds_read_b64_tr_b16 a[158:159], v6 offset:35328
    buffer_load_dwordx4 v11, s[48:51], s3 offen offset:1024 lds
    v_fma_f32 v238, v238, v72, v242
    v_add_f32 v66, v234, v238
    v_sub_f32 v70, v234, v238
    v_fma_f32 v235, v247, v72, v235
    v_mfma_f32_32x32x16_bf16 v[32:47], a[164:167], a[44:47], v[32:47]
    s_waitcnt vmcnt(17)
    s_barrier
    s_waitcnt lgkmcnt(8)
    ds_read_b64_tr_b16 a[160:161], v3 offset:0
    ds_read_b64_tr_b16 a[162:163], v3 offset:512
    v_fma_f32 v239, v239, v72, v243
    v_mfma_f32_32x32x16_bf16 v[32:47], a[168:171], a[48:51], v[32:47]
    ds_read_b64_tr_b16 a[164:165], v3 offset:2048
    ds_read_b64_tr_b16 a[166:167], v3 offset:2560
    buffer_load_dwordx4 v12, s[48:51], s3 offen offset:2048 lds
    v_add_f32 v67, v235, v239
    v_sub_f32 v71, v235, v239
    v_cvt_pk_bf16_f32 v48, v64, v65
    v_cvt_pk_bf16_f32 v49, v66, v67
    v_mfma_f32_32x32x16_bf16 v[32:47], a[172:175], a[52:55], v[32:47]
    s_waitcnt lgkmcnt(8)
    ds_read_b64_tr_b16 a[168:169], v3 offset:4096
    ds_read_b64_tr_b16 a[170:171], v3 offset:4608
    v_cvt_pk_bf16_f32 v50, v68, v69
    v_cvt_pk_bf16_f32 v51, v70, v71
    v_mfma_f32_32x32x16_bf16 v[32:47], a[144:147], a[56:59], v[32:47]
    ds_read_b64_tr_b16 a[172:173], v3 offset:6144
    ds_read_b64_tr_b16 a[174:175], v3 offset:6656
    buffer_load_dwordx4 v13, s[48:51], s3 offen offset:3072 lds
    v_nop
    v_nop
    v_permlane32_swap_b32 v48, v50
    v_permlane32_swap_b32 v49, v51
    v_lshrrev_b32 v52, 5, v0
    v_mfma_f32_32x32x16_bf16 v[32:47], a[148:151], a[60:63], v[32:47]
    s_waitcnt lgkmcnt(8)
    ds_read_b64_tr_b16 a[144:145], v3 offset:8192
    ds_read_b64_tr_b16 a[146:147], v3 offset:8704
    v_mul_u32_u24 v52, 626688, v52
    v_and_b32 v53, 31, v0
    v_lshlrev_b32 v53, 4, v53
    v_add_u32 v52, v52, v53
    v_mfma_f32_32x32x16_bf16 v[32:47], a[152:155], a[64:67], v[32:47]
    s_mul_i32 s34, s94, 34816
    s_lshl_b32 s35, s65, 2
    s_add_u32 s35, s35, s64
    s_add_u32 m0, s68, 118784
    s_add_u32 s3, s69, 3244032
    ds_read_b64_tr_b16 a[148:149], v3 offset:10240
    ds_read_b64_tr_b16 a[150:151], v3 offset:10752
    buffer_load_dwordx4 v10, s[48:51], s3 offen offset:0 lds
    v_mfma_f32_32x32x16_bf16 v[32:47], a[156:159], a[68:71], v[32:47]
    s_waitcnt lgkmcnt(8)
    s_lshl_b32 s35, s35, 9
    s_add_u32 s35, s35, s34
    s_add_u32 s35, s35, 41943040
    s_barrier
    ds_read_b64_tr_b16 a[152:153], v3 offset:12288
    ds_read_b64_tr_b16 a[154:155], v3 offset:12800
    v_mfma_f32_32x32x16_bf16 v[16:31], a[160:163], a[72:75], v[16:31]
    s_add_u32 m0, s68, 0
    s_add_u32 s3, s70, 0
    ds_read_b64_tr_b16 a[156:157], v3 offset:14336
    ds_read_b64_tr_b16 a[158:159], v3 offset:14848
    buffer_store_dwordx4 v[48:51], v52, s[56:59], s35 offen sc1
    buffer_load_dwordx4 v10, s[44:47], s3 offen offset:0 lds
    v_mfma_f32_32x32x16_bf16 v[16:31], a[164:167], a[76:79], v[16:31]
    s_waitcnt lgkmcnt(8)
    ds_read_b64_tr_b16 a[160:161], v3 offset:16384
    ds_read_b64_tr_b16 a[162:163], v3 offset:16896
    v_mov_b32 v78, v76
    v_nop
    v_nop
    v_permlane32_swap_b32 v78, v77
    v_mfma_f32_32x32x16_bf16 v[16:31], a[168:171], a[80:83], v[16:31]
    ds_read_b64_tr_b16 a[164:165], v3 offset:18432
    ds_read_b64_tr_b16 a[166:167], v3 offset:18944
    buffer_load_dwordx4 v11, s[44:47], s3 offen offset:1024 lds
    v_mov_b32 v57, 0
    v_mov_b32 v58, 0
    v_mov_b32 v59, 0
    v_cvt_pk_bf16_f32 v56, v78, v57
    v_mfma_f32_32x32x16_bf16 v[16:31], a[172:175], a[84:87], v[16:31]
    s_waitcnt lgkmcnt(8)
    s_or_b32 s35, s65, s64
    s_cmp_eq_u32 s35, 0
    s_cselect_b32 s96, 0, 0x40000000
    ds_read_b64_tr_b16 a[168:169], v3 offset:20480
    ds_read_b64_tr_b16 a[170:171], v3 offset:20992
    v_add_u32 v53, s96, v52
    v_mfma_f32_32x32x16_bf16 v[16:31], a[144:147], a[88:91], v[16:31]
    s_add_u32 s34, s34, 41975808
    ds_read_b64_tr_b16 a[172:173], v3 offset:22528
    ds_read_b64_tr_b16 a[174:175], v3 offset:23040
    buffer_store_dwordx4 v[56:59], v53, s[56:59], s34 offen sc1
    buffer_load_dwordx4 v12, s[44:47], s3 offen offset:2048 lds
    v_mfma_f32_32x32x16_bf16 v[16:31], a[148:151], a[92:95], v[16:31]
    s_waitcnt lgkmcnt(8)
    ds_read_b64_tr_b16 a[144:145], v3 offset:24576
    ds_read_b64_tr_b16 a[146:147], v3 offset:25088
    v_mov_b32 v60, 0
    v_mov_b32 v61, 0
    v_mov_b32 v62, 0
    v_mov_b32 v63, 0
    v_mfma_f32_32x32x16_bf16 v[16:31], a[152:155], a[96:99], v[16:31]
    ds_read_b64_tr_b16 a[148:149], v3 offset:26624
    ds_read_b64_tr_b16 a[150:151], v3 offset:27136
    buffer_store_dwordx4 v[60:63], v53, s[56:59], s34 offen offset:512 sc1
    buffer_load_dwordx4 v13, s[44:47], s3 offen offset:3072 lds
    v_mfma_f32_32x32x16_bf16 v[16:31], a[156:159], a[100:103], v[16:31]
    s_waitcnt lgkmcnt(8)
    ds_read_b64_tr_b16 a[152:153], v3 offset:28672
    ds_read_b64_tr_b16 a[154:155], v3 offset:29184
    v_mfma_f32_32x32x16_bf16 v[16:31], a[160:163], a[104:107], v[16:31]
    s_add_u32 m0, s68, 4096
    s_add_u32 s3, s70, 294912
    ds_read_b64_tr_b16 a[156:157], v3 offset:30720
    ds_read_b64_tr_b16 a[158:159], v3 offset:31232
    buffer_store_dwordx4 v[60:63], v53, s[56:59], s34 offen offset:1024 sc1
    buffer_load_dwordx4 v10, s[44:47], s3 offen offset:0 lds
    v_mfma_f32_32x32x16_bf16 v[16:31], a[164:167], a[108:111], v[16:31]
    s_waitcnt lgkmcnt(8)
    ds_read_b64_tr_b16 a[160:161], v3 offset:32768
    ds_read_b64_tr_b16 a[162:163], v3 offset:33280
    buffer_store_dwordx4 v[60:63], v53, s[56:59], s34 offen offset:1536 sc1
    v_mfma_f32_32x32x16_bf16 v[16:31], a[168:171], a[112:115], v[16:31]
    ds_read_b64_tr_b16 a[164:165], v3 offset:34816
    ds_read_b64_tr_b16 a[166:167], v3 offset:35328
    buffer_load_dwordx4 v11, s[44:47], s3 offen offset:1024 lds
    v_lshrrev_b32 v112, 5, v0
    v_lshlrev_b32 v112, 4, v112
    v_mfma_f32_32x32x16_bf16 v[16:31], a[172:175], a[116:119], v[16:31]
    s_waitcnt lgkmcnt(8)
    s_lshl_b32 s96, s64, 12
    s_add_u32 s96, s96, 147456
    ds_read_b64_tr_b16 a[168:169], v7 offset:0
    ds_read_b64_tr_b16 a[170:171], v7 offset:512
    v_add_u32 v112, s96, v112
    v_mfma_f32_32x32x16_bf16 v[16:31], a[144:147], a[120:123], v[16:31]
    ds_read_b64_tr_b16 a[172:173], v7 offset:2048
    ds_read_b64_tr_b16 a[174:175], v7 offset:2560
    ds_read_b128 v[48:51], v112 offset:0
    ds_read_b128 v[52:55], v112 offset:32
    ds_read_b128 v[56:59], v112 offset:64
    ds_read_b128 v[60:63], v112 offset:96
    buffer_load_dwordx4 v12, s[44:47], s3 offen offset:2048 lds
    v_mfma_f32_32x32x16_bf16 v[16:31], a[148:151], a[124:127], v[16:31]
    s_waitcnt lgkmcnt(12)
    s_waitcnt lgkmcnt(0)
    s_cmp_lt_u32 s95, 9
    s_cselect_b32 s34, 1.0, -1.0
    ds_read_b64_tr_b16 a[144:145], v7 offset:4096
    ds_read_b64_tr_b16 a[146:147], v7 offset:4608
    v_mov_b32 v72, s34
    v_mfma_f32_32x32x16_bf16 v[16:31], a[152:155], a[128:131], v[16:31]
    s_cmp_eq_u32 s95, 9
    s_cselect_b32 s34, 0, 99
    ds_read_b64_tr_b16 a[148:149], v7 offset:6144
    ds_read_b64_tr_b16 a[150:151], v7 offset:6656
    buffer_load_dwordx4 v13, s[44:47], s3 offen offset:3072 lds
    v_and_b32 v73, 31, v0
    v_cmp_eq_u32 vcc, s34, v73
    v_mov_b32 v74, 1.0
    v_nop
    v_cndmask_b32 v72, v72, v74, vcc
    v_mfma_f32_32x32x16_bf16 v[16:31], a[156:159], a[132:135], v[16:31]
    s_or_b32 s34, s65, s64
    s_cmp_eq_u32 s34, 0
    s_cselect_b32 s34, 32, 0
    ds_read_b64_tr_b16 a[152:153], v7 offset:8192
    ds_read_b64_tr_b16 a[154:155], v7 offset:8704
    v_mfma_f32_32x32x16_bf16 v[16:31], a[160:163], a[136:139], v[16:31]
    s_add_u32 m0, s68, 8192
    s_add_u32 s3, s70, 589824
    ds_read_b64_tr_b16 a[156:157], v7 offset:10240
    ds_read_b64_tr_b16 a[158:159], v7 offset:10752
    buffer_load_dwordx4 v10, s[44:47], s3 offen offset:0 lds
    v_cmp_gt_u32 vcc, s34, v0
    v_mov_b32 v64, 0
    v_mov_b32 v65, 1.0
    v_cndmask_b32 v73, v72, v65, vcc
    v_cndmask_b32 v74, v65, v64, vcc
    v_cndmask_b32 v75, v72, v64, vcc
    v_mfma_f32_32x32x16_bf16 v[16:31], a[164:167], a[140:143], v[16:31]
    ds_read_b64_tr_b16 a[160:161], v7 offset:12288
    ds_read_b64_tr_b16 a[162:163], v7 offset:12800
    v_mul_f32 v128, v128, v48
    v_mul_f32 v129, v129, v49
    v_mul_f32 v130, v130, v50
    v_mfma_f32_32x32x16_bf16 v[32:47], a[168:171], a[72:75], v[32:47]
    ds_read_b64_tr_b16 a[164:165], v7 offset:14336
    ds_read_b64_tr_b16 a[166:167], v7 offset:14848
    v_mul_f32 v131, v131, v51
    v_mul_f32 v132, v132, v52
    v_mul_f32 v133, v133, v53
    v_mul_f32 v134, v134, v54
    v_mul_f32 v135, v135, v55
    v_mfma_f32_32x32x16_bf16 v[32:47], a[172:175], a[76:79], v[32:47]
    s_waitcnt lgkmcnt(8)
    ds_read_b64_tr_b16 a[168:169], v7 offset:16384
    ds_read_b64_tr_b16 a[170:171], v7 offset:16896
    v_mul_f32 v136, v136, v56
    v_mul_f32 v137, v137, v57
    v_mul_f32 v138, v138, v58
    v_mfma_f32_32x32x16_bf16 v[32:47], a[144:147], a[80:83], v[32:47]
    ds_read_b64_tr_b16 a[172:173], v7 offset:18432
    ds_read_b64_tr_b16 a[174:175], v7 offset:18944
    v_mul_f32 v139, v139, v59
    v_mul_f32 v140, v140, v60
    v_mul_f32 v141, v141, v61
    v_mul_f32 v142, v142, v62
    v_mul_f32 v143, v143, v63
    v_mfma_f32_32x32x16_bf16 v[32:47], a[148:151], a[84:87], v[32:47]
    s_waitcnt lgkmcnt(8)
    ds_read_b64_tr_b16 a[144:145], v7 offset:20480
    ds_read_b64_tr_b16 a[146:147], v7 offset:20992
    v_add_f32 v76, v136, v140
    v_sub_f32 v77, v136, v140
    v_mov_b32 v78, 0
    v_mfma_f32_32x32x16_bf16 v[32:47], a[152:155], a[88:91], v[32:47]
    ds_read_b64_tr_b16 a[148:149], v7 offset:22528
    ds_read_b64_tr_b16 a[150:151], v7 offset:23040
    v_cmp_lt_f32 vcc, 0, v72
    v_nop
    v_nop
    v_cndmask_b32 v76, v78, v76, vcc
    v_cndmask_b32 v77, v77, v78, vcc
    v_mfma_f32_32x32x16_bf16 v[32:47], a[156:159], a[92:95], v[32:47]
    s_waitcnt lgkmcnt(8)
    ds_read_b64_tr_b16 a[152:153], v7 offset:24576
    ds_read_b64_tr_b16 a[154:155], v7 offset:25088
    v_mul_f32 v136, v136, v74
    v_fma_f32 v128, v140, v75, v128
    v_fma_f32 v132, v132, v73, v136
    v_add_f32 v64, v128, v132
    v_mfma_f32_32x32x16_bf16 v[32:47], a[160:163], a[96:99], v[32:47]
    ds_read_b64_tr_b16 a[156:157], v7 offset:26624
    ds_read_b64_tr_b16 a[158:159], v7 offset:27136
    v_sub_f32 v68, v128, v132
    v_fma_f32 v129, v141, v72, v129
    v_fma_f32 v133, v133, v72, v137
    v_add_f32 v65, v129, v133
    v_mfma_f32_32x32x16_bf16 v[32:47], a[164:167], a[100:103], v[32:47]
    s_waitcnt lgkmcnt(8)
    ds_read_b64_tr_b16 a[160:161], v7 offset:28672
    ds_read_b64_tr_b16 a[162:163], v7 offset:29184
    v_sub_f32 v69, v129, v133
    v_fma_f32 v130, v142, v72, v130
    v_fma_f32 v134, v134, v72, v138
    v_add_f32 v66, v130, v134
    v_mfma_f32_32x32x16_bf16 v[32:47], a[168:171], a[104:107], v[32:47]
    ds_read_b64_tr_b16 a[164:165], v7 offset:30720
    ds_read_b64_tr_b16 a[166:167], v7 offset:31232
    v_sub_f32 v70, v130, v134
    v_fma_f32 v131, v143, v72, v131
    v_fma_f32 v135, v135, v72, v139
    v_add_f32 v67, v131, v135
    v_mfma_f32_32x32x16_bf16 v[32:47], a[172:175], a[108:111], v[32:47]
    s_waitcnt lgkmcnt(8)
    ds_read_b64_tr_b16 a[168:169], v7 offset:32768
    ds_read_b64_tr_b16 a[170:171], v7 offset:33280
    v_sub_f32 v71, v131, v135
    v_cvt_pk_bf16_f32 v48, v64, v65
    v_cvt_pk_bf16_f32 v49, v66, v67
    v_cvt_pk_bf16_f32 v50, v68, v69
    v_mfma_f32_32x32x16_bf16 v[32:47], a[144:147], a[112:115], v[32:47]
    ds_read_b64_tr_b16 a[172:173], v7 offset:34816
    ds_read_b64_tr_b16 a[174:175], v7 offset:35328
    v_cvt_pk_bf16_f32 v51, v70, v71
    v_nop
    v_nop
    v_permlane32_swap_b32 v48, v50
    v_permlane32_swap_b32 v49, v51
    v_mfma_f32_32x32x16_bf16 v[32:47], a[148:151], a[116:119], v[32:47]
    s_waitcnt vmcnt(23)
    s_barrier
    s_waitcnt lgkmcnt(8)
    ds_read_b64_tr_b16 a[144:145], v4 offset:0
    ds_read_b64_tr_b16 a[146:147], v4 offset:512
    v_mfma_f32_32x32x16_bf16 v[32:47], a[152:155], a[120:123], v[32:47]
    ds_read_b64_tr_b16 a[148:149], v4 offset:2048
    ds_read_b64_tr_b16 a[150:151], v4 offset:2560
    v_lshrrev_b32 v52, 5, v0
    v_mul_u32_u24 v52, 626688, v52
    v_and_b32 v53, 31, v0
    v_lshlrev_b32 v53, 4, v53
    v_add_u32 v52, v52, v53
    v_mfma_f32_32x32x16_bf16 v[32:47], a[156:159], a[124:127], v[32:47]
    s_waitcnt lgkmcnt(8)
    s_mul_i32 s34, s95, 34816
    s_lshl_b32 s35, s65, 2
    s_add_u32 s35, s35, s64
    ds_read_b64_tr_b16 a[152:153], v4 offset:4096
    ds_read_b64_tr_b16 a[154:155], v4 offset:4608
    v_mfma_f32_32x32x16_bf16 v[32:47], a[160:163], a[128:131], v[32:47]
    s_lshl_b32 s35, s35, 9
    s_add_u32 s35, s35, s34
    s_add_u32 s35, s35, 41943040
    ds_read_b64_tr_b16 a[156:157], v4 offset:6144
    ds_read_b64_tr_b16 a[158:159], v4 offset:6656
    v_mfma_f32_32x32x16_bf16 v[32:47], a[164:167], a[132:135], v[32:47]
    s_waitcnt lgkmcnt(8)
    ds_read_b64_tr_b16 a[160:161], v4 offset:8192
    ds_read_b64_tr_b16 a[162:163], v4 offset:8704
    buffer_store_dwordx4 v[48:51], v52, s[56:59], s35 offen sc1
    v_mfma_f32_32x32x16_bf16 v[32:47], a[168:171], a[136:139], v[32:47]
    ds_read_b64_tr_b16 a[164:165], v4 offset:10240
    ds_read_b64_tr_b16 a[166:167], v4 offset:10752
    v_mov_b32 v78, v76
    v_nop
    v_nop
    v_permlane32_swap_b32 v78, v77
    v_mov_b32 v57, 0
    v_mfma_f32_32x32x16_bf16 v[32:47], a[172:175], a[140:143], v[32:47]
    s_waitcnt lgkmcnt(8)
    s_barrier
    ds_read_b64_tr_b16 a[168:169], v4 offset:12288
    ds_read_b64_tr_b16 a[170:171], v4 offset:12800
    v_mov_b32 v58, 0
    v_mov_b32 v59, 0
    v_cvt_pk_bf16_f32 v56, v78, v57
    v_mfma_f32_32x32x16_bf16 v[80:95], a[144:147], a[0:3], 0
    s_or_b32 s35, s65, s64
    s_cmp_eq_u32 s35, 0
    s_cselect_b32 s96, 0, 0x40000000
    s_add_u32 m0, s68, 36864
    s_add_u32 s3, s70, 2654208
    ds_read_b64_tr_b16 a[172:173], v4 offset:14336
    ds_read_b64_tr_b16 a[174:175], v4 offset:14848
    buffer_load_dwordx4 v10, s[44:47], s3 offen offset:0 lds
    v_add_u32 v53, s96, v52
    v_mfma_f32_32x32x16_bf16 v[80:95], a[148:151], a[4:7], v[80:95]
    s_waitcnt lgkmcnt(8)
    s_add_u32 s34, s34, 41975808
    ds_read_b64_tr_b16 a[144:145], v4 offset:16384
    ds_read_b64_tr_b16 a[146:147], v4 offset:16896
    buffer_store_dwordx4 v[56:59], v53, s[56:59], s34 offen sc1
    v_mfma_f32_32x32x16_bf16 v[80:95], a[152:155], a[8:11], v[80:95]
    ds_read_b64_tr_b16 a[148:149], v4 offset:18432
    ds_read_b64_tr_b16 a[150:151], v4 offset:18944
    buffer_load_dwordx4 v11, s[44:47], s3 offen offset:1024 lds
    v_mov_b32 v60, 0
    v_mov_b32 v61, 0
    v_mov_b32 v62, 0
    v_mov_b32 v63, 0
    v_mfma_f32_32x32x16_bf16 v[80:95], a[156:159], a[12:15], v[80:95]
    s_waitcnt lgkmcnt(8)
    s_xor_b32 s82, s66, 1
    s_and_b32 s78, s82, 1
    s_mul_i32 s76, s82, 288
    ds_read_b64_tr_b16 a[152:153], v4 offset:20480
    ds_read_b64_tr_b16 a[154:155], v4 offset:20992
    v_lshrrev_b32 v224, 5, v0
    v_mfma_f32_32x32x16_bf16 v[80:95], a[160:163], a[16:19], v[80:95]
    ds_read_b64_tr_b16 a[156:157], v4 offset:22528
    ds_read_b64_tr_b16 a[158:159], v4 offset:23040
    buffer_store_dwordx4 v[60:63], v53, s[56:59], s34 offen offset:512 sc1
    buffer_load_dwordx4 v12, s[44:47], s3 offen offset:2048 lds
    v_mfma_f32_32x32x16_bf16 v[80:95], a[164:167], a[20:23], v[80:95]
    s_waitcnt lgkmcnt(8)
    ds_read_b64_tr_b16 a[160:161], v4 offset:24576
    ds_read_b64_tr_b16 a[162:163], v4 offset:25088
    buffer_store_dwordx4 v[60:63], v53, s[56:59], s34 offen offset:1024 sc1
    v_mfma_f32_32x32x16_bf16 v[80:95], a[168:171], a[24:27], v[80:95]
    ds_read_b64_tr_b16 a[164:165], v4 offset:26624
    ds_read_b64_tr_b16 a[166:167], v4 offset:27136
    buffer_store_dwordx4 v[60:63], v53, s[56:59], s34 offen offset:1536 sc1
    buffer_load_dwordx4 v13, s[44:47], s3 offen offset:3072 lds
    v_mfma_f32_32x32x16_bf16 v[80:95], a[172:175], a[28:31], v[80:95]
    s_waitcnt lgkmcnt(8)
    s_lshr_b32 s38, s66, 3
    s_lshl_b32 s94, s64, 13
    s_lshl_b32 s95, s64, 10
    ds_read_b64_tr_b16 a[168:169], v4 offset:28672
    ds_read_b64_tr_b16 a[170:171], v4 offset:29184
    v_lshlrev_b32 v224, 9, v224
    v_mfma_f32_32x32x16_bf16 v[80:95], a[144:147], a[32:35], v[80:95]
    s_add_u32 m0, s68, 40960
    s_add_u32 s3, s70, 2949120
    ds_read_b64_tr_b16 a[172:173], v4 offset:30720
    ds_read_b64_tr_b16 a[174:175], v4 offset:31232
    buffer_load_dwordx4 v10, s[44:47], s3 offen offset:0 lds
    v_bfe_u32 v225, v0, 2, 2
    v_lshlrev_b32 v225, 6, v225
    v_mfma_f32_32x32x16_bf16 v[80:95], a[148:151], a[36:39], v[80:95]
    s_waitcnt lgkmcnt(8)
    s_mul_i32 s39, s38, 626688
    s_add_u32 s39, s39, s94
    s_add_u32 s39, s39, 41943040
    ds_read_b64_tr_b16 a[144:145], v4 offset:32768
    ds_read_b64_tr_b16 a[146:147], v4 offset:33280
    v_add_u32 v224, v224, v225
    v_lshrrev_b32 v240, 3, v0
    v_mfma_f32_32x32x16_bf16 v[80:95], a[152:155], a[40:43], v[80:95]
    ds_read_b64_tr_b16 a[148:149], v4 offset:34816
    ds_read_b64_tr_b16 a[150:151], v4 offset:35328
    buffer_load_dwordx4 v11, s[44:47], s3 offen offset:1024 lds
    v_bfe_u32 v225, v0, 4, 1
    v_and_b32 v247, 7, v0
    v_lshrrev_b32 v250, 1, v240
    v_xor_b32 v247, v247, v250
    v_lshlrev_b32 v247, 4, v247
    v_mfma_f32_32x32x16_bf16 v[80:95], a[156:159], a[44:47], v[80:95]
    s_waitcnt lgkmcnt(8)
    s_mul_i32 s77, s78, 224
    s_add_u32 s77, s76, s77
    ds_read_b64_tr_b16 a[152:153], v8 offset:0
    ds_read_b64_tr_b16 a[154:155], v8 offset:512
    v_lshlrev_b32 v225, 5, v225
    v_xor_b32 v250, 64, v247
    v_mfma_f32_32x32x16_bf16 v[80:95], a[160:163], a[48:51], v[80:95]
    s_lshl_b32 s96, s65, 5
    s_add_u32 s96, s96, s38
    ds_read_b64_tr_b16 a[156:157], v8 offset:2048
    ds_read_b64_tr_b16 a[158:159], v8 offset:2560
    buffer_load_dwordx4 v12, s[44:47], s3 offen offset:2048 lds
    v_add_u32 v224, v224, v225
    v_lshlrev_b32 v240, 1, v240
    v_add_u32 v240, s96, v240
    v_mfma_f32_32x32x16_bf16 v[80:95], a[164:167], a[52:55], v[80:95]
    s_waitcnt lgkmcnt(8)
    s_lshl_b32 s96, s64, 8
    ds_read_b64_tr_b16 a[160:161], v8 offset:4096
    ds_read_b64_tr_b16 a[162:163], v8 offset:4608
    v_and_b32 v225, 3, v0
    v_lshlrev_b32 v225, 3, v225
    v_add_u32 v247, s96, v247
    v_add_u32 v250, s96, v250
    v_mfma_f32_32x32x16_bf16 v[80:95], a[168:171], a[56:59], v[80:95]
    ds_read_b64_tr_b16 a[164:165], v8 offset:6144
    ds_read_b64_tr_b16 a[166:167], v8 offset:6656
    buffer_load_dwordx4 v13, s[44:47], s3 offen offset:3072 lds
    v_add_u32 v224, v224, v225
    v_lshlrev_b32 v232, 12, v240
    v_add_u32 v233, 65536, v232
    v_sub_u32 v240, 1024, v240
    v_lshlrev_b32 v234, 12, v240
    v_mfma_f32_32x32x16_bf16 v[80:95], a[172:175], a[60:63], v[80:95]
    s_waitcnt lgkmcnt(8)
    ds_read_b64_tr_b16 a[168:169], v8 offset:8192
    ds_read_b64_tr_b16 a[170:171], v8 offset:8704
    v_add_u32 v248, 0, v224
    v_subrev_u32 v235, 65536, v234
    v_add_u32 v232, v232, v247
    v_add_u32 v233, v233, v250
    v_mfma_f32_32x32x16_bf16 v[80:95], a[144:147], a[64:67], v[80:95]
    s_add_u32 m0, s68, 45056
    s_add_u32 s3, s70, 3244032
    ds_read_b64_tr_b16 a[172:173], v8 offset:10240
    ds_read_b64_tr_b16 a[174:175], v8 offset:10752
    buffer_load_dwordx4 v10, s[44:47], s3 offen offset:0 lds
    v_add_u32 v234, v234, v247
    v_add_u32 v235, v235, v250
    v_mfma_f32_32x32x16_bf16 v[80:95], a[148:151], a[68:71], v[80:95]
    s_waitcnt lgkmcnt(8)
    ds_read_b64_tr_b16 a[144:145], v8 offset:12288
    ds_read_b64_tr_b16 a[146:147], v8 offset:12800
    v_and_b32 v240, 15, v0
    v_lshrrev_b32 v247, 4, v0
    v_mfma_f32_32x32x16_bf16 v[96:111], a[152:155], a[0:3], 0
    ds_read_b64_tr_b16 a[148:149], v8 offset:14336
    ds_read_b64_tr_b16 a[150:151], v8 offset:14848
    v_lshrrev_b32 v224, 5, v0
    v_bfe_u32 v250, v0, 1, 3
    v_xor_b32 v250, v250, v247
    v_lshlrev_b32 v250, 4, v250
    v_mfma_f32_32x32x16_bf16 v[96:111], a[156:159], a[4:7], v[96:111]
    s_waitcnt lgkmcnt(8)
    ds_read_b64_tr_b16 a[152:153], v8 offset:16384
    ds_read_b64_tr_b16 a[154:155], v8 offset:16896
    v_lshlrev_b32 v240, 7, v240
    v_add_u32 v240, v240, v250
    v_mfma_f32_32x32x16_bf16 v[96:111], a[160:163], a[8:11], v[96:111]
    ds_read_b64_tr_b16 a[156:157], v8 offset:18432
    ds_read_b64_tr_b16 a[158:159], v8 offset:18944
    v_lshlrev_b32 v224, 9, v224
    v_add_u32 v236, s94, v240
    v_add_u32 v236, 73728, v236
    v_xor_b32 v237, 64, v236
    v_mfma_f32_32x32x16_bf16 v[96:111], a[164:167], a[12:15], v[96:111]
    s_waitcnt lgkmcnt(8)
    s_cmp_eq_u32 s64, 3
    s_cselect_b32 s96, 147456, 0
    ds_read_b64_tr_b16 a[160:161], v8 offset:20480
    ds_read_b64_tr_b16 a[162:163], v8 offset:20992
    v_bfe_u32 v225, v0, 2, 2
    v_mfma_f32_32x32x16_bf16 v[96:111], a[168:171], a[16:19], v[96:111]
    s_add_u32 s97, s94, 73728
    s_cmp_eq_u32 s64, 3
    s_cselect_b32 s96, s96, s97
    ds_read_b64_tr_b16 a[164:165], v8 offset:22528
    ds_read_b64_tr_b16 a[166:167], v8 offset:23040
    v_lshlrev_b32 v225, 6, v225
    v_mfma_f32_32x32x16_bf16 v[96:111], a[172:175], a[20:23], v[96:111]
    s_waitcnt lgkmcnt(8)
    s_cmp_eq_u32 s78, 0
    s_cselect_b32 s79, 64, -64
    s_cselect_b32 s80, 256, 0
    ds_read_b64_tr_b16 a[168:169], v8 offset:24576
    ds_read_b64_tr_b16 a[170:171], v8 offset:25088
    v_add_u32 v238, s96, v240
    v_mfma_f32_32x32x16_bf16 v[96:111], a[144:147], a[24:27], v[96:111]
    s_movk_i32 s97, 4096
    s_cmp_eq_u32 s64, 3
    s_cselect_b32 s97, s97, 36864
    s_add_u32 s80, s80, s76
    ds_read_b64_tr_b16 a[172:173], v8 offset:26624
    ds_read_b64_tr_b16 a[174:175], v8 offset:27136
    v_add_u32 v224, v224, v225
    v_mfma_f32_32x32x16_bf16 v[96:111], a[148:151], a[28:31], v[96:111]
    s_waitcnt lgkmcnt(8)
    s_mul_i32 s81, s79, 0
    s_add_u32 s81, s81, s77
    ds_read_b64_tr_b16 a[144:145], v8 offset:28672
    ds_read_b64_tr_b16 a[146:147], v8 offset:29184
    v_bfe_u32 v225, v0, 4, 1
    v_add_u32 v239, s97, v238
    v_mfma_f32_32x32x16_bf16 v[96:111], a[152:155], a[32:35], v[96:111]
    s_mul_i32 s16, s81, 1152
    s_add_u32 s17, s16, 36864
    s_mul_i32 s81, s79, 1
    s_add_u32 s81, s81, s77
    ds_read_b64_tr_b16 a[148:149], v8 offset:30720
    ds_read_b64_tr_b16 a[150:151], v8 offset:31232
    v_mfma_f32_32x32x16_bf16 v[96:111], a[156:159], a[36:39], v[96:111]
    s_waitcnt lgkmcnt(8)
    s_mul_i32 s18, s81, 1152
    s_add_u32 s19, s18, 36864
    ds_read_b64_tr_b16 a[152:153], v8 offset:32768
    ds_read_b64_tr_b16 a[154:155], v8 offset:33280
    v_lshlrev_b32 v225, 5, v225
    v_mfma_f32_32x32x16_bf16 v[96:111], a[160:163], a[40:43], v[96:111]
    s_mul_i32 s81, s79, 2
    s_add_u32 s81, s81, s77
    s_mul_i32 s20, s81, 1152
    s_add_u32 s21, s20, 36864
    ds_read_b64_tr_b16 a[156:157], v8 offset:34816
    ds_read_b64_tr_b16 a[158:159], v8 offset:35328
    v_add_u32 v224, v224, v225
    v_mfma_f32_32x32x16_bf16 v[96:111], a[164:167], a[44:47], v[96:111]
    s_waitcnt vmcnt(6)
    s_barrier
    s_waitcnt lgkmcnt(8)
    buffer_atomic_add v231, v253, s[12:15], 0 offen offset:128 sc1
    ds_read_b64_tr_b16 a[160:161], v5 offset:0
    ds_read_b64_tr_b16 a[162:163], v5 offset:512
    v_mfma_f32_32x32x16_bf16 v[96:111], a[168:171], a[48:51], v[96:111]
    s_mul_i32 s81, s79, 3
    s_add_u32 s81, s81, s77
    s_mul_i32 s22, s81, 1152
    s_add_u32 s23, s22, 36864
    ds_read_b64_tr_b16 a[164:165], v5 offset:2048
    ds_read_b64_tr_b16 a[166:167], v5 offset:2560
    v_and_b32 v225, 3, v0
    v_mfma_f32_32x32x16_bf16 v[96:111], a[172:175], a[52:55], v[96:111]
    s_waitcnt lgkmcnt(8)
    s_mul_i32 s24, s80, 1152
    s_and_b32 s78, s66, 1
    s_mul_i32 s76, s78, 640
    s_lshr_b32 s77, s66, 2
    ds_read_b64_tr_b16 a[168:169], v5 offset:4096
    ds_read_b64_tr_b16 a[170:171], v5 offset:4608
    v_mfma_f32_32x32x16_bf16 v[96:111], a[144:147], a[56:59], v[96:111]
    s_add_u32 s79, s77, 1
    s_and_b32 s79, s79, 3
    s_lshl_b32 s79, s79, 7
    s_add_u32 s25, s76, s79
    ds_read_b64_tr_b16 a[172:173], v5 offset:6144
    ds_read_b64_tr_b16 a[174:175], v5 offset:6656
    v_lshlrev_b32 v225, 3, v225
    v_mfma_f32_32x32x16_bf16 v[96:111], a[148:151], a[60:63], v[96:111]
    s_waitcnt lgkmcnt(8)
    s_add_u32 s79, s77, 2
    s_and_b32 s79, s79, 3
    s_lshl_b32 s79, s79, 7
    s_add_u32 s26, s76, s79
    s_add_u32 s79, s77, 3
    s_and_b32 s79, s79, 3
    s_lshl_b32 s79, s79, 7
    s_add_u32 s27, s76, s79
    s_add_u32 s79, s77, 0
    s_and_b32 s79, s79, 3
    s_lshl_b32 s79, s79, 7
    s_add_u32 s28, s76, s79
    s_cmp_eq_u32 s78, 0
    s_cselect_b32 s29, 0, 64
    s_add_u32 s29, s29, 512
    ds_read_b64_tr_b16 a[144:145], v5 offset:8192
    ds_read_b64_tr_b16 a[146:147], v5 offset:8704
    v_add_u32 v224, v224, v225
    v_mfma_f32_32x32x16_bf16 v[96:111], a[152:155], a[64:67], v[96:111]
    ds_read_b64_tr_b16 a[148:149], v5 offset:10240
    ds_read_b64_tr_b16 a[150:151], v5 offset:10752
    v_mfma_f32_32x32x16_bf16 v[96:111], a[156:159], a[68:71], v[96:111]
    s_waitcnt lgkmcnt(8)
    s_barrier
    ds_read_b64_tr_b16 a[152:153], v5 offset:12288
    ds_read_b64_tr_b16 a[154:155], v5 offset:12800
    v_add_u32 v249, 36864, v224
    v_mfma_f32_32x32x16_bf16 v[80:95], a[160:163], a[72:75], v[80:95]
    s_add_u32 m0, s68, 73728
    s_add_u32 s3, s70, 0
    ds_read_b64_tr_b16 a[156:157], v5 offset:14336
    ds_read_b64_tr_b16 a[158:159], v5 offset:14848
    buffer_load_dwordx4 v10, s[48:51], s3 offen offset:0 lds
    v_mfma_f32_32x32x16_bf16 v[80:95], a[164:167], a[76:79], v[80:95]
    s_waitcnt lgkmcnt(8)
    ds_read_b64_tr_b16 a[160:161], v5 offset:16384
    ds_read_b64_tr_b16 a[162:163], v5 offset:16896
    v_mfma_f32_32x32x16_bf16 v[80:95], a[168:171], a[80:83], v[80:95]
    ds_read_b64_tr_b16 a[164:165], v5 offset:18432
    ds_read_b64_tr_b16 a[166:167], v5 offset:18944
    buffer_load_dwordx4 v11, s[48:51], s3 offen offset:1024 lds
    v_mfma_f32_32x32x16_bf16 v[80:95], a[172:175], a[84:87], v[80:95]
    s_waitcnt lgkmcnt(8)
    ds_read_b64_tr_b16 a[168:169], v5 offset:20480
    ds_read_b64_tr_b16 a[170:171], v5 offset:20992
    v_mfma_f32_32x32x16_bf16 v[80:95], a[144:147], a[88:91], v[80:95]
    ds_read_b64_tr_b16 a[172:173], v5 offset:22528
    ds_read_b64_tr_b16 a[174:175], v5 offset:23040
    buffer_load_dwordx4 v12, s[48:51], s3 offen offset:2048 lds
    v_and_b32 v224, 15, v0
    v_lshrrev_b32 v225, 4, v0
    v_and_b32 v226, 1, v225
    v_mfma_f32_32x32x16_bf16 v[80:95], a[148:151], a[92:95], v[80:95]
    s_waitcnt lgkmcnt(8)
    ds_read_b64_tr_b16 a[144:145], v5 offset:24576
    ds_read_b64_tr_b16 a[146:147], v5 offset:25088
    v_lshlrev_b32 v226, 9, v226
    v_lshrrev_b32 v225, 1, v225
    v_lshlrev_b32 v225, 10, v225
    v_mfma_f32_32x32x16_bf16 v[80:95], a[152:155], a[96:99], v[80:95]
    ds_read_b64_tr_b16 a[148:149], v5 offset:26624
    ds_read_b64_tr_b16 a[150:151], v5 offset:27136
    buffer_load_dwordx4 v13, s[48:51], s3 offen offset:3072 lds
    v_add_u32 v226, v226, v225
    v_mfma_f32_32x32x16_bf16 v[80:95], a[156:159], a[100:103], v[80:95]
    s_waitcnt lgkmcnt(8)
    s_and_b32 s96, s66, 7
    s_mul_i32 s96, s96, 36
    ds_read_b64_tr_b16 a[152:153], v5 offset:28672
    ds_read_b64_tr_b16 a[154:155], v5 offset:29184
    v_add_u32 v224, s96, v224
    v_lshrrev_b32 v225, 5, v224
    v_mfma_f32_32x32x16_bf16 v[80:95], a[160:163], a[104:107], v[80:95]
    s_add_u32 m0, s68, 77824
    s_add_u32 s3, s70, 294912
    ds_read_b64_tr_b16 a[156:157], v5 offset:30720
    ds_read_b64_tr_b16 a[158:159], v5 offset:31232
    buffer_load_dwordx4 v10, s[48:51], s3 offen offset:0 lds
    v_mul_u32_u24 v225, 34816, v225
    v_and_b32 v227, 31, v224
    v_mfma_f32_32x32x16_bf16 v[80:95], a[164:167], a[108:111], v[80:95]
    s_waitcnt lgkmcnt(8)
    ds_read_b64_tr_b16 a[160:161], v5 offset:32768
    ds_read_b64_tr_b16 a[162:163], v5 offset:33280
    v_lshlrev_b32 v227, 4, v227
    v_add_u32 v225, v225, v227
    v_add_u32 v225, v225, v226
    v_subrev_u32 v227, s96, v224
    v_mfma_f32_32x32x16_bf16 v[80:95], a[168:171], a[112:115], v[80:95]
    ds_read_b64_tr_b16 a[164:165], v5 offset:34816
    ds_read_b64_tr_b16 a[166:167], v5 offset:35328
    buffer_load_dwordx4 v11, s[48:51], s3 offen offset:1024 lds
    v_lshlrev_b32 v247, 2, v224
    v_mov_b32 v244, 0x40000000
    v_mov_b32 v241, 0x40000000
    v_mfma_f32_32x32x16_bf16 v[80:95], a[172:175], a[116:119], v[80:95]
    s_waitcnt lgkmcnt(8)
    ds_read_b64_tr_b16 a[168:169], v9 offset:0
    ds_read_b64_tr_b16 a[170:171], v9 offset:512
    v_cmp_gt_u32 vcc, 36, v227
    v_nop
    v_nop
    v_cndmask_b32 v241, v241, v225, vcc
    v_mfma_f32_32x32x16_bf16 v[80:95], a[144:147], a[120:123], v[80:95]
    ds_read_b64_tr_b16 a[172:173], v9 offset:2048
    ds_read_b64_tr_b16 a[174:175], v9 offset:2560
    buffer_load_dwordx4 v12, s[48:51], s3 offen offset:2048 lds
    v_add_u32 v227, 313344, v225
    v_cndmask_b32 v244, v244, v227, vcc
    v_mfma_f32_32x32x16_bf16 v[80:95], a[148:151], a[124:127], v[80:95]
    s_waitcnt lgkmcnt(8)
    ds_read_b64_tr_b16 a[144:145], v9 offset:4096
    ds_read_b64_tr_b16 a[146:147], v9 offset:4608
    v_cmp_eq_u32 vcc, 0x120, v224
    v_nop
    v_nop
    v_cndmask_b32 v241, v241, v225, vcc
    v_mfma_f32_32x32x16_bf16 v[80:95], a[152:155], a[128:131], v[80:95]
    ds_read_b64_tr_b16 a[148:149], v9 offset:6144
    ds_read_b64_tr_b16 a[150:151], v9 offset:6656
    buffer_load_dwordx4 v13, s[48:51], s3 offen offset:3072 lds
    v_mov_b32 v227, 0x40000000
    v_cmp_eq_u32 vcc, 0, v224
    v_nop
    v_nop
    v_cndmask_b32 v244, v244, v227, vcc
    v_mfma_f32_32x32x16_bf16 v[80:95], a[156:159], a[132:135], v[80:95]
    s_waitcnt lgkmcnt(8)
    ds_read_b64_tr_b16 a[152:153], v9 offset:8192
    ds_read_b64_tr_b16 a[154:155], v9 offset:8704
    v_mfma_f32_32x32x16_bf16 v[80:95], a[160:163], a[136:139], v[80:95]
    s_add_u32 m0, s68, 81920
    s_add_u32 s3, s70, 589824
    ds_read_b64_tr_b16 a[156:157], v9 offset:10240
    ds_read_b64_tr_b16 a[158:159], v9 offset:10752
    buffer_load_dwordx4 v10, s[48:51], s3 offen offset:0 lds
    v_mfma_f32_32x32x16_bf16 v[80:95], a[164:167], a[140:143], v[80:95]
    s_waitcnt lgkmcnt(8)
    ds_read_b64_tr_b16 a[160:161], v9 offset:12288
    ds_read_b64_tr_b16 a[162:163], v9 offset:12800
    v_cmp_eq_u32 vcc, v227, v241
    v_nop
    v_nop
    v_cndmask_b32 v247, v247, v227, vcc
    v_mfma_f32_32x32x16_bf16 v[96:111], a[168:171], a[72:75], v[96:111]
    ds_read_b64_tr_b16 a[164:165], v9 offset:14336
    ds_read_b64_tr_b16 a[166:167], v9 offset:14848
    v_add_u32 v224, 16, v224
    v_lshrrev_b32 v225, 5, v224
    v_mul_u32_u24 v225, 34816, v225
    v_and_b32 v227, 31, v224
    v_lshlrev_b32 v227, 4, v227
    v_mfma_f32_32x32x16_bf16 v[96:111], a[172:175], a[76:79], v[96:111]
    s_waitcnt lgkmcnt(8)
    ds_read_b64_tr_b16 a[168:169], v9 offset:16384
    ds_read_b64_tr_b16 a[170:171], v9 offset:16896
    v_add_u32 v225, v225, v227
    v_add_u32 v225, v225, v226
    v_subrev_u32 v227, s96, v224
    v_lshlrev_b32 v250, 2, v224
    v_mfma_f32_32x32x16_bf16 v[96:111], a[144:147], a[80:83], v[96:111]
    ds_read_b64_tr_b16 a[172:173], v9 offset:18432
    ds_read_b64_tr_b16 a[174:175], v9 offset:18944
    v_mov_b32 v245, 0x40000000
    v_mov_b32 v242, 0x40000000
    v_cmp_gt_u32 vcc, 36, v227
    v_nop
    v_nop
    v_cndmask_b32 v242, v242, v225, vcc
    v_mfma_f32_32x32x16_bf16 v[96:111], a[148:151], a[84:87], v[96:111]
    s_waitcnt lgkmcnt(8)
    ds_read_b64_tr_b16 a[144:145], v9 offset:20480
    ds_read_b64_tr_b16 a[146:147], v9 offset:20992
    v_add_u32 v227, 313344, v225
    v_cndmask_b32 v245, v245, v227, vcc
    v_mfma_f32_32x32x16_bf16 v[96:111], a[152:155], a[88:91], v[96:111]
    ds_read_b64_tr_b16 a[148:149], v9 offset:22528
    ds_read_b64_tr_b16 a[150:151], v9 offset:23040
    v_cmp_eq_u32 vcc, 0x120, v224
    v_nop
    v_nop
    v_cndmask_b32 v242, v242, v225, vcc
    v_mfma_f32_32x32x16_bf16 v[96:111], a[156:159], a[92:95], v[96:111]
    s_waitcnt lgkmcnt(8)
    ds_read_b64_tr_b16 a[152:153], v9 offset:24576
    ds_read_b64_tr_b16 a[154:155], v9 offset:25088
    v_mov_b32 v227, 0x40000000
    v_cmp_eq_u32 vcc, 0, v224
    v_nop
    v_nop
    v_cndmask_b32 v245, v245, v227, vcc
    v_mfma_f32_32x32x16_bf16 v[96:111], a[160:163], a[96:99], v[96:111]
    ds_read_b64_tr_b16 a[156:157], v9 offset:26624
    ds_read_b64_tr_b16 a[158:159], v9 offset:27136
    v_mfma_f32_32x32x16_bf16 v[96:111], a[164:167], a[100:103], v[96:111]
    s_waitcnt lgkmcnt(8)
    ds_read_b64_tr_b16 a[160:161], v9 offset:28672
    ds_read_b64_tr_b16 a[162:163], v9 offset:29184
    v_cmp_eq_u32 vcc, v227, v242
    v_nop
    v_nop
    v_cndmask_b32 v250, v250, v227, vcc
    v_mfma_f32_32x32x16_bf16 v[96:111], a[168:171], a[104:107], v[96:111]
    ds_read_b64_tr_b16 a[164:165], v9 offset:30720
    ds_read_b64_tr_b16 a[166:167], v9 offset:31232
    v_add_u32 v224, 16, v224
    v_lshrrev_b32 v225, 5, v224
    v_mul_u32_u24 v225, 34816, v225
    v_and_b32 v227, 31, v224
    v_lshlrev_b32 v227, 4, v227
    v_mfma_f32_32x32x16_bf16 v[96:111], a[172:175], a[108:111], v[96:111]
    s_waitcnt lgkmcnt(8)
    ds_read_b64_tr_b16 a[168:169], v9 offset:32768
    ds_read_b64_tr_b16 a[170:171], v9 offset:33280
    v_add_u32 v225, v225, v227
    v_add_u32 v225, v225, v226
    v_subrev_u32 v227, s96, v224
    v_mfma_f32_32x32x16_bf16 v[96:111], a[144:147], a[112:115], v[96:111]
    ds_read_b64_tr_b16 a[172:173], v9 offset:34816
    ds_read_b64_tr_b16 a[174:175], v9 offset:35328
    v_lshlrev_b32 v251, 2, v224
    v_mov_b32 v246, 0x40000000
    v_mov_b32 v243, 0x40000000
    v_mfma_f32_32x32x16_bf16 v[96:111], a[148:151], a[116:119], v[96:111]
    s_barrier
    s_waitcnt lgkmcnt(8)
    ds_read_b64_tr_b16 a[144:145], v2 offset:0
    ds_read_b64_tr_b16 a[146:147], v2 offset:512
    v_mfma_f32_32x32x16_bf16 v[96:111], a[152:155], a[120:123], v[96:111]
    ds_read_b64_tr_b16 a[148:149], v2 offset:2048
    ds_read_b64_tr_b16 a[150:151], v2 offset:2560
    v_cmp_gt_u32 vcc, 36, v227
    v_nop
    v_nop
    v_cndmask_b32 v243, v243, v225, vcc
    v_add_u32 v227, 313344, v225
    v_mfma_f32_32x32x16_bf16 v[96:111], a[156:159], a[124:127], v[96:111]
    s_waitcnt lgkmcnt(8)
    ds_read_b64_tr_b16 a[152:153], v2 offset:4096
    ds_read_b64_tr_b16 a[154:155], v2 offset:4608
    v_cndmask_b32 v246, v246, v227, vcc
    v_cmp_eq_u32 vcc, 0x120, v224
    v_nop
    v_nop
    v_cndmask_b32 v243, v243, v225, vcc
    v_mfma_f32_32x32x16_bf16 v[96:111], a[160:163], a[128:131], v[96:111]
    ds_read_b64_tr_b16 a[156:157], v2 offset:6144
    ds_read_b64_tr_b16 a[158:159], v2 offset:6656
    v_mov_b32 v227, 0x40000000
    v_cmp_eq_u32 vcc, 0, v224
    v_nop
    v_nop
    v_cndmask_b32 v246, v246, v227, vcc
    v_mfma_f32_32x32x16_bf16 v[96:111], a[164:167], a[132:135], v[96:111]
    s_waitcnt lgkmcnt(8)
    ds_read_b64_tr_b16 a[160:161], v2 offset:8192
    ds_read_b64_tr_b16 a[162:163], v2 offset:8704
    v_mfma_f32_32x32x16_bf16 v[96:111], a[168:171], a[136:139], v[96:111]
    ds_read_b64_tr_b16 a[164:165], v2 offset:10240
    ds_read_b64_tr_b16 a[166:167], v2 offset:10752
    v_cmp_eq_u32 vcc, v227, v243
    v_nop
    v_nop
    v_cndmask_b32 v251, v251, v227, vcc
    v_add_u32 v224, 16, v224
    v_mfma_f32_32x32x16_bf16 v[96:111], a[172:175], a[140:143], v[96:111]
    s_waitcnt lgkmcnt(8)
    s_barrier
    ds_read_b64_tr_b16 a[168:169], v2 offset:12288
    ds_read_b64_tr_b16 a[170:171], v2 offset:12800
    v_mfma_f32_32x32x16_bf16 v[48:63], a[144:147], a[0:3], 0
    s_add_u32 m0, s68, 110592
    s_add_u32 s3, s70, 2654208
    ds_read_b64_tr_b16 a[172:173], v2 offset:14336
    ds_read_b64_tr_b16 a[174:175], v2 offset:14848
    buffer_load_dwordx4 v10, s[48:51], s3 offen offset:0 lds
    v_mfma_f32_32x32x16_bf16 v[48:63], a[148:151], a[4:7], v[48:63]
    s_waitcnt lgkmcnt(8)
    ds_read_b64_tr_b16 a[144:145], v2 offset:16384
    ds_read_b64_tr_b16 a[146:147], v2 offset:16896
    v_mul_f32 v216, v16, v16
    v_mul_f32 v217, v17, v17
    v_fma_f32 v216, v216, v15, v14
    v_mfma_f32_32x32x16_bf16 v[48:63], a[152:155], a[8:11], v[48:63]
    ds_read_b64_tr_b16 a[148:149], v2 offset:18432
    ds_read_b64_tr_b16 a[150:151], v2 offset:18944
    buffer_load_dwordx4 v11, s[48:51], s3 offen offset:1024 lds
    v_fma_f32 v217, v217, v15, v14
    v_mul_f32 v216, v16, v216
    v_mul_f32 v217, v17, v217
    v_mfma_f32_32x32x16_bf16 v[48:63], a[156:159], a[12:15], v[48:63]
    s_waitcnt lgkmcnt(8)
    s_lshl_b32 s97, s33, 2
    s_add_u32 s97, s97, s64
    s_mul_i32 s97, s97, 41
    ds_read_b64_tr_b16 a[152:153], v2 offset:20480
    ds_read_b64_tr_b16 a[154:155], v2 offset:20992
    v_mfma_f32_32x32x16_bf16 v[48:63], a[160:163], a[16:19], v[48:63]
    ds_read_b64_tr_b16 a[156:157], v2 offset:22528
    ds_read_b64_tr_b16 a[158:159], v2 offset:23040
    buffer_load_dwordx4 v12, s[48:51], s3 offen offset:2048 lds
    v_exp_f32 v216, v216
    v_mfma_f32_32x32x16_bf16 v[48:63], a[164:167], a[20:23], v[48:63]
    s_waitcnt lgkmcnt(8)
    ds_read_b64_tr_b16 a[160:161], v2 offset:24576
    ds_read_b64_tr_b16 a[162:163], v2 offset:25088
    v_add_u32 v228, s97, v0
    v_exp_f32 v217, v217
    v_mfma_f32_32x32x16_bf16 v[48:63], a[168:171], a[24:27], v[48:63]
    ds_read_b64_tr_b16 a[164:165], v2 offset:26624
    ds_read_b64_tr_b16 a[166:167], v2 offset:27136
    buffer_load_dwordx4 v13, s[48:51], s3 offen offset:3072 lds
    v_lshlrev_b32 v228, 7, v228
    v_mul_f32 v218, v16, v80
    v_mul_f32 v219, v17, v81
    v_mfma_f32_32x32x16_bf16 v[48:63], a[172:175], a[28:31], v[48:63]
    s_waitcnt lgkmcnt(8)
    ds_read_b64_tr_b16 a[168:169], v2 offset:28672
    ds_read_b64_tr_b16 a[170:171], v2 offset:29184
    v_mov_b32 v227, 0x40000000
    v_fma_f32 v216, v216, v254, v254
    v_fma_f32 v217, v217, v254, v254
    v_mfma_f32_32x32x16_bf16 v[48:63], a[144:147], a[32:35], v[48:63]
    s_add_u32 m0, s68, 114688
    s_add_u32 s3, s70, 2949120
    ds_read_b64_tr_b16 a[172:173], v2 offset:30720
    ds_read_b64_tr_b16 a[174:175], v2 offset:31232
    buffer_load_dwordx4 v10, s[48:51], s3 offen offset:0 lds
    v_mfma_f32_32x32x16_bf16 v[48:63], a[148:151], a[36:39], v[48:63]
    s_waitcnt lgkmcnt(8)
    ds_read_b64_tr_b16 a[144:145], v2 offset:32768
    ds_read_b64_tr_b16 a[146:147], v2 offset:33280
    v_rcp_f32 v216, v216
    v_mfma_f32_32x32x16_bf16 v[48:63], a[152:155], a[40:43], v[48:63]
    ds_read_b64_tr_b16 a[148:149], v2 offset:34816
    ds_read_b64_tr_b16 a[150:151], v2 offset:35328
    buffer_load_dwordx4 v11, s[48:51], s3 offen offset:1024 lds
    v_rcp_f32 v217, v217
    v_mul_f32 v218, v218, v216
    v_mfma_f32_32x32x16_bf16 v[48:63], a[156:159], a[44:47], v[48:63]
    s_waitcnt lgkmcnt(8)
    ds_read_b64_tr_b16 a[152:153], v6 offset:0
    ds_read_b64_tr_b16 a[154:155], v6 offset:512
    v_cmp_gt_u32 vcc, 41, v0
    v_nop
    v_nop
    v_cndmask_b32 v228, v227, v228, vcc
    v_mfma_f32_32x32x16_bf16 v[48:63], a[160:163], a[48:51], v[48:63]
    ds_read_b64_tr_b16 a[156:157], v6 offset:2048
    ds_read_b64_tr_b16 a[158:159], v6 offset:2560
    buffer_load_dwordx4 v12, s[48:51], s3 offen offset:2048 lds
    v_mul_f32 v219, v219, v217
    v_cvt_pk_bf16_f32 v144, v218, v219
    v_mul_f32 v220, v18, v18
    v_mfma_f32_32x32x16_bf16 v[48:63], a[164:167], a[52:55], v[48:63]
    s_waitcnt lgkmcnt(8)
    ds_read_b64_tr_b16 a[160:161], v6 offset:4096
    ds_read_b64_tr_b16 a[162:163], v6 offset:4608
    v_mul_f32 v221, v19, v19
    v_fma_f32 v220, v220, v15, v14
    v_fma_f32 v221, v221, v15, v14
    v_mfma_f32_32x32x16_bf16 v[48:63], a[168:171], a[56:59], v[48:63]
    s_and_b32 s97, s66, 7
    s_lshl_b32 s97, s97, 2
    s_add_u32 s97, s97, s64
    ds_read_b64_tr_b16 a[164:165], v6 offset:6144
    ds_read_b64_tr_b16 a[166:167], v6 offset:6656
    buffer_load_dwordx4 v13, s[48:51], s3 offen offset:3072 lds
    v_mfma_f32_32x32x16_bf16 v[48:63], a[172:175], a[60:63], v[48:63]
    s_waitcnt lgkmcnt(8)
    ds_read_b64_tr_b16 a[168:169], v6 offset:8192
    ds_read_b64_tr_b16 a[170:171], v6 offset:8704
    v_mul_f32 v220, v18, v220
    v_mul_f32 v221, v19, v221
    v_mfma_f32_32x32x16_bf16 v[48:63], a[144:147], a[64:67], v[48:63]
    s_add_u32 m0, s68, 118784
    s_add_u32 s3, s70, 3244032
    ds_read_b64_tr_b16 a[172:173], v6 offset:10240
    ds_read_b64_tr_b16 a[174:175], v6 offset:10752
    buffer_load_dwordx4 v10, s[48:51], s3 offen offset:0 lds
    v_mfma_f32_32x32x16_bf16 v[48:63], a[148:151], a[68:71], v[48:63]
    s_waitcnt lgkmcnt(8)
    ds_read_b64_tr_b16 a[144:145], v6 offset:12288
    ds_read_b64_tr_b16 a[146:147], v6 offset:12800
    v_exp_f32 v220, v220
    v_mfma_f32_32x32x16_bf16 v[64:79], a[152:155], a[0:3], 0
    s_and_b32 s96, s97, 15
    s_lshl_b32 s96, s96, 1
    s_add_u32 s96, s96, s38
    ds_read_b64_tr_b16 a[148:149], v6 offset:14336
    ds_read_b64_tr_b16 a[150:151], v6 offset:14848
    v_mfma_f32_32x32x16_bf16 v[64:79], a[156:159], a[4:7], v[64:79]
    s_waitcnt lgkmcnt(8)
    ds_read_b64_tr_b16 a[152:153], v6 offset:16384
    ds_read_b64_tr_b16 a[154:155], v6 offset:16896
    v_exp_f32 v221, v221
    v_mul_f32 v222, v18, v82
    v_mfma_f32_32x32x16_bf16 v[64:79], a[160:163], a[8:11], v[64:79]
    ds_read_b64_tr_b16 a[156:157], v6 offset:18432
    ds_read_b64_tr_b16 a[158:159], v6 offset:18944
    v_mul_f32 v223, v19, v83
    v_fma_f32 v220, v220, v254, v254
    v_fma_f32 v221, v221, v254, v254
    v_mfma_f32_32x32x16_bf16 v[64:79], a[164:167], a[12:15], v[64:79]
    s_waitcnt lgkmcnt(8)
    s_lshl_b32 s34, s65, 5
    s_add_u32 s96, s96, s34
    s_sub_u32 s34, 1024, s96
    ds_read_b64_tr_b16 a[160:161], v6 offset:20480
    ds_read_b64_tr_b16 a[162:163], v6 offset:20992
    v_mfma_f32_32x32x16_bf16 v[64:79], a[168:171], a[16:19], v[64:79]
    ds_read_b64_tr_b16 a[164:165], v6 offset:22528
    ds_read_b64_tr_b16 a[166:167], v6 offset:23040
    v_rcp_f32 v220, v220
    v_rcp_f32 v221, v221
    v_mfma_f32_32x32x16_bf16 v[64:79], a[172:175], a[20:23], v[64:79]
    s_waitcnt lgkmcnt(8)
    ds_read_b64_tr_b16 a[168:169], v6 offset:24576
    ds_read_b64_tr_b16 a[170:171], v6 offset:25088
    v_mul_f32 v222, v222, v220
    v_mul_f32 v223, v223, v221
    v_cvt_pk_bf16_f32 v145, v222, v223
    v_mfma_f32_32x32x16_bf16 v[64:79], a[144:147], a[24:27], v[64:79]
    s_cmp_lt_u32 s97, 16
    s_cselect_b32 s97, s96, s34
    s_lshl_b32 s97, s97, 12
    ds_read_b64_tr_b16 a[172:173], v6 offset:26624
    ds_read_b64_tr_b16 a[174:175], v6 offset:27136
    v_mul_f32 v216, v20, v20
    v_mfma_f32_32x32x16_bf16 v[64:79], a[148:151], a[28:31], v[64:79]
    s_waitcnt lgkmcnt(8)
    ds_read_b64_tr_b16 a[144:145], v6 offset:28672
    ds_read_b64_tr_b16 a[146:147], v6 offset:29184
    v_mul_f32 v217, v21, v21
    v_fma_f32 v216, v216, v15, v14
    v_fma_f32 v217, v217, v15, v14
    v_mfma_f32_32x32x16_bf16 v[64:79], a[152:155], a[32:35], v[64:79]
    ds_read_b64_tr_b16 a[148:149], v6 offset:30720
    ds_read_b64_tr_b16 a[150:151], v6 offset:31232
    v_lshlrev_b32 v229, 7, v0
    v_add_u32 v229, s97, v229
    v_mul_f32 v216, v20, v216
    v_mul_f32 v217, v21, v217
    v_mfma_f32_32x32x16_bf16 v[64:79], a[156:159], a[36:39], v[64:79]
    s_waitcnt lgkmcnt(8)
    ds_read_b64_tr_b16 a[152:153], v6 offset:32768
    ds_read_b64_tr_b16 a[154:155], v6 offset:33280
    v_exp_f32 v216, v216
    v_mfma_f32_32x32x16_bf16 v[64:79], a[160:163], a[40:43], v[64:79]
    ds_read_b64_tr_b16 a[156:157], v6 offset:34816
    ds_read_b64_tr_b16 a[158:159], v6 offset:35328
    v_exp_f32 v217, v217
    v_mul_f32 v218, v20, v84
    v_mul_f32 v219, v21, v85
    v_mfma_f32_32x32x16_bf16 v[64:79], a[164:167], a[44:47], v[64:79]
    s_waitcnt vmcnt(19)
    s_barrier
    s_waitcnt lgkmcnt(8)
    ds_read_b64_tr_b16 a[160:161], v3 offset:0
    ds_read_b64_tr_b16 a[162:163], v3 offset:512
    v_mfma_f32_32x32x16_bf16 v[64:79], a[168:171], a[48:51], v[64:79]
    ds_read_b64_tr_b16 a[164:165], v3 offset:2048
    ds_read_b64_tr_b16 a[166:167], v3 offset:2560
    v_cmp_gt_u32 vcc, 9, v0
    v_nop
    v_nop
    v_cndmask_b32 v229, v227, v229, vcc
    v_mfma_f32_32x32x16_bf16 v[64:79], a[172:175], a[52:55], v[64:79]
    s_waitcnt lgkmcnt(8)
    ds_read_b64_tr_b16 a[168:169], v3 offset:4096
    ds_read_b64_tr_b16 a[170:171], v3 offset:4608
    v_fma_f32 v216, v216, v254, v254
    v_fma_f32 v217, v217, v254, v254
    v_mfma_f32_32x32x16_bf16 v[64:79], a[144:147], a[56:59], v[64:79]
    ds_read_b64_tr_b16 a[172:173], v3 offset:6144
    ds_read_b64_tr_b16 a[174:175], v3 offset:6656
    v_rcp_f32 v216, v216
    v_rcp_f32 v217, v217
    v_mfma_f32_32x32x16_bf16 v[64:79], a[148:151], a[60:63], v[64:79]
    s_waitcnt lgkmcnt(8)
    ds_read_b64_tr_b16 a[144:145], v3 offset:8192
    ds_read_b64_tr_b16 a[146:147], v3 offset:8704
    v_mul_f32 v218, v218, v216
    v_mul_f32 v219, v219, v217
    v_cvt_pk_bf16_f32 v146, v218, v219
    v_mfma_f32_32x32x16_bf16 v[64:79], a[152:155], a[64:67], v[64:79]
    ds_read_b64_tr_b16 a[148:149], v3 offset:10240
    ds_read_b64_tr_b16 a[150:151], v3 offset:10752
    v_mul_f32 v220, v22, v22
    v_mul_f32 v221, v23, v23
    v_fma_f32 v220, v220, v15, v14
    v_fma_f32 v221, v221, v15, v14
    v_mfma_f32_32x32x16_bf16 v[64:79], a[156:159], a[68:71], v[64:79]
    s_waitcnt lgkmcnt(8)
    s_barrier
    ds_read_b64_tr_b16 a[152:153], v3 offset:12288
    ds_read_b64_tr_b16 a[154:155], v3 offset:12800
    v_mfma_f32_32x32x16_bf16 v[48:63], a[160:163], a[72:75], v[48:63]
    s_add_u32 m0, s68, 0
    s_add_u32 s3, s71, 0
    ds_read_b64_tr_b16 a[156:157], v3 offset:14336
    ds_read_b64_tr_b16 a[158:159], v3 offset:14848
    buffer_load_dwordx4 v10, s[44:47], s3 offen offset:0 lds
    v_mul_f32 v220, v22, v220
    v_mfma_f32_32x32x16_bf16 v[48:63], a[164:167], a[76:79], v[48:63]
    s_waitcnt lgkmcnt(8)
    ds_read_b64_tr_b16 a[160:161], v3 offset:16384
    ds_read_b64_tr_b16 a[162:163], v3 offset:16896
    v_mul_f32 v221, v23, v221
    v_exp_f32 v220, v220
    v_mfma_f32_32x32x16_bf16 v[48:63], a[168:171], a[80:83], v[48:63]
    ds_read_b64_tr_b16 a[164:165], v3 offset:18432
    ds_read_b64_tr_b16 a[166:167], v3 offset:18944
    buffer_load_dwordx4 v11, s[44:47], s3 offen offset:1024 lds
    v_exp_f32 v221, v221
    v_mul_f32 v222, v22, v86
    v_mfma_f32_32x32x16_bf16 v[48:63], a[172:175], a[84:87], v[48:63]
    s_waitcnt lgkmcnt(8)
    ds_read_b64_tr_b16 a[168:169], v3 offset:20480
    ds_read_b64_tr_b16 a[170:171], v3 offset:20992
    v_mul_f32 v223, v23, v87
    v_fma_f32 v220, v220, v254, v254
    v_fma_f32 v221, v221, v254, v254
    v_mfma_f32_32x32x16_bf16 v[48:63], a[144:147], a[88:91], v[48:63]
    ds_read_b64_tr_b16 a[172:173], v3 offset:22528
    ds_read_b64_tr_b16 a[174:175], v3 offset:23040
    buffer_load_dwordx4 v12, s[44:47], s3 offen offset:2048 lds
    v_rcp_f32 v220, v220
    v_mfma_f32_32x32x16_bf16 v[48:63], a[148:151], a[92:95], v[48:63]
    s_waitcnt lgkmcnt(8)
    ds_read_b64_tr_b16 a[144:145], v3 offset:24576
    ds_read_b64_tr_b16 a[146:147], v3 offset:25088
    v_rcp_f32 v221, v221
    v_mul_f32 v222, v222, v220
    v_mfma_f32_32x32x16_bf16 v[48:63], a[152:155], a[96:99], v[48:63]
    ds_read_b64_tr_b16 a[148:149], v3 offset:26624
    ds_read_b64_tr_b16 a[150:151], v3 offset:27136
    buffer_load_dwordx4 v13, s[44:47], s3 offen offset:3072 lds
    v_mul_f32 v223, v223, v221
    v_cvt_pk_bf16_f32 v147, v222, v223
    v_mul_f32 v216, v24, v24
    v_mfma_f32_32x32x16_bf16 v[48:63], a[156:159], a[100:103], v[48:63]
    s_waitcnt lgkmcnt(8)
    ds_read_b64_tr_b16 a[152:153], v3 offset:28672
    ds_read_b64_tr_b16 a[154:155], v3 offset:29184
    v_mul_f32 v217, v25, v25
    v_fma_f32 v216, v216, v15, v14
    v_fma_f32 v217, v217, v15, v14
    v_mfma_f32_32x32x16_bf16 v[48:63], a[160:163], a[104:107], v[48:63]
    s_add_u32 m0, s68, 4096
    s_add_u32 s3, s71, 294912
    ds_read_b64_tr_b16 a[156:157], v3 offset:30720
    ds_read_b64_tr_b16 a[158:159], v3 offset:31232
    buffer_load_dwordx4 v10, s[44:47], s3 offen offset:0 lds
    v_mul_f32 v216, v24, v216
    v_mfma_f32_32x32x16_bf16 v[48:63], a[164:167], a[108:111], v[48:63]
    s_waitcnt lgkmcnt(8)
    ds_read_b64_tr_b16 a[160:161], v3 offset:32768
    ds_read_b64_tr_b16 a[162:163], v3 offset:33280
    v_mul_f32 v217, v25, v217
    v_exp_f32 v216, v216
    v_mfma_f32_32x32x16_bf16 v[48:63], a[168:171], a[112:115], v[48:63]
    ds_read_b64_tr_b16 a[164:165], v3 offset:34816
    ds_read_b64_tr_b16 a[166:167], v3 offset:35328
    buffer_load_dwordx4 v11, s[44:47], s3 offen offset:1024 lds
    v_exp_f32 v217, v217
    v_mul_f32 v218, v24, v88
    v_mfma_f32_32x32x16_bf16 v[48:63], a[172:175], a[116:119], v[48:63]
    s_waitcnt lgkmcnt(8)
    ds_read_b64_tr_b16 a[168:169], v7 offset:0
    ds_read_b64_tr_b16 a[170:171], v7 offset:512
    v_mul_f32 v219, v25, v89
    v_fma_f32 v216, v216, v254, v254
    v_fma_f32 v217, v217, v254, v254
    v_mfma_f32_32x32x16_bf16 v[48:63], a[144:147], a[120:123], v[48:63]
    ds_read_b64_tr_b16 a[172:173], v7 offset:2048
    ds_read_b64_tr_b16 a[174:175], v7 offset:2560
    buffer_load_dwordx4 v12, s[44:47], s3 offen offset:2048 lds
    v_rcp_f32 v216, v216
    v_mfma_f32_32x32x16_bf16 v[48:63], a[148:151], a[124:127], v[48:63]
    s_waitcnt lgkmcnt(8)
    ds_read_b64_tr_b16 a[144:145], v7 offset:4096
    ds_read_b64_tr_b16 a[146:147], v7 offset:4608
    v_rcp_f32 v217, v217
    v_mul_f32 v218, v218, v216
    v_mfma_f32_32x32x16_bf16 v[48:63], a[152:155], a[128:131], v[48:63]
    ds_read_b64_tr_b16 a[148:149], v7 offset:6144
    ds_read_b64_tr_b16 a[150:151], v7 offset:6656
    buffer_load_dwordx4 v13, s[44:47], s3 offen offset:3072 lds
    v_mul_f32 v219, v219, v217
    v_cvt_pk_bf16_f32 v148, v218, v219
    v_mul_f32 v220, v26, v26
    v_mfma_f32_32x32x16_bf16 v[48:63], a[156:159], a[132:135], v[48:63]
    s_waitcnt lgkmcnt(8)
    ds_read_b64_tr_b16 a[152:153], v7 offset:8192
    ds_read_b64_tr_b16 a[154:155], v7 offset:8704
    v_mul_f32 v221, v27, v27
    v_fma_f32 v220, v220, v15, v14
    v_fma_f32 v221, v221, v15, v14
    v_mfma_f32_32x32x16_bf16 v[48:63], a[160:163], a[136:139], v[48:63]
    s_add_u32 m0, s68, 8192
    s_add_u32 s3, s71, 589824
    ds_read_b64_tr_b16 a[156:157], v7 offset:10240
    ds_read_b64_tr_b16 a[158:159], v7 offset:10752
    buffer_load_dwordx4 v10, s[44:47], s3 offen offset:0 lds
    v_mul_f32 v220, v26, v220
    v_mfma_f32_32x32x16_bf16 v[48:63], a[164:167], a[140:143], v[48:63]
    s_waitcnt lgkmcnt(8)
    ds_read_b64_tr_b16 a[160:161], v7 offset:12288
    ds_read_b64_tr_b16 a[162:163], v7 offset:12800
    v_mul_f32 v221, v27, v221
    v_exp_f32 v220, v220
    v_mfma_f32_32x32x16_bf16 v[64:79], a[168:171], a[72:75], v[64:79]
    ds_read_b64_tr_b16 a[164:165], v7 offset:14336
    ds_read_b64_tr_b16 a[166:167], v7 offset:14848
    v_exp_f32 v221, v221
    v_mul_f32 v222, v26, v90
    v_mul_f32 v223, v27, v91
    v_mfma_f32_32x32x16_bf16 v[64:79], a[172:175], a[76:79], v[64:79]
    s_waitcnt lgkmcnt(8)
    ds_read_b64_tr_b16 a[168:169], v7 offset:16384
    ds_read_b64_tr_b16 a[170:171], v7 offset:16896
    v_fma_f32 v220, v220, v254, v254
    v_fma_f32 v221, v221, v254, v254
    v_mfma_f32_32x32x16_bf16 v[64:79], a[144:147], a[80:83], v[64:79]
    ds_read_b64_tr_b16 a[172:173], v7 offset:18432
    ds_read_b64_tr_b16 a[174:175], v7 offset:18944
    v_rcp_f32 v220, v220
    v_rcp_f32 v221, v221
    v_mfma_f32_32x32x16_bf16 v[64:79], a[148:151], a[84:87], v[64:79]
    s_waitcnt lgkmcnt(8)
    ds_read_b64_tr_b16 a[144:145], v7 offset:20480
    ds_read_b64_tr_b16 a[146:147], v7 offset:20992
    v_mul_f32 v222, v222, v220
    v_mul_f32 v223, v223, v221
    v_cvt_pk_bf16_f32 v149, v222, v223
    v_mfma_f32_32x32x16_bf16 v[64:79], a[152:155], a[88:91], v[64:79]
    ds_read_b64_tr_b16 a[148:149], v7 offset:22528
    ds_read_b64_tr_b16 a[150:151], v7 offset:23040
    v_mul_f32 v216, v28, v28
    v_mul_f32 v217, v29, v29
    v_fma_f32 v216, v216, v15, v14
    v_fma_f32 v217, v217, v15, v14
    v_mfma_f32_32x32x16_bf16 v[64:79], a[156:159], a[92:95], v[64:79]
    s_waitcnt lgkmcnt(8)
    ds_read_b64_tr_b16 a[152:153], v7 offset:24576
    ds_read_b64_tr_b16 a[154:155], v7 offset:25088
    v_mul_f32 v216, v28, v216
    v_mul_f32 v217, v29, v217
    v_mfma_f32_32x32x16_bf16 v[64:79], a[160:163], a[96:99], v[64:79]
    ds_read_b64_tr_b16 a[156:157], v7 offset:26624
    ds_read_b64_tr_b16 a[158:159], v7 offset:27136
    v_exp_f32 v216, v216
    v_exp_f32 v217, v217
    v_mfma_f32_32x32x16_bf16 v[64:79], a[164:167], a[100:103], v[64:79]
    s_waitcnt lgkmcnt(8)
    ds_read_b64_tr_b16 a[160:161], v7 offset:28672
    ds_read_b64_tr_b16 a[162:163], v7 offset:29184
    v_mul_f32 v218, v28, v92
    v_mul_f32 v219, v29, v93
    v_fma_f32 v216, v216, v254, v254
    v_mfma_f32_32x32x16_bf16 v[64:79], a[168:171], a[104:107], v[64:79]
    ds_read_b64_tr_b16 a[164:165], v7 offset:30720
    ds_read_b64_tr_b16 a[166:167], v7 offset:31232
    v_fma_f32 v217, v217, v254, v254
    v_rcp_f32 v216, v216
    v_mfma_f32_32x32x16_bf16 v[64:79], a[172:175], a[108:111], v[64:79]
    s_waitcnt lgkmcnt(8)
    ds_read_b64_tr_b16 a[168:169], v7 offset:32768
    ds_read_b64_tr_b16 a[170:171], v7 offset:33280
    v_rcp_f32 v217, v217
    v_mul_f32 v218, v218, v216
    v_mfma_f32_32x32x16_bf16 v[64:79], a[144:147], a[112:115], v[64:79]
    ds_read_b64_tr_b16 a[172:173], v7 offset:34816
    ds_read_b64_tr_b16 a[174:175], v7 offset:35328
    v_mul_f32 v219, v219, v217
    v_cvt_pk_bf16_f32 v150, v218, v219
    v_mul_f32 v220, v30, v30
    v_mul_f32 v221, v31, v31
    v_mfma_f32_32x32x16_bf16 v[64:79], a[148:151], a[116:119], v[64:79]
    s_waitcnt vmcnt(18)
    s_barrier
    s_waitcnt lgkmcnt(8)
    ds_read_b64_tr_b16 a[144:145], v4 offset:0
    ds_read_b64_tr_b16 a[146:147], v4 offset:512
    v_mfma_f32_32x32x16_bf16 v[64:79], a[152:155], a[120:123], v[64:79]
    ds_read_b64_tr_b16 a[148:149], v4 offset:2048
    ds_read_b64_tr_b16 a[150:151], v4 offset:2560
    v_fma_f32 v220, v220, v15, v14
    v_fma_f32 v221, v221, v15, v14
    v_mul_f32 v220, v30, v220
    v_mul_f32 v221, v31, v221
    v_mfma_f32_32x32x16_bf16 v[64:79], a[156:159], a[124:127], v[64:79]
    s_waitcnt lgkmcnt(8)
    ds_read_b64_tr_b16 a[152:153], v4 offset:4096
    ds_read_b64_tr_b16 a[154:155], v4 offset:4608
    v_exp_f32 v220, v220
    v_mfma_f32_32x32x16_bf16 v[64:79], a[160:163], a[128:131], v[64:79]
    ds_read_b64_tr_b16 a[156:157], v4 offset:6144
    ds_read_b64_tr_b16 a[158:159], v4 offset:6656
    v_exp_f32 v221, v221
    v_mul_f32 v222, v30, v94
    v_mul_f32 v223, v31, v95
    v_mfma_f32_32x32x16_bf16 v[64:79], a[164:167], a[132:135], v[64:79]
    s_waitcnt lgkmcnt(8)
    ds_read_b64_tr_b16 a[160:161], v4 offset:8192
    ds_read_b64_tr_b16 a[162:163], v4 offset:8704
    v_fma_f32 v220, v220, v254, v254
    v_fma_f32 v221, v221, v254, v254
    v_mfma_f32_32x32x16_bf16 v[64:79], a[168:171], a[136:139], v[64:79]
    ds_read_b64_tr_b16 a[164:165], v4 offset:10240
    ds_read_b64_tr_b16 a[166:167], v4 offset:10752
    v_rcp_f32 v220, v220
    v_rcp_f32 v221, v221
    v_mfma_f32_32x32x16_bf16 v[64:79], a[172:175], a[140:143], v[64:79]
    s_waitcnt lgkmcnt(8)
    s_barrier
    ds_read_b64_tr_b16 a[168:169], v4 offset:12288
    ds_read_b64_tr_b16 a[170:171], v4 offset:12800
    v_mfma_f32_32x32x16_bf16 v[112:127], a[144:147], a[0:3], 0
    s_add_u32 m0, s68, 36864
    s_add_u32 s3, s71, 2654208
    ds_read_b64_tr_b16 a[172:173], v4 offset:14336
    ds_read_b64_tr_b16 a[174:175], v4 offset:14848
    buffer_load_dwordx4 v10, s[44:47], s3 offen offset:0 lds
    v_mul_f32 v222, v222, v220
    v_mul_f32 v223, v223, v221
    v_cvt_pk_bf16_f32 v151, v222, v223
    v_mfma_f32_32x32x16_bf16 v[112:127], a[148:151], a[4:7], v[112:127]
    s_waitcnt lgkmcnt(8)
    s_add_u32 s34, s32, 0
    ds_read_b64_tr_b16 a[144:145], v4 offset:16384
    ds_read_b64_tr_b16 a[146:147], v4 offset:16896
    v_mfma_f32_32x32x16_bf16 v[112:127], a[152:155], a[8:11], v[112:127]
    ds_read_b64_tr_b16 a[148:149], v4 offset:18432
    ds_read_b64_tr_b16 a[150:151], v4 offset:18944
    buffer_load_dwordx4 v11, s[44:47], s3 offen offset:1024 lds
    buffer_store_dwordx4 v[144:147], v1, s[56:59], s34 offen sc1
    v_mfma_f32_32x32x16_bf16 v[112:127], a[156:159], a[12:15], v[112:127]
    s_waitcnt lgkmcnt(8)
    ds_read_b64_tr_b16 a[152:153], v4 offset:20480
    ds_read_b64_tr_b16 a[154:155], v4 offset:20992
    v_mfma_f32_32x32x16_bf16 v[112:127], a[160:163], a[16:19], v[112:127]
    ds_read_b64_tr_b16 a[156:157], v4 offset:22528
    ds_read_b64_tr_b16 a[158:159], v4 offset:23040
    buffer_load_dwordx4 v12, s[44:47], s3 offen offset:2048 lds
    buffer_store_dwordx4 v[148:151], v1, s[56:59], s34 offen offset:1024 sc1
    v_mfma_f32_32x32x16_bf16 v[112:127], a[164:167], a[20:23], v[112:127]
    s_waitcnt lgkmcnt(8)
    ds_read_b64_tr_b16 a[160:161], v4 offset:24576
    ds_read_b64_tr_b16 a[162:163], v4 offset:25088
    v_mul_f32 v216, v32, v32
    v_mul_f32 v217, v33, v33
    v_fma_f32 v216, v216, v15, v14
    v_mfma_f32_32x32x16_bf16 v[112:127], a[168:171], a[24:27], v[112:127]
    ds_read_b64_tr_b16 a[164:165], v4 offset:26624
    ds_read_b64_tr_b16 a[166:167], v4 offset:27136
    buffer_load_dwordx4 v13, s[44:47], s3 offen offset:3072 lds
    v_fma_f32 v217, v217, v15, v14
    v_mul_f32 v216, v32, v216
    v_mfma_f32_32x32x16_bf16 v[112:127], a[172:175], a[28:31], v[112:127]
    s_waitcnt lgkmcnt(8)
    ds_read_b64_tr_b16 a[168:169], v4 offset:28672
    ds_read_b64_tr_b16 a[170:171], v4 offset:29184
    v_mul_f32 v217, v33, v217
    v_exp_f32 v216, v216
    v_mfma_f32_32x32x16_bf16 v[112:127], a[144:147], a[32:35], v[112:127]
    s_add_u32 m0, s68, 40960
    s_add_u32 s3, s71, 2949120
    ds_read_b64_tr_b16 a[172:173], v4 offset:30720
    ds_read_b64_tr_b16 a[174:175], v4 offset:31232
    buffer_load_dwordx4 v10, s[44:47], s3 offen offset:0 lds
    v_mfma_f32_32x32x16_bf16 v[112:127], a[148:151], a[36:39], v[112:127]
    s_waitcnt lgkmcnt(8)
    ds_read_b64_tr_b16 a[144:145], v4 offset:32768
    ds_read_b64_tr_b16 a[146:147], v4 offset:33280
    v_exp_f32 v217, v217
    v_mul_f32 v218, v32, v96
    v_mfma_f32_32x32x16_bf16 v[112:127], a[152:155], a[40:43], v[112:127]
    ds_read_b64_tr_b16 a[148:149], v4 offset:34816
    ds_read_b64_tr_b16 a[150:151], v4 offset:35328
    buffer_load_dwordx4 v11, s[44:47], s3 offen offset:1024 lds
    v_mul_f32 v219, v33, v97
    v_fma_f32 v216, v216, v254, v254
    v_fma_f32 v217, v217, v254, v254
    v_mfma_f32_32x32x16_bf16 v[112:127], a[156:159], a[44:47], v[112:127]
    s_waitcnt lgkmcnt(8)
    ds_read_b64_tr_b16 a[152:153], v8 offset:0
    ds_read_b64_tr_b16 a[154:155], v8 offset:512
    v_rcp_f32 v216, v216
    v_mfma_f32_32x32x16_bf16 v[112:127], a[160:163], a[48:51], v[112:127]
    ds_read_b64_tr_b16 a[156:157], v8 offset:2048
    ds_read_b64_tr_b16 a[158:159], v8 offset:2560
    buffer_load_dwordx4 v12, s[44:47], s3 offen offset:2048 lds
    v_rcp_f32 v217, v217
    v_mul_f32 v218, v218, v216
    v_mfma_f32_32x32x16_bf16 v[112:127], a[164:167], a[52:55], v[112:127]
    s_waitcnt lgkmcnt(8)
    ds_read_b64_tr_b16 a[160:161], v8 offset:4096
    ds_read_b64_tr_b16 a[162:163], v8 offset:4608
    v_mul_f32 v219, v219, v217
    v_cvt_pk_bf16_f32 v152, v218, v219
    v_mul_f32 v220, v34, v34
    v_mfma_f32_32x32x16_bf16 v[112:127], a[168:171], a[56:59], v[112:127]
    ds_read_b64_tr_b16 a[164:165], v8 offset:6144
    ds_read_b64_tr_b16 a[166:167], v8 offset:6656
    buffer_load_dwordx4 v13, s[44:47], s3 offen offset:3072 lds
    v_mul_f32 v221, v35, v35
    v_fma_f32 v220, v220, v15, v14
    v_fma_f32 v221, v221, v15, v14
    v_mfma_f32_32x32x16_bf16 v[112:127], a[172:175], a[60:63], v[112:127]
    s_waitcnt lgkmcnt(8)
    ds_read_b64_tr_b16 a[168:169], v8 offset:8192
    ds_read_b64_tr_b16 a[170:171], v8 offset:8704
    v_mul_f32 v220, v34, v220
    v_mul_f32 v221, v35, v221
    v_mfma_f32_32x32x16_bf16 v[112:127], a[144:147], a[64:67], v[112:127]
    s_add_u32 m0, s68, 45056
    s_add_u32 s3, s71, 3244032
    ds_read_b64_tr_b16 a[172:173], v8 offset:10240
    ds_read_b64_tr_b16 a[174:175], v8 offset:10752
    buffer_load_dwordx4 v10, s[44:47], s3 offen offset:0 lds
    v_mfma_f32_32x32x16_bf16 v[112:127], a[148:151], a[68:71], v[112:127]
    s_waitcnt lgkmcnt(8)
    ds_read_b64_tr_b16 a[144:145], v8 offset:12288
    ds_read_b64_tr_b16 a[146:147], v8 offset:12800
    v_exp_f32 v220, v220
    v_mfma_f32_32x32x16_bf16 v[128:143], a[152:155], a[0:3], 0
    ds_read_b64_tr_b16 a[148:149], v8 offset:14336
    ds_read_b64_tr_b16 a[150:151], v8 offset:14848
    buffer_load_dword v252, v228, s[52:55], 0 offen
    v_exp_f32 v221, v221
    v_mul_f32 v222, v34, v98
    v_mfma_f32_32x32x16_bf16 v[128:143], a[156:159], a[4:7], v[128:143]
    s_waitcnt lgkmcnt(8)
    ds_read_b64_tr_b16 a[152:153], v8 offset:16384
    ds_read_b64_tr_b16 a[154:155], v8 offset:16896
    v_mul_f32 v223, v35, v99
    v_fma_f32 v220, v220, v254, v254
    v_fma_f32 v221, v221, v254, v254
    v_mfma_f32_32x32x16_bf16 v[128:143], a[160:163], a[8:11], v[128:143]
    ds_read_b64_tr_b16 a[156:157], v8 offset:18432
    ds_read_b64_tr_b16 a[158:159], v8 offset:18944
    v_rcp_f32 v220, v220
    v_rcp_f32 v221, v221
    v_mfma_f32_32x32x16_bf16 v[128:143], a[164:167], a[12:15], v[128:143]
    s_waitcnt lgkmcnt(8)
    ds_read_b64_tr_b16 a[160:161], v8 offset:20480
    ds_read_b64_tr_b16 a[162:163], v8 offset:20992
    v_mul_f32 v222, v222, v220
    v_mul_f32 v223, v223, v221
    v_cvt_pk_bf16_f32 v153, v222, v223
    v_mfma_f32_32x32x16_bf16 v[128:143], a[168:171], a[16:19], v[128:143]
    ds_read_b64_tr_b16 a[164:165], v8 offset:22528
    ds_read_b64_tr_b16 a[166:167], v8 offset:23040
    v_mul_f32 v216, v36, v36
    v_mul_f32 v217, v37, v37
    v_fma_f32 v216, v216, v15, v14
    v_fma_f32 v217, v217, v15, v14
    v_mfma_f32_32x32x16_bf16 v[128:143], a[172:175], a[20:23], v[128:143]
    s_waitcnt lgkmcnt(8)
    ds_read_b64_tr_b16 a[168:169], v8 offset:24576
    ds_read_b64_tr_b16 a[170:171], v8 offset:25088
    v_mul_f32 v216, v36, v216
    v_mul_f32 v217, v37, v217
    v_mfma_f32_32x32x16_bf16 v[128:143], a[144:147], a[24:27], v[128:143]
    ds_read_b64_tr_b16 a[172:173], v8 offset:26624
    ds_read_b64_tr_b16 a[174:175], v8 offset:27136
    v_exp_f32 v216, v216
    v_exp_f32 v217, v217
    v_mfma_f32_32x32x16_bf16 v[128:143], a[148:151], a[28:31], v[128:143]
    s_waitcnt lgkmcnt(8)
    ds_read_b64_tr_b16 a[144:145], v8 offset:28672
    ds_read_b64_tr_b16 a[146:147], v8 offset:29184
    v_mul_f32 v218, v36, v100
    v_mul_f32 v219, v37, v101
    v_fma_f32 v216, v216, v254, v254
    v_mfma_f32_32x32x16_bf16 v[128:143], a[152:155], a[32:35], v[128:143]
    ds_read_b64_tr_b16 a[148:149], v8 offset:30720
    ds_read_b64_tr_b16 a[150:151], v8 offset:31232
    v_fma_f32 v217, v217, v254, v254
    v_rcp_f32 v216, v216
    v_mfma_f32_32x32x16_bf16 v[128:143], a[156:159], a[36:39], v[128:143]
    s_waitcnt lgkmcnt(8)
    ds_read_b64_tr_b16 a[152:153], v8 offset:32768
    ds_read_b64_tr_b16 a[154:155], v8 offset:33280
    v_rcp_f32 v217, v217
    v_mul_f32 v218, v218, v216
    v_mfma_f32_32x32x16_bf16 v[128:143], a[160:163], a[40:43], v[128:143]
    ds_read_b64_tr_b16 a[156:157], v8 offset:34816
    ds_read_b64_tr_b16 a[158:159], v8 offset:35328
    v_mul_f32 v219, v219, v217
    v_cvt_pk_bf16_f32 v154, v218, v219
    v_mul_f32 v220, v38, v38
    v_mul_f32 v221, v39, v39
    v_mfma_f32_32x32x16_bf16 v[128:143], a[164:167], a[44:47], v[128:143]
    s_waitcnt vmcnt(21)
    s_barrier
    s_waitcnt lgkmcnt(8)
    ds_read_b64_tr_b16 a[160:161], v5 offset:0
    ds_read_b64_tr_b16 a[162:163], v5 offset:512
    v_mfma_f32_32x32x16_bf16 v[128:143], a[168:171], a[48:51], v[128:143]
    ds_read_b64_tr_b16 a[164:165], v5 offset:2048
    ds_read_b64_tr_b16 a[166:167], v5 offset:2560
    v_fma_f32 v220, v220, v15, v14
    v_fma_f32 v221, v221, v15, v14
    v_mul_f32 v220, v38, v220
    v_mul_f32 v221, v39, v221
    v_mfma_f32_32x32x16_bf16 v[128:143], a[172:175], a[52:55], v[128:143]
    s_waitcnt lgkmcnt(8)
    ds_read_b64_tr_b16 a[168:169], v5 offset:4096
    ds_read_b64_tr_b16 a[170:171], v5 offset:4608
    v_exp_f32 v220, v220
    v_mfma_f32_32x32x16_bf16 v[128:143], a[144:147], a[56:59], v[128:143]
    ds_read_b64_tr_b16 a[172:173], v5 offset:6144
    ds_read_b64_tr_b16 a[174:175], v5 offset:6656
    v_exp_f32 v221, v221
    v_mul_f32 v222, v38, v102
    v_mul_f32 v223, v39, v103
    v_mfma_f32_32x32x16_bf16 v[128:143], a[148:151], a[60:63], v[128:143]
    s_waitcnt lgkmcnt(8)
    ds_read_b64_tr_b16 a[144:145], v5 offset:8192
    ds_read_b64_tr_b16 a[146:147], v5 offset:8704
    v_fma_f32 v220, v220, v254, v254
    v_fma_f32 v221, v221, v254, v254
    v_mfma_f32_32x32x16_bf16 v[128:143], a[152:155], a[64:67], v[128:143]
    ds_read_b64_tr_b16 a[148:149], v5 offset:10240
    ds_read_b64_tr_b16 a[150:151], v5 offset:10752
    v_rcp_f32 v220, v220
    v_rcp_f32 v221, v221
    v_mfma_f32_32x32x16_bf16 v[128:143], a[156:159], a[68:71], v[128:143]
    s_waitcnt lgkmcnt(8)
    s_barrier
    ds_read_b64_tr_b16 a[152:153], v5 offset:12288
    ds_read_b64_tr_b16 a[154:155], v5 offset:12800
    v_mfma_f32_32x32x16_bf16 v[112:127], a[160:163], a[72:75], v[112:127]
    s_add_u32 m0, s68, 73728
    s_add_u32 s3, s71, 0
    ds_read_b64_tr_b16 a[156:157], v5 offset:14336
    ds_read_b64_tr_b16 a[158:159], v5 offset:14848
    buffer_load_dwordx4 v10, s[48:51], s3 offen offset:0 lds
    v_mul_f32 v222, v222, v220
    v_mfma_f32_32x32x16_bf16 v[112:127], a[164:167], a[76:79], v[112:127]
    s_waitcnt lgkmcnt(8)
    ds_read_b64_tr_b16 a[160:161], v5 offset:16384
    ds_read_b64_tr_b16 a[162:163], v5 offset:16896
    v_mul_f32 v223, v223, v221
    v_cvt_pk_bf16_f32 v155, v222, v223
    v_mul_f32 v216, v40, v40
    v_mfma_f32_32x32x16_bf16 v[112:127], a[168:171], a[80:83], v[112:127]
    ds_read_b64_tr_b16 a[164:165], v5 offset:18432
    ds_read_b64_tr_b16 a[166:167], v5 offset:18944
    buffer_load_dwordx4 v11, s[48:51], s3 offen offset:1024 lds
    v_mul_f32 v217, v41, v41
    v_fma_f32 v216, v216, v15, v14
    v_fma_f32 v217, v217, v15, v14
    v_mfma_f32_32x32x16_bf16 v[112:127], a[172:175], a[84:87], v[112:127]
    s_waitcnt lgkmcnt(8)
    ds_read_b64_tr_b16 a[168:169], v5 offset:20480
    ds_read_b64_tr_b16 a[170:171], v5 offset:20992
    v_mul_f32 v216, v40, v216
    v_mul_f32 v217, v41, v217
    v_mfma_f32_32x32x16_bf16 v[112:127], a[144:147], a[88:91], v[112:127]
    ds_read_b64_tr_b16 a[172:173], v5 offset:22528
    ds_read_b64_tr_b16 a[174:175], v5 offset:23040
    buffer_load_dwordx4 v12, s[48:51], s3 offen offset:2048 lds
    v_exp_f32 v216, v216
    v_mfma_f32_32x32x16_bf16 v[112:127], a[148:151], a[92:95], v[112:127]
    s_waitcnt lgkmcnt(8)
    ds_read_b64_tr_b16 a[144:145], v5 offset:24576
    ds_read_b64_tr_b16 a[146:147], v5 offset:25088
    v_exp_f32 v217, v217
    v_mul_f32 v218, v40, v104
    v_mfma_f32_32x32x16_bf16 v[112:127], a[152:155], a[96:99], v[112:127]
    ds_read_b64_tr_b16 a[148:149], v5 offset:26624
    ds_read_b64_tr_b16 a[150:151], v5 offset:27136
    buffer_load_dwordx4 v13, s[48:51], s3 offen offset:3072 lds
    v_mul_f32 v219, v41, v105
    v_fma_f32 v216, v216, v254, v254
    v_fma_f32 v217, v217, v254, v254
    v_mfma_f32_32x32x16_bf16 v[112:127], a[156:159], a[100:103], v[112:127]
    s_waitcnt lgkmcnt(8)
    ds_read_b64_tr_b16 a[152:153], v5 offset:28672
    ds_read_b64_tr_b16 a[154:155], v5 offset:29184
    v_rcp_f32 v216, v216
    v_mfma_f32_32x32x16_bf16 v[112:127], a[160:163], a[104:107], v[112:127]
    s_add_u32 m0, s68, 77824
    s_add_u32 s3, s71, 294912
    ds_read_b64_tr_b16 a[156:157], v5 offset:30720
    ds_read_b64_tr_b16 a[158:159], v5 offset:31232
    buffer_load_dwordx4 v10, s[48:51], s3 offen offset:0 lds
    v_mfma_f32_32x32x16_bf16 v[112:127], a[164:167], a[108:111], v[112:127]
    s_waitcnt lgkmcnt(8)
    ds_read_b64_tr_b16 a[160:161], v5 offset:32768
    ds_read_b64_tr_b16 a[162:163], v5 offset:33280
    v_rcp_f32 v217, v217
    v_mul_f32 v218, v218, v216
    v_mfma_f32_32x32x16_bf16 v[112:127], a[168:171], a[112:115], v[112:127]
    ds_read_b64_tr_b16 a[164:165], v5 offset:34816
    ds_read_b64_tr_b16 a[166:167], v5 offset:35328
    buffer_load_dwordx4 v11, s[48:51], s3 offen offset:1024 lds
    v_mul_f32 v219, v219, v217
    v_cvt_pk_bf16_f32 v156, v218, v219
    v_mul_f32 v220, v42, v42
    v_mfma_f32_32x32x16_bf16 v[112:127], a[172:175], a[116:119], v[112:127]
    s_waitcnt lgkmcnt(8)
    ds_read_b64_tr_b16 a[168:169], v9 offset:0
    ds_read_b64_tr_b16 a[170:171], v9 offset:512
    v_mul_f32 v221, v43, v43
    v_fma_f32 v220, v220, v15, v14
    v_fma_f32 v221, v221, v15, v14
    v_mfma_f32_32x32x16_bf16 v[112:127], a[144:147], a[120:123], v[112:127]
    ds_read_b64_tr_b16 a[172:173], v9 offset:2048
    ds_read_b64_tr_b16 a[174:175], v9 offset:2560
    buffer_load_dwordx4 v12, s[48:51], s3 offen offset:2048 lds
    v_mul_f32 v220, v42, v220
    v_mul_f32 v221, v43, v221
    v_mfma_f32_32x32x16_bf16 v[112:127], a[148:151], a[124:127], v[112:127]
    s_waitcnt lgkmcnt(8)
    ds_read_b64_tr_b16 a[144:145], v9 offset:4096
    ds_read_b64_tr_b16 a[146:147], v9 offset:4608
    v_exp_f32 v220, v220
    v_mfma_f32_32x32x16_bf16 v[112:127], a[152:155], a[128:131], v[112:127]
    ds_read_b64_tr_b16 a[148:149], v9 offset:6144
    ds_read_b64_tr_b16 a[150:151], v9 offset:6656
    buffer_load_dwordx4 v13, s[48:51], s3 offen offset:3072 lds
    v_exp_f32 v221, v221
    v_mul_f32 v222, v42, v106
    v_mfma_f32_32x32x16_bf16 v[112:127], a[156:159], a[132:135], v[112:127]
    s_waitcnt lgkmcnt(8)
    ds_read_b64_tr_b16 a[152:153], v9 offset:8192
    ds_read_b64_tr_b16 a[154:155], v9 offset:8704
    v_mul_f32 v223, v43, v107
    v_fma_f32 v220, v220, v254, v254
    v_fma_f32 v221, v221, v254, v254
    v_mfma_f32_32x32x16_bf16 v[112:127], a[160:163], a[136:139], v[112:127]
    s_add_u32 m0, s68, 81920
    s_add_u32 s3, s71, 589824
    ds_read_b64_tr_b16 a[156:157], v9 offset:10240
    ds_read_b64_tr_b16 a[158:159], v9 offset:10752
    buffer_load_dwordx4 v10, s[48:51], s3 offen offset:0 lds
    v_mfma_f32_32x32x16_bf16 v[112:127], a[164:167], a[140:143], v[112:127]
    s_waitcnt lgkmcnt(8)
    ds_read_b64_tr_b16 a[160:161], v9 offset:12288
    ds_read_b64_tr_b16 a[162:163], v9 offset:12800
    v_rcp_f32 v220, v220
    v_mfma_f32_32x32x16_bf16 v[128:143], a[168:171], a[72:75], v[128:143]
    ds_read_b64_tr_b16 a[164:165], v9 offset:14336
    ds_read_b64_tr_b16 a[166:167], v9 offset:14848
    v_rcp_f32 v221, v221
    v_mul_f32 v222, v222, v220
    v_mul_f32 v223, v223, v221
    v_mfma_f32_32x32x16_bf16 v[128:143], a[172:175], a[76:79], v[128:143]
    s_waitcnt lgkmcnt(8)
    ds_read_b64_tr_b16 a[168:169], v9 offset:16384
    ds_read_b64_tr_b16 a[170:171], v9 offset:16896
    v_cvt_pk_bf16_f32 v157, v222, v223
    v_mul_f32 v216, v44, v44
    v_mul_f32 v217, v45, v45
    v_mfma_f32_32x32x16_bf16 v[128:143], a[144:147], a[80:83], v[128:143]
    ds_read_b64_tr_b16 a[172:173], v9 offset:18432
    ds_read_b64_tr_b16 a[174:175], v9 offset:18944
    v_fma_f32 v216, v216, v15, v14
    v_fma_f32 v217, v217, v15, v14
    v_mul_f32 v216, v44, v216
    v_mul_f32 v217, v45, v217
    v_mfma_f32_32x32x16_bf16 v[128:143], a[148:151], a[84:87], v[128:143]
    s_waitcnt lgkmcnt(8)
    ds_read_b64_tr_b16 a[144:145], v9 offset:20480
    ds_read_b64_tr_b16 a[146:147], v9 offset:20992
    v_exp_f32 v216, v216
    v_mfma_f32_32x32x16_bf16 v[128:143], a[152:155], a[88:91], v[128:143]
    ds_read_b64_tr_b16 a[148:149], v9 offset:22528
    ds_read_b64_tr_b16 a[150:151], v9 offset:23040
    v_exp_f32 v217, v217
    v_mul_f32 v218, v44, v108
    v_mul_f32 v219, v45, v109
    v_mfma_f32_32x32x16_bf16 v[128:143], a[156:159], a[92:95], v[128:143]
    s_waitcnt lgkmcnt(8)
    ds_read_b64_tr_b16 a[152:153], v9 offset:24576
    ds_read_b64_tr_b16 a[154:155], v9 offset:25088
    v_fma_f32 v216, v216, v254, v254
    v_fma_f32 v217, v217, v254, v254
    v_mfma_f32_32x32x16_bf16 v[128:143], a[160:163], a[96:99], v[128:143]
    ds_read_b64_tr_b16 a[156:157], v9 offset:26624
    ds_read_b64_tr_b16 a[158:159], v9 offset:27136
    v_rcp_f32 v216, v216
    v_rcp_f32 v217, v217
    v_mfma_f32_32x32x16_bf16 v[128:143], a[164:167], a[100:103], v[128:143]
    s_waitcnt lgkmcnt(8)
    ds_read_b64_tr_b16 a[160:161], v9 offset:28672
    ds_read_b64_tr_b16 a[162:163], v9 offset:29184
    v_mul_f32 v218, v218, v216
    v_mul_f32 v219, v219, v217
    v_cvt_pk_bf16_f32 v158, v218, v219
    v_mfma_f32_32x32x16_bf16 v[128:143], a[168:171], a[104:107], v[128:143]
    ds_read_b64_tr_b16 a[164:165], v9 offset:30720
    ds_read_b64_tr_b16 a[166:167], v9 offset:31232
    v_mul_f32 v220, v46, v46
    v_mul_f32 v221, v47, v47
    v_fma_f32 v220, v220, v15, v14
    v_fma_f32 v221, v221, v15, v14
    v_mfma_f32_32x32x16_bf16 v[128:143], a[172:175], a[108:111], v[128:143]
    s_waitcnt lgkmcnt(8)
    ds_read_b64_tr_b16 a[168:169], v9 offset:32768
    ds_read_b64_tr_b16 a[170:171], v9 offset:33280
    v_mul_f32 v220, v46, v220
    v_mul_f32 v221, v47, v221
    v_mfma_f32_32x32x16_bf16 v[128:143], a[144:147], a[112:115], v[128:143]
    ds_read_b64_tr_b16 a[172:173], v9 offset:34816
    ds_read_b64_tr_b16 a[174:175], v9 offset:35328
    v_exp_f32 v220, v220
    v_exp_f32 v221, v221
    v_mfma_f32_32x32x16_bf16 v[128:143], a[148:151], a[116:119], v[128:143]
    s_waitcnt vmcnt(21)
    s_barrier
    s_waitcnt lgkmcnt(8)
    ds_read_b64_tr_b16 a[144:145], v2 offset:0
    ds_read_b64_tr_b16 a[146:147], v2 offset:512
    v_mfma_f32_32x32x16_bf16 v[128:143], a[152:155], a[120:123], v[128:143]
    ds_read_b64_tr_b16 a[148:149], v2 offset:2048
    ds_read_b64_tr_b16 a[150:151], v2 offset:2560
    v_mul_f32 v222, v46, v110
    v_mul_f32 v223, v47, v111
    v_fma_f32 v220, v220, v254, v254
    v_fma_f32 v221, v221, v254, v254
    v_mfma_f32_32x32x16_bf16 v[128:143], a[156:159], a[124:127], v[128:143]
    s_waitcnt lgkmcnt(8)
    ds_read_b64_tr_b16 a[152:153], v2 offset:4096
    ds_read_b64_tr_b16 a[154:155], v2 offset:4608
    v_rcp_f32 v220, v220
    v_mfma_f32_32x32x16_bf16 v[128:143], a[160:163], a[128:131], v[128:143]
    ds_read_b64_tr_b16 a[156:157], v2 offset:6144
    ds_read_b64_tr_b16 a[158:159], v2 offset:6656
    v_rcp_f32 v221, v221
    v_mul_f32 v222, v222, v220
    v_mul_f32 v223, v223, v221
    v_mfma_f32_32x32x16_bf16 v[128:143], a[164:167], a[132:135], v[128:143]
    s_waitcnt lgkmcnt(8)
    ds_read_b64_tr_b16 a[160:161], v2 offset:8192
    ds_read_b64_tr_b16 a[162:163], v2 offset:8704
    v_cvt_pk_bf16_f32 v159, v222, v223
    v_mfma_f32_32x32x16_bf16 v[128:143], a[168:171], a[136:139], v[128:143]
    s_add_u32 s35, s32, 2048
    ds_read_b64_tr_b16 a[164:165], v2 offset:10240
    ds_read_b64_tr_b16 a[166:167], v2 offset:10752
    buffer_store_dwordx4 v[152:155], v1, s[56:59], s35 offen sc1
    v_mfma_f32_32x32x16_bf16 v[128:143], a[172:175], a[140:143], v[128:143]
    s_waitcnt lgkmcnt(8)
    s_barrier
    ds_read_b64_tr_b16 a[168:169], v2 offset:12288
    ds_read_b64_tr_b16 a[170:171], v2 offset:12800
    v_mfma_f32_32x32x16_bf16 v[16:31], a[144:147], a[0:3], 0
    s_add_u32 m0, s68, 110592
    s_add_u32 s3, s71, 2654208
    ds_read_b64_tr_b16 a[172:173], v2 offset:14336
    ds_read_b64_tr_b16 a[174:175], v2 offset:14848
    buffer_load_dwordx4 v10, s[48:51], s3 offen offset:0 lds
    v_mfma_f32_32x32x16_bf16 v[16:31], a[148:151], a[4:7], v[16:31]
    s_waitcnt lgkmcnt(8)
    ds_read_b64_tr_b16 a[144:145], v2 offset:16384
    ds_read_b64_tr_b16 a[146:147], v2 offset:16896
    buffer_store_dwordx4 v[156:159], v1, s[56:59], s35 offen offset:1024 sc1
    v_mfma_f32_32x32x16_bf16 v[16:31], a[152:155], a[8:11], v[16:31]
    ds_read_b64_tr_b16 a[148:149], v2 offset:18432
    ds_read_b64_tr_b16 a[150:151], v2 offset:18944
    buffer_load_dwordx4 v11, s[48:51], s3 offen offset:1024 lds
    v_mul_f32 v216, v48, v48
    v_mul_f32 v217, v49, v49
    v_fma_f32 v216, v216, v15, v14
    v_mfma_f32_32x32x16_bf16 v[16:31], a[156:159], a[12:15], v[16:31]
    s_waitcnt lgkmcnt(8)
    ds_read_b64_tr_b16 a[152:153], v2 offset:20480
    ds_read_b64_tr_b16 a[154:155], v2 offset:20992
    v_fma_f32 v217, v217, v15, v14
    v_mul_f32 v216, v48, v216
    v_mfma_f32_32x32x16_bf16 v[16:31], a[160:163], a[16:19], v[16:31]
    ds_read_b64_tr_b16 a[156:157], v2 offset:22528
    ds_read_b64_tr_b16 a[158:159], v2 offset:23040
    buffer_load_dwordx4 v12, s[48:51], s3 offen offset:2048 lds
    v_mul_f32 v217, v49, v217
    v_exp_f32 v216, v216
    v_mfma_f32_32x32x16_bf16 v[16:31], a[164:167], a[20:23], v[16:31]
    s_waitcnt lgkmcnt(8)
    ds_read_b64_tr_b16 a[160:161], v2 offset:24576
    ds_read_b64_tr_b16 a[162:163], v2 offset:25088
    v_exp_f32 v217, v217
    v_mfma_f32_32x32x16_bf16 v[16:31], a[168:171], a[24:27], v[16:31]
    ds_read_b64_tr_b16 a[164:165], v2 offset:26624
    ds_read_b64_tr_b16 a[166:167], v2 offset:27136
    buffer_load_dwordx4 v13, s[48:51], s3 offen offset:3072 lds
    v_mul_f32 v218, v48, v112
    v_mul_f32 v219, v49, v113
    v_fma_f32 v216, v216, v254, v254
    v_mfma_f32_32x32x16_bf16 v[16:31], a[172:175], a[28:31], v[16:31]
    s_waitcnt lgkmcnt(8)
    ds_read_b64_tr_b16 a[168:169], v2 offset:28672
    ds_read_b64_tr_b16 a[170:171], v2 offset:29184
    v_fma_f32 v217, v217, v254, v254
    v_rcp_f32 v216, v216
    v_mfma_f32_32x32x16_bf16 v[16:31], a[144:147], a[32:35], v[16:31]
    s_add_u32 m0, s68, 114688
    s_add_u32 s3, s71, 2949120
    ds_read_b64_tr_b16 a[172:173], v2 offset:30720
    ds_read_b64_tr_b16 a[174:175], v2 offset:31232
    buffer_load_dwordx4 v10, s[48:51], s3 offen offset:0 lds
    v_mfma_f32_32x32x16_bf16 v[16:31], a[148:151], a[36:39], v[16:31]
    s_waitcnt lgkmcnt(8)
    ds_read_b64_tr_b16 a[144:145], v2 offset:32768
    ds_read_b64_tr_b16 a[146:147], v2 offset:33280
    v_rcp_f32 v217, v217
    v_mul_f32 v218, v218, v216
    v_mfma_f32_32x32x16_bf16 v[16:31], a[152:155], a[40:43], v[16:31]
    ds_read_b64_tr_b16 a[148:149], v2 offset:34816
    ds_read_b64_tr_b16 a[150:151], v2 offset:35328
    buffer_load_dwordx4 v11, s[48:51], s3 offen offset:1024 lds
    v_mul_f32 v219, v219, v217
    v_cvt_pk_bf16_f32 v160, v218, v219
    v_mul_f32 v220, v50, v50
    v_mfma_f32_32x32x16_bf16 v[16:31], a[156:159], a[44:47], v[16:31]
    s_waitcnt lgkmcnt(8)
    ds_read_b64_tr_b16 a[152:153], v6 offset:0
    ds_read_b64_tr_b16 a[154:155], v6 offset:512
    v_mul_f32 v221, v51, v51
    v_fma_f32 v220, v220, v15, v14
    v_mfma_f32_32x32x16_bf16 v[16:31], a[160:163], a[48:51], v[16:31]
    ds_read_b64_tr_b16 a[156:157], v6 offset:2048
    ds_read_b64_tr_b16 a[158:159], v6 offset:2560
    buffer_load_dwordx4 v12, s[48:51], s3 offen offset:2048 lds
    v_fma_f32 v221, v221, v15, v14
    v_mul_f32 v220, v50, v220
    v_mul_f32 v221, v51, v221
    v_mfma_f32_32x32x16_bf16 v[16:31], a[164:167], a[52:55], v[16:31]
    s_waitcnt lgkmcnt(8)
    ds_read_b64_tr_b16 a[160:161], v6 offset:4096
    ds_read_b64_tr_b16 a[162:163], v6 offset:4608
    v_exp_f32 v220, v220
    v_mfma_f32_32x32x16_bf16 v[16:31], a[168:171], a[56:59], v[16:31]
    ds_read_b64_tr_b16 a[164:165], v6 offset:6144
    ds_read_b64_tr_b16 a[166:167], v6 offset:6656
    buffer_load_dwordx4 v13, s[48:51], s3 offen offset:3072 lds
    v_exp_f32 v221, v221
    v_mul_f32 v222, v50, v114
    v_mfma_f32_32x32x16_bf16 v[16:31], a[172:175], a[60:63], v[16:31]
    s_waitcnt lgkmcnt(8)
    ds_read_b64_tr_b16 a[168:169], v6 offset:8192
    ds_read_b64_tr_b16 a[170:171], v6 offset:8704
    v_mul_f32 v223, v51, v115
    v_fma_f32 v220, v220, v254, v254
    v_fma_f32 v221, v221, v254, v254
    v_mfma_f32_32x32x16_bf16 v[16:31], a[144:147], a[64:67], v[16:31]
    s_add_u32 m0, s68, 118784
    s_add_u32 s3, s71, 3244032
    ds_read_b64_tr_b16 a[172:173], v6 offset:10240
    ds_read_b64_tr_b16 a[174:175], v6 offset:10752
    buffer_load_dwordx4 v10, s[48:51], s3 offen offset:0 lds
    v_mfma_f32_32x32x16_bf16 v[16:31], a[148:151], a[68:71], v[16:31]
    s_waitcnt lgkmcnt(8)
    ds_read_b64_tr_b16 a[144:145], v6 offset:12288
    ds_read_b64_tr_b16 a[146:147], v6 offset:12800
    v_rcp_f32 v220, v220
    v_mfma_f32_32x32x16_bf16 v[32:47], a[152:155], a[0:3], 0
    ds_read_b64_tr_b16 a[148:149], v6 offset:14336
    ds_read_b64_tr_b16 a[150:151], v6 offset:14848
    v_rcp_f32 v221, v221
    v_mul_f32 v222, v222, v220
    v_mul_f32 v223, v223, v221
    v_mfma_f32_32x32x16_bf16 v[32:47], a[156:159], a[4:7], v[32:47]
    s_waitcnt lgkmcnt(8)
    ds_read_b64_tr_b16 a[152:153], v6 offset:16384
    ds_read_b64_tr_b16 a[154:155], v6 offset:16896
    v_cvt_pk_bf16_f32 v161, v222, v223
    v_mul_f32 v216, v52, v52
    v_mul_f32 v217, v53, v53
    v_mfma_f32_32x32x16_bf16 v[32:47], a[160:163], a[8:11], v[32:47]
    ds_read_b64_tr_b16 a[156:157], v6 offset:18432
    ds_read_b64_tr_b16 a[158:159], v6 offset:18944
    v_fma_f32 v216, v216, v15, v14
    v_fma_f32 v217, v217, v15, v14
    v_mul_f32 v216, v52, v216
    v_mul_f32 v217, v53, v217
    v_mfma_f32_32x32x16_bf16 v[32:47], a[164:167], a[12:15], v[32:47]
    s_waitcnt lgkmcnt(8)
    ds_read_b64_tr_b16 a[160:161], v6 offset:20480
    ds_read_b64_tr_b16 a[162:163], v6 offset:20992
    v_exp_f32 v216, v216
    v_mfma_f32_32x32x16_bf16 v[32:47], a[168:171], a[16:19], v[32:47]
    ds_read_b64_tr_b16 a[164:165], v6 offset:22528
    ds_read_b64_tr_b16 a[166:167], v6 offset:23040
    v_exp_f32 v217, v217
    v_mul_f32 v218, v52, v116
    v_mul_f32 v219, v53, v117
    v_mfma_f32_32x32x16_bf16 v[32:47], a[172:175], a[20:23], v[32:47]
    s_waitcnt lgkmcnt(8)
    ds_read_b64_tr_b16 a[168:169], v6 offset:24576
    ds_read_b64_tr_b16 a[170:171], v6 offset:25088
    v_fma_f32 v216, v216, v254, v254
    v_fma_f32 v217, v217, v254, v254
    v_mfma_f32_32x32x16_bf16 v[32:47], a[144:147], a[24:27], v[32:47]
    ds_read_b64_tr_b16 a[172:173], v6 offset:26624
    ds_read_b64_tr_b16 a[174:175], v6 offset:27136
    v_rcp_f32 v216, v216
    v_rcp_f32 v217, v217
    v_mfma_f32_32x32x16_bf16 v[32:47], a[148:151], a[28:31], v[32:47]
    s_waitcnt lgkmcnt(8)
    ds_read_b64_tr_b16 a[144:145], v6 offset:28672
    ds_read_b64_tr_b16 a[146:147], v6 offset:29184
    v_mul_f32 v218, v218, v216
    v_mul_f32 v219, v219, v217
    v_mfma_f32_32x32x16_bf16 v[32:47], a[152:155], a[32:35], v[32:47]
    ds_read_b64_tr_b16 a[148:149], v6 offset:30720
    ds_read_b64_tr_b16 a[150:151], v6 offset:31232
    v_cvt_pk_bf16_f32 v162, v218, v219
    v_mul_f32 v220, v54, v54
    v_mul_f32 v221, v55, v55
    v_fma_f32 v220, v220, v15, v14
    v_mfma_f32_32x32x16_bf16 v[32:47], a[156:159], a[36:39], v[32:47]
    s_waitcnt lgkmcnt(8)
    ds_read_b64_tr_b16 a[152:153], v6 offset:32768
    ds_read_b64_tr_b16 a[154:155], v6 offset:33280
    v_fma_f32 v221, v221, v15, v14
    v_mul_f32 v220, v54, v220
    v_mfma_f32_32x32x16_bf16 v[32:47], a[160:163], a[40:43], v[32:47]
    ds_read_b64_tr_b16 a[156:157], v6 offset:34816
    ds_read_b64_tr_b16 a[158:159], v6 offset:35328
    v_mul_f32 v221, v55, v221
    v_exp_f32 v220, v220
    v_mfma_f32_32x32x16_bf16 v[32:47], a[164:167], a[44:47], v[32:47]
    s_waitcnt vmcnt(21)
    s_barrier
    s_waitcnt lgkmcnt(8)
    ds_read_b64_tr_b16 a[160:161], v3 offset:0
    ds_read_b64_tr_b16 a[162:163], v3 offset:512
    v_mfma_f32_32x32x16_bf16 v[32:47], a[168:171], a[48:51], v[32:47]
    ds_read_b64_tr_b16 a[164:165], v3 offset:2048
    ds_read_b64_tr_b16 a[166:167], v3 offset:2560
    v_exp_f32 v221, v221
    v_mul_f32 v222, v54, v118
    v_mul_f32 v223, v55, v119
    v_mfma_f32_32x32x16_bf16 v[32:47], a[172:175], a[52:55], v[32:47]
    s_waitcnt lgkmcnt(8)
    ds_read_b64_tr_b16 a[168:169], v3 offset:4096
    ds_read_b64_tr_b16 a[170:171], v3 offset:4608
    v_fma_f32 v220, v220, v254, v254
    v_fma_f32 v221, v221, v254, v254
    v_mfma_f32_32x32x16_bf16 v[32:47], a[144:147], a[56:59], v[32:47]
    ds_read_b64_tr_b16 a[172:173], v3 offset:6144
    ds_read_b64_tr_b16 a[174:175], v3 offset:6656
    v_rcp_f32 v220, v220
    v_rcp_f32 v221, v221
    v_mfma_f32_32x32x16_bf16 v[32:47], a[148:151], a[60:63], v[32:47]
    s_waitcnt lgkmcnt(8)
    ds_read_b64_tr_b16 a[144:145], v3 offset:8192
    ds_read_b64_tr_b16 a[146:147], v3 offset:8704
    v_mul_f32 v222, v222, v220
    v_mul_f32 v223, v223, v221
    v_cvt_pk_bf16_f32 v163, v222, v223
    v_mfma_f32_32x32x16_bf16 v[32:47], a[152:155], a[64:67], v[32:47]
    ds_read_b64_tr_b16 a[148:149], v3 offset:10240
    ds_read_b64_tr_b16 a[150:151], v3 offset:10752
    v_mul_f32 v216, v56, v56
    v_mul_f32 v217, v57, v57
    v_fma_f32 v216, v216, v15, v14
    v_mfma_f32_32x32x16_bf16 v[32:47], a[156:159], a[68:71], v[32:47]
    s_waitcnt lgkmcnt(8)
    s_barrier
    ds_read_b64_tr_b16 a[152:153], v3 offset:12288
    ds_read_b64_tr_b16 a[154:155], v3 offset:12800
    v_mfma_f32_32x32x16_bf16 v[16:31], a[160:163], a[72:75], v[16:31]
    s_add_u32 m0, s68, 0
    s_add_u32 s3, s72, 0
    ds_read_b64_tr_b16 a[156:157], v3 offset:14336
    ds_read_b64_tr_b16 a[158:159], v3 offset:14848
    buffer_load_dwordx4 v10, s[44:47], s3 offen offset:0 lds
    v_fma_f32 v217, v217, v15, v14
    v_mfma_f32_32x32x16_bf16 v[16:31], a[164:167], a[76:79], v[16:31]
    s_waitcnt lgkmcnt(8)
    ds_read_b64_tr_b16 a[160:161], v3 offset:16384
    ds_read_b64_tr_b16 a[162:163], v3 offset:16896
    v_mul_f32 v216, v56, v216
    v_mul_f32 v217, v57, v217
    v_mfma_f32_32x32x16_bf16 v[16:31], a[168:171], a[80:83], v[16:31]
    ds_read_b64_tr_b16 a[164:165], v3 offset:18432
    ds_read_b64_tr_b16 a[166:167], v3 offset:18944
    buffer_load_dwordx4 v11, s[44:47], s3 offen offset:1024 lds
    v_exp_f32 v216, v216
    v_mfma_f32_32x32x16_bf16 v[16:31], a[172:175], a[84:87], v[16:31]
    s_waitcnt lgkmcnt(8)
    ds_read_b64_tr_b16 a[168:169], v3 offset:20480
    ds_read_b64_tr_b16 a[170:171], v3 offset:20992
    v_exp_f32 v217, v217
    v_mul_f32 v218, v56, v120
    v_mfma_f32_32x32x16_bf16 v[16:31], a[144:147], a[88:91], v[16:31]
    ds_read_b64_tr_b16 a[172:173], v3 offset:22528
    ds_read_b64_tr_b16 a[174:175], v3 offset:23040
    buffer_load_dwordx4 v12, s[44:47], s3 offen offset:2048 lds
    v_mul_f32 v219, v57, v121
    v_fma_f32 v216, v216, v254, v254
    v_fma_f32 v217, v217, v254, v254
    v_mfma_f32_32x32x16_bf16 v[16:31], a[148:151], a[92:95], v[16:31]
    s_waitcnt lgkmcnt(8)
    ds_read_b64_tr_b16 a[144:145], v3 offset:24576
    ds_read_b64_tr_b16 a[146:147], v3 offset:25088
    v_rcp_f32 v216, v216
    v_mfma_f32_32x32x16_bf16 v[16:31], a[152:155], a[96:99], v[16:31]
    ds_read_b64_tr_b16 a[148:149], v3 offset:26624
    ds_read_b64_tr_b16 a[150:151], v3 offset:27136
    buffer_load_dwordx4 v13, s[44:47], s3 offen offset:3072 lds
    v_rcp_f32 v217, v217
    v_mul_f32 v218, v218, v216
    v_mfma_f32_32x32x16_bf16 v[16:31], a[156:159], a[100:103], v[16:31]
    s_waitcnt lgkmcnt(8)
    ds_read_b64_tr_b16 a[152:153], v3 offset:28672
    ds_read_b64_tr_b16 a[154:155], v3 offset:29184
    v_mul_f32 v219, v219, v217
    v_cvt_pk_bf16_f32 v164, v218, v219
    v_mul_f32 v220, v58, v58
    v_mfma_f32_32x32x16_bf16 v[16:31], a[160:163], a[104:107], v[16:31]
    s_add_u32 m0, s68, 4096
    s_add_u32 s3, s72, 294912
    ds_read_b64_tr_b16 a[156:157], v3 offset:30720
    ds_read_b64_tr_b16 a[158:159], v3 offset:31232
    buffer_load_dwordx4 v10, s[44:47], s3 offen offset:0 lds
    v_mul_f32 v221, v59, v59
    v_mfma_f32_32x32x16_bf16 v[16:31], a[164:167], a[108:111], v[16:31]
    s_waitcnt lgkmcnt(8)
    ds_read_b64_tr_b16 a[160:161], v3 offset:32768
    ds_read_b64_tr_b16 a[162:163], v3 offset:33280
    v_fma_f32 v220, v220, v15, v14
    v_fma_f32 v221, v221, v15, v14
    v_mul_f32 v220, v58, v220
    v_mfma_f32_32x32x16_bf16 v[16:31], a[168:171], a[112:115], v[16:31]
    ds_read_b64_tr_b16 a[164:165], v3 offset:34816
    ds_read_b64_tr_b16 a[166:167], v3 offset:35328
    buffer_load_dwordx4 v11, s[44:47], s3 offen offset:1024 lds
    v_mul_f32 v221, v59, v221
    v_exp_f32 v220, v220
    v_mfma_f32_32x32x16_bf16 v[16:31], a[172:175], a[116:119], v[16:31]
    s_waitcnt lgkmcnt(8)
    ds_read_b64_tr_b16 a[168:169], v7 offset:0
    ds_read_b64_tr_b16 a[170:171], v7 offset:512
    v_exp_f32 v221, v221
    v_mfma_f32_32x32x16_bf16 v[16:31], a[144:147], a[120:123], v[16:31]
    ds_read_b64_tr_b16 a[172:173], v7 offset:2048
    ds_read_b64_tr_b16 a[174:175], v7 offset:2560
    buffer_load_dwordx4 v12, s[44:47], s3 offen offset:2048 lds
    v_mul_f32 v222, v58, v122
    v_mul_f32 v223, v59, v123
    v_fma_f32 v220, v220, v254, v254
    v_mfma_f32_32x32x16_bf16 v[16:31], a[148:151], a[124:127], v[16:31]
    s_waitcnt lgkmcnt(8)
    ds_read_b64_tr_b16 a[144:145], v7 offset:4096
    ds_read_b64_tr_b16 a[146:147], v7 offset:4608
    v_fma_f32 v221, v221, v254, v254
    v_rcp_f32 v220, v220
    v_mfma_f32_32x32x16_bf16 v[16:31], a[152:155], a[128:131], v[16:31]
    ds_read_b64_tr_b16 a[148:149], v7 offset:6144
    ds_read_b64_tr_b16 a[150:151], v7 offset:6656
    buffer_load_dwordx4 v13, s[44:47], s3 offen offset:3072 lds
    v_rcp_f32 v221, v221
    v_mfma_f32_32x32x16_bf16 v[16:31], a[156:159], a[132:135], v[16:31]
    s_waitcnt lgkmcnt(8)
    ds_read_b64_tr_b16 a[152:153], v7 offset:8192
    ds_read_b64_tr_b16 a[154:155], v7 offset:8704
    v_mul_f32 v222, v222, v220
    v_mul_f32 v223, v223, v221
    v_mfma_f32_32x32x16_bf16 v[16:31], a[160:163], a[136:139], v[16:31]
    s_add_u32 m0, s68, 8192
    s_add_u32 s3, s72, 589824
    ds_read_b64_tr_b16 a[156:157], v7 offset:10240
    ds_read_b64_tr_b16 a[158:159], v7 offset:10752
    buffer_load_dwordx4 v10, s[44:47], s3 offen offset:0 lds
    v_cvt_pk_bf16_f32 v165, v222, v223
    v_mfma_f32_32x32x16_bf16 v[16:31], a[164:167], a[140:143], v[16:31]
    s_waitcnt lgkmcnt(8)
    ds_read_b64_tr_b16 a[160:161], v7 offset:12288
    ds_read_b64_tr_b16 a[162:163], v7 offset:12800
    v_mul_f32 v216, v60, v60
    v_mul_f32 v217, v61, v61
    v_fma_f32 v216, v216, v15, v14
    v_mfma_f32_32x32x16_bf16 v[32:47], a[168:171], a[72:75], v[32:47]
    ds_read_b64_tr_b16 a[164:165], v7 offset:14336
    ds_read_b64_tr_b16 a[166:167], v7 offset:14848
    buffer_load_dword v252, v229, s[4:7], 0 offen
    v_fma_f32 v217, v217, v15, v14
    v_mul_f32 v216, v60, v216
    v_mfma_f32_32x32x16_bf16 v[32:47], a[172:175], a[76:79], v[32:47]
    s_waitcnt lgkmcnt(8)
    ds_read_b64_tr_b16 a[168:169], v7 offset:16384
    ds_read_b64_tr_b16 a[170:171], v7 offset:16896
    buffer_load_dword v252, v229, s[8:11], 0 offen
    v_mul_f32 v217, v61, v217
    v_mfma_f32_32x32x16_bf16 v[32:47], a[144:147], a[80:83], v[32:47]
    ds_read_b64_tr_b16 a[172:173], v7 offset:18432
    ds_read_b64_tr_b16 a[174:175], v7 offset:18944
    v_exp_f32 v216, v216
    v_exp_f32 v217, v217
    v_mfma_f32_32x32x16_bf16 v[32:47], a[148:151], a[84:87], v[32:47]
    s_waitcnt lgkmcnt(8)
    ds_read_b64_tr_b16 a[144:145], v7 offset:20480
    ds_read_b64_tr_b16 a[146:147], v7 offset:20992
    v_mul_f32 v218, v60, v124
    v_mul_f32 v219, v61, v125
    v_fma_f32 v216, v216, v254, v254
    v_mfma_f32_32x32x16_bf16 v[32:47], a[152:155], a[88:91], v[32:47]
    ds_read_b64_tr_b16 a[148:149], v7 offset:22528
    ds_read_b64_tr_b16 a[150:151], v7 offset:23040
    v_fma_f32 v217, v217, v254, v254
    v_rcp_f32 v216, v216
    v_mfma_f32_32x32x16_bf16 v[32:47], a[156:159], a[92:95], v[32:47]
    s_waitcnt lgkmcnt(8)
    ds_read_b64_tr_b16 a[152:153], v7 offset:24576
    ds_read_b64_tr_b16 a[154:155], v7 offset:25088
    v_rcp_f32 v217, v217
    v_mul_f32 v218, v218, v216
    v_mfma_f32_32x32x16_bf16 v[32:47], a[160:163], a[96:99], v[32:47]
    ds_read_b64_tr_b16 a[156:157], v7 offset:26624
    ds_read_b64_tr_b16 a[158:159], v7 offset:27136
    v_mul_f32 v219, v219, v217
    v_cvt_pk_bf16_f32 v166, v218, v219
    v_mul_f32 v220, v62, v62
    v_mul_f32 v221, v63, v63
    v_mfma_f32_32x32x16_bf16 v[32:47], a[164:167], a[100:103], v[32:47]
    s_waitcnt lgkmcnt(8)
    ds_read_b64_tr_b16 a[160:161], v7 offset:28672
    ds_read_b64_tr_b16 a[162:163], v7 offset:29184
    v_fma_f32 v220, v220, v15, v14
    v_fma_f32 v221, v221, v15, v14
    v_mfma_f32_32x32x16_bf16 v[32:47], a[168:171], a[104:107], v[32:47]
    ds_read_b64_tr_b16 a[164:165], v7 offset:30720
    ds_read_b64_tr_b16 a[166:167], v7 offset:31232
    v_mul_f32 v220, v62, v220
    v_mul_f32 v221, v63, v221
    v_exp_f32 v220, v220
    v_mfma_f32_32x32x16_bf16 v[32:47], a[172:175], a[108:111], v[32:47]
    s_waitcnt lgkmcnt(8)
    ds_read_b64_tr_b16 a[168:169], v7 offset:32768
    ds_read_b64_tr_b16 a[170:171], v7 offset:33280
    v_exp_f32 v221, v221
    v_mfma_f32_32x32x16_bf16 v[32:47], a[144:147], a[112:115], v[32:47]
    ds_read_b64_tr_b16 a[172:173], v7 offset:34816
    ds_read_b64_tr_b16 a[174:175], v7 offset:35328
    v_mul_f32 v222, v62, v126
    v_mul_f32 v223, v63, v127
    v_fma_f32 v220, v220, v254, v254
    v_fma_f32 v221, v221, v254, v254
    v_mfma_f32_32x32x16_bf16 v[32:47], a[148:151], a[116:119], v[32:47]
    s_waitcnt vmcnt(22)
    s_barrier
    s_waitcnt lgkmcnt(8)
    ds_read_b64_tr_b16 a[144:145], v4 offset:0
    ds_read_b64_tr_b16 a[146:147], v4 offset:512
    v_mfma_f32_32x32x16_bf16 v[32:47], a[152:155], a[120:123], v[32:47]
    ds_read_b64_tr_b16 a[148:149], v4 offset:2048
    ds_read_b64_tr_b16 a[150:151], v4 offset:2560
    v_rcp_f32 v220, v220
    v_rcp_f32 v221, v221
    v_mfma_f32_32x32x16_bf16 v[32:47], a[156:159], a[124:127], v[32:47]
    s_waitcnt lgkmcnt(8)
    ds_read_b64_tr_b16 a[152:153], v4 offset:4096
    ds_read_b64_tr_b16 a[154:155], v4 offset:4608
    v_mul_f32 v222, v222, v220
    v_mul_f32 v223, v223, v221
    v_mfma_f32_32x32x16_bf16 v[32:47], a[160:163], a[128:131], v[32:47]
    ds_read_b64_tr_b16 a[156:157], v4 offset:6144
    ds_read_b64_tr_b16 a[158:159], v4 offset:6656
    v_cvt_pk_bf16_f32 v167, v222, v223
    v_mfma_f32_32x32x16_bf16 v[32:47], a[164:167], a[132:135], v[32:47]
    s_waitcnt lgkmcnt(8)
    s_add_u32 s34, s32, 4096
    ds_read_b64_tr_b16 a[160:161], v4 offset:8192
    ds_read_b64_tr_b16 a[162:163], v4 offset:8704
    v_mfma_f32_32x32x16_bf16 v[32:47], a[168:171], a[136:139], v[32:47]
    ds_read_b64_tr_b16 a[164:165], v4 offset:10240
    ds_read_b64_tr_b16 a[166:167], v4 offset:10752
    buffer_store_dwordx4 v[160:163], v1, s[56:59], s34 offen sc1
    v_mfma_f32_32x32x16_bf16 v[32:47], a[172:175], a[140:143], v[32:47]
    s_waitcnt lgkmcnt(8)
    s_barrier
    ds_read_b64_tr_b16 a[168:169], v4 offset:12288
    ds_read_b64_tr_b16 a[170:171], v4 offset:12800
    v_mfma_f32_32x32x16_bf16 v[80:95], a[144:147], a[0:3], 0
    s_add_u32 m0, s68, 36864
    s_add_u32 s3, s72, 2654208
    ds_read_b64_tr_b16 a[172:173], v4 offset:14336
    ds_read_b64_tr_b16 a[174:175], v4 offset:14848
    buffer_load_dwordx4 v10, s[44:47], s3 offen offset:0 lds
    v_mfma_f32_32x32x16_bf16 v[80:95], a[148:151], a[4:7], v[80:95]
    s_waitcnt lgkmcnt(8)
    ds_read_b64_tr_b16 a[144:145], v4 offset:16384
    ds_read_b64_tr_b16 a[146:147], v4 offset:16896
    buffer_store_dwordx4 v[164:167], v1, s[56:59], s34 offen offset:1024 sc1
    v_mfma_f32_32x32x16_bf16 v[80:95], a[152:155], a[8:11], v[80:95]
    ds_read_b64_tr_b16 a[148:149], v4 offset:18432
    ds_read_b64_tr_b16 a[150:151], v4 offset:18944
    buffer_load_dwordx4 v11, s[44:47], s3 offen offset:1024 lds
    v_mul_f32 v216, v64, v64
    v_mul_f32 v217, v65, v65
    v_fma_f32 v216, v216, v15, v14
    v_mfma_f32_32x32x16_bf16 v[80:95], a[156:159], a[12:15], v[80:95]
    s_waitcnt lgkmcnt(8)
    ds_read_b64_tr_b16 a[152:153], v4 offset:20480
    ds_read_b64_tr_b16 a[154:155], v4 offset:20992
    v_fma_f32 v217, v217, v15, v14
    v_mul_f32 v216, v64, v216
    v_mul_f32 v217, v65, v217
    v_mfma_f32_32x32x16_bf16 v[80:95], a[160:163], a[16:19], v[80:95]
    ds_read_b64_tr_b16 a[156:157], v4 offset:22528
    ds_read_b64_tr_b16 a[158:159], v4 offset:23040
    buffer_load_dwordx4 v12, s[44:47], s3 offen offset:2048 lds
    v_exp_f32 v216, v216
    v_mfma_f32_32x32x16_bf16 v[80:95], a[164:167], a[20:23], v[80:95]
    s_waitcnt lgkmcnt(8)
    ds_read_b64_tr_b16 a[160:161], v4 offset:24576
    ds_read_b64_tr_b16 a[162:163], v4 offset:25088
    v_exp_f32 v217, v217
    v_mul_f32 v218, v64, v128
    v_mfma_f32_32x32x16_bf16 v[80:95], a[168:171], a[24:27], v[80:95]
    ds_read_b64_tr_b16 a[164:165], v4 offset:26624
    ds_read_b64_tr_b16 a[166:167], v4 offset:27136
    buffer_load_dwordx4 v13, s[44:47], s3 offen offset:3072 lds
    v_mul_f32 v219, v65, v129
    v_fma_f32 v216, v216, v254, v254
    v_fma_f32 v217, v217, v254, v254
    v_mfma_f32_32x32x16_bf16 v[80:95], a[172:175], a[28:31], v[80:95]
    s_waitcnt lgkmcnt(8)
    ds_read_b64_tr_b16 a[168:169], v4 offset:28672
    ds_read_b64_tr_b16 a[170:171], v4 offset:29184
    v_rcp_f32 v216, v216
    v_mfma_f32_32x32x16_bf16 v[80:95], a[144:147], a[32:35], v[80:95]
    s_add_u32 m0, s68, 40960
    s_add_u32 s3, s72, 2949120
    ds_read_b64_tr_b16 a[172:173], v4 offset:30720
    ds_read_b64_tr_b16 a[174:175], v4 offset:31232
    buffer_load_dwordx4 v10, s[44:47], s3 offen offset:0 lds
    v_mfma_f32_32x32x16_bf16 v[80:95], a[148:151], a[36:39], v[80:95]
    s_waitcnt lgkmcnt(8)
    ds_read_b64_tr_b16 a[144:145], v4 offset:32768
    ds_read_b64_tr_b16 a[146:147], v4 offset:33280
    v_rcp_f32 v217, v217
    v_mul_f32 v218, v218, v216
    v_mfma_f32_32x32x16_bf16 v[80:95], a[152:155], a[40:43], v[80:95]
    ds_read_b64_tr_b16 a[148:149], v4 offset:34816
    ds_read_b64_tr_b16 a[150:151], v4 offset:35328
    buffer_load_dwordx4 v11, s[44:47], s3 offen offset:1024 lds
    v_mul_f32 v219, v219, v217
    v_cvt_pk_bf16_f32 v168, v218, v219
    v_mul_f32 v220, v66, v66
    v_mfma_f32_32x32x16_bf16 v[80:95], a[156:159], a[44:47], v[80:95]
    s_waitcnt lgkmcnt(8)
    ds_read_b64_tr_b16 a[152:153], v8 offset:0
    ds_read_b64_tr_b16 a[154:155], v8 offset:512
    v_mul_f32 v221, v67, v67
    v_fma_f32 v220, v220, v15, v14
    v_fma_f32 v221, v221, v15, v14
    v_mfma_f32_32x32x16_bf16 v[80:95], a[160:163], a[48:51], v[80:95]
    ds_read_b64_tr_b16 a[156:157], v8 offset:2048
    ds_read_b64_tr_b16 a[158:159], v8 offset:2560
    buffer_load_dwordx4 v12, s[44:47], s3 offen offset:2048 lds
    v_mul_f32 v220, v66, v220
    v_mul_f32 v221, v67, v221
    v_mfma_f32_32x32x16_bf16 v[80:95], a[164:167], a[52:55], v[80:95]
    s_waitcnt lgkmcnt(8)
    ds_read_b64_tr_b16 a[160:161], v8 offset:4096
    ds_read_b64_tr_b16 a[162:163], v8 offset:4608
    v_exp_f32 v220, v220
    v_mfma_f32_32x32x16_bf16 v[80:95], a[168:171], a[56:59], v[80:95]
    ds_read_b64_tr_b16 a[164:165], v8 offset:6144
    ds_read_b64_tr_b16 a[166:167], v8 offset:6656
    buffer_load_dwordx4 v13, s[44:47], s3 offen offset:3072 lds
    v_exp_f32 v221, v221
    v_mul_f32 v222, v66, v130
    v_mfma_f32_32x32x16_bf16 v[80:95], a[172:175], a[60:63], v[80:95]
    s_waitcnt lgkmcnt(8)
    ds_read_b64_tr_b16 a[168:169], v8 offset:8192
    ds_read_b64_tr_b16 a[170:171], v8 offset:8704
    v_mul_f32 v223, v67, v131
    v_fma_f32 v220, v220, v254, v254
    v_fma_f32 v221, v221, v254, v254
    v_mfma_f32_32x32x16_bf16 v[80:95], a[144:147], a[64:67], v[80:95]
    s_add_u32 m0, s68, 45056
    s_add_u32 s3, s72, 3244032
    ds_read_b64_tr_b16 a[172:173], v8 offset:10240
    ds_read_b64_tr_b16 a[174:175], v8 offset:10752
    buffer_load_dwordx4 v10, s[44:47], s3 offen offset:0 lds
    v_mfma_f32_32x32x16_bf16 v[80:95], a[148:151], a[68:71], v[80:95]
    s_waitcnt lgkmcnt(8)
    ds_read_b64_tr_b16 a[144:145], v8 offset:12288
    ds_read_b64_tr_b16 a[146:147], v8 offset:12800
    v_rcp_f32 v220, v220
    v_mfma_f32_32x32x16_bf16 v[96:111], a[152:155], a[0:3], 0
    ds_read_b64_tr_b16 a[148:149], v8 offset:14336
    ds_read_b64_tr_b16 a[150:151], v8 offset:14848
    v_rcp_f32 v221, v221
    v_mul_f32 v222, v222, v220
    v_mul_f32 v223, v223, v221
    v_mfma_f32_32x32x16_bf16 v[96:111], a[156:159], a[4:7], v[96:111]
    s_waitcnt lgkmcnt(8)
    ds_read_b64_tr_b16 a[152:153], v8 offset:16384
    ds_read_b64_tr_b16 a[154:155], v8 offset:16896
    v_cvt_pk_bf16_f32 v169, v222, v223
    v_mul_f32 v216, v68, v68
    v_mul_f32 v217, v69, v69
    v_mfma_f32_32x32x16_bf16 v[96:111], a[160:163], a[8:11], v[96:111]
    ds_read_b64_tr_b16 a[156:157], v8 offset:18432
    ds_read_b64_tr_b16 a[158:159], v8 offset:18944
    v_fma_f32 v216, v216, v15, v14
    v_fma_f32 v217, v217, v15, v14
    v_mul_f32 v216, v68, v216
    v_mul_f32 v217, v69, v217
    v_mfma_f32_32x32x16_bf16 v[96:111], a[164:167], a[12:15], v[96:111]
    s_waitcnt lgkmcnt(8)
    ds_read_b64_tr_b16 a[160:161], v8 offset:20480
    ds_read_b64_tr_b16 a[162:163], v8 offset:20992
    v_exp_f32 v216, v216
    v_mfma_f32_32x32x16_bf16 v[96:111], a[168:171], a[16:19], v[96:111]
    ds_read_b64_tr_b16 a[164:165], v8 offset:22528
    ds_read_b64_tr_b16 a[166:167], v8 offset:23040
    v_exp_f32 v217, v217
    v_mul_f32 v218, v68, v132
    v_mul_f32 v219, v69, v133
    v_mfma_f32_32x32x16_bf16 v[96:111], a[172:175], a[20:23], v[96:111]
    s_waitcnt lgkmcnt(8)
    ds_read_b64_tr_b16 a[168:169], v8 offset:24576
    ds_read_b64_tr_b16 a[170:171], v8 offset:25088
    v_fma_f32 v216, v216, v254, v254
    v_fma_f32 v217, v217, v254, v254
    v_mfma_f32_32x32x16_bf16 v[96:111], a[144:147], a[24:27], v[96:111]
    ds_read_b64_tr_b16 a[172:173], v8 offset:26624
    ds_read_b64_tr_b16 a[174:175], v8 offset:27136
    v_rcp_f32 v216, v216
    v_rcp_f32 v217, v217
    v_mfma_f32_32x32x16_bf16 v[96:111], a[148:151], a[28:31], v[96:111]
    s_waitcnt lgkmcnt(8)
    ds_read_b64_tr_b16 a[144:145], v8 offset:28672
    ds_read_b64_tr_b16 a[146:147], v8 offset:29184
    v_mul_f32 v218, v218, v216
    v_mul_f32 v219, v219, v217
    v_cvt_pk_bf16_f32 v170, v218, v219
    v_mfma_f32_32x32x16_bf16 v[96:111], a[152:155], a[32:35], v[96:111]
    ds_read_b64_tr_b16 a[148:149], v8 offset:30720
    ds_read_b64_tr_b16 a[150:151], v8 offset:31232
    v_mul_f32 v220, v70, v70
    v_mul_f32 v221, v71, v71
    v_fma_f32 v220, v220, v15, v14
    v_fma_f32 v221, v221, v15, v14
    v_mfma_f32_32x32x16_bf16 v[96:111], a[156:159], a[36:39], v[96:111]
    s_waitcnt lgkmcnt(8)
    ds_read_b64_tr_b16 a[152:153], v8 offset:32768
    ds_read_b64_tr_b16 a[154:155], v8 offset:33280
    v_mul_f32 v220, v70, v220
    v_mul_f32 v221, v71, v221
    v_mfma_f32_32x32x16_bf16 v[96:111], a[160:163], a[40:43], v[96:111]
    ds_read_b64_tr_b16 a[156:157], v8 offset:34816
    ds_read_b64_tr_b16 a[158:159], v8 offset:35328
    v_exp_f32 v220, v220
    v_exp_f32 v221, v221
    v_mfma_f32_32x32x16_bf16 v[96:111], a[164:167], a[44:47], v[96:111]
    s_waitcnt vmcnt(22)
    s_barrier
    s_waitcnt lgkmcnt(8)
    ds_read_b64_tr_b16 a[160:161], v5 offset:0
    ds_read_b64_tr_b16 a[162:163], v5 offset:512
    v_mfma_f32_32x32x16_bf16 v[96:111], a[168:171], a[48:51], v[96:111]
    ds_read_b64_tr_b16 a[164:165], v5 offset:2048
    ds_read_b64_tr_b16 a[166:167], v5 offset:2560
    v_mul_f32 v222, v70, v134
    v_mul_f32 v223, v71, v135
    v_fma_f32 v220, v220, v254, v254
    v_mfma_f32_32x32x16_bf16 v[96:111], a[172:175], a[52:55], v[96:111]
    s_waitcnt lgkmcnt(8)
    ds_read_b64_tr_b16 a[168:169], v5 offset:4096
    ds_read_b64_tr_b16 a[170:171], v5 offset:4608
    v_fma_f32 v221, v221, v254, v254
    v_rcp_f32 v220, v220
    v_mfma_f32_32x32x16_bf16 v[96:111], a[144:147], a[56:59], v[96:111]
    ds_read_b64_tr_b16 a[172:173], v5 offset:6144
    ds_read_b64_tr_b16 a[174:175], v5 offset:6656
    v_rcp_f32 v221, v221
    v_mul_f32 v222, v222, v220
    v_mfma_f32_32x32x16_bf16 v[96:111], a[148:151], a[60:63], v[96:111]
    s_waitcnt lgkmcnt(8)
    ds_read_b64_tr_b16 a[144:145], v5 offset:8192
    ds_read_b64_tr_b16 a[146:147], v5 offset:8704
    v_mul_f32 v223, v223, v221
    v_cvt_pk_bf16_f32 v171, v222, v223
    v_mul_f32 v216, v72, v72
    v_mfma_f32_32x32x16_bf16 v[96:111], a[152:155], a[64:67], v[96:111]
    ds_read_b64_tr_b16 a[148:149], v5 offset:10240
    ds_read_b64_tr_b16 a[150:151], v5 offset:10752
    v_mul_f32 v217, v73, v73
    v_fma_f32 v216, v216, v15, v14
    v_fma_f32 v217, v217, v15, v14
    v_mfma_f32_32x32x16_bf16 v[96:111], a[156:159], a[68:71], v[96:111]
    s_waitcnt lgkmcnt(8)
    s_barrier
    ds_read_b64_tr_b16 a[152:153], v5 offset:12288
    ds_read_b64_tr_b16 a[154:155], v5 offset:12800
    v_mfma_f32_32x32x16_bf16 v[80:95], a[160:163], a[72:75], v[80:95]
    s_add_u32 m0, s68, 73728
    s_add_u32 s3, s72, 0
    ds_read_b64_tr_b16 a[156:157], v5 offset:14336
    ds_read_b64_tr_b16 a[158:159], v5 offset:14848
    buffer_load_dwordx4 v10, s[48:51], s3 offen offset:0 lds
    v_mul_f32 v216, v72, v216
    v_mfma_f32_32x32x16_bf16 v[80:95], a[164:167], a[76:79], v[80:95]
    s_waitcnt lgkmcnt(8)
    ds_read_b64_tr_b16 a[160:161], v5 offset:16384
    ds_read_b64_tr_b16 a[162:163], v5 offset:16896
    v_mul_f32 v217, v73, v217
    v_exp_f32 v216, v216
    v_mfma_f32_32x32x16_bf16 v[80:95], a[168:171], a[80:83], v[80:95]
    ds_read_b64_tr_b16 a[164:165], v5 offset:18432
    ds_read_b64_tr_b16 a[166:167], v5 offset:18944
    buffer_load_dwordx4 v11, s[48:51], s3 offen offset:1024 lds
    v_exp_f32 v217, v217
    v_mfma_f32_32x32x16_bf16 v[80:95], a[172:175], a[84:87], v[80:95]
    s_waitcnt lgkmcnt(8)
    ds_read_b64_tr_b16 a[168:169], v5 offset:20480
    ds_read_b64_tr_b16 a[170:171], v5 offset:20992
    v_mul_f32 v218, v72, v136
    v_mul_f32 v219, v73, v137
    v_fma_f32 v216, v216, v254, v254
    v_mfma_f32_32x32x16_bf16 v[80:95], a[144:147], a[88:91], v[80:95]
    ds_read_b64_tr_b16 a[172:173], v5 offset:22528
    ds_read_b64_tr_b16 a[174:175], v5 offset:23040
    buffer_load_dwordx4 v12, s[48:51], s3 offen offset:2048 lds
    v_fma_f32 v217, v217, v254, v254
    v_rcp_f32 v216, v216
    v_mfma_f32_32x32x16_bf16 v[80:95], a[148:151], a[92:95], v[80:95]
    s_waitcnt lgkmcnt(8)
    ds_read_b64_tr_b16 a[144:145], v5 offset:24576
    ds_read_b64_tr_b16 a[146:147], v5 offset:25088
    v_rcp_f32 v217, v217
    v_mfma_f32_32x32x16_bf16 v[80:95], a[152:155], a[96:99], v[80:95]
    ds_read_b64_tr_b16 a[148:149], v5 offset:26624
    ds_read_b64_tr_b16 a[150:151], v5 offset:27136
    buffer_load_dwordx4 v13, s[48:51], s3 offen offset:3072 lds
    v_mul_f32 v218, v218, v216
    v_mul_f32 v219, v219, v217
    v_cvt_pk_bf16_f32 v172, v218, v219
    v_mfma_f32_32x32x16_bf16 v[80:95], a[156:159], a[100:103], v[80:95]
    s_waitcnt lgkmcnt(8)
    ds_read_b64_tr_b16 a[152:153], v5 offset:28672
    ds_read_b64_tr_b16 a[154:155], v5 offset:29184
    v_mul_f32 v220, v74, v74
    v_mul_f32 v221, v75, v75
    v_mfma_f32_32x32x16_bf16 v[80:95], a[160:163], a[104:107], v[80:95]
    s_add_u32 m0, s68, 77824
    s_add_u32 s3, s72, 294912
    ds_read_b64_tr_b16 a[156:157], v5 offset:30720
    ds_read_b64_tr_b16 a[158:159], v5 offset:31232
    buffer_load_dwordx4 v10, s[48:51], s3 offen offset:0 lds
    v_fma_f32 v220, v220, v15, v14
    v_mfma_f32_32x32x16_bf16 v[80:95], a[164:167], a[108:111], v[80:95]
    s_waitcnt lgkmcnt(8)
    ds_read_b64_tr_b16 a[160:161], v5 offset:32768
    ds_read_b64_tr_b16 a[162:163], v5 offset:33280
    v_fma_f32 v221, v221, v15, v14
    v_mul_f32 v220, v74, v220
    v_mul_f32 v221, v75, v221
    v_mfma_f32_32x32x16_bf16 v[80:95], a[168:171], a[112:115], v[80:95]
    ds_read_b64_tr_b16 a[164:165], v5 offset:34816
    ds_read_b64_tr_b16 a[166:167], v5 offset:35328
    buffer_load_dwordx4 v11, s[48:51], s3 offen offset:1024 lds
    v_exp_f32 v220, v220
    v_mfma_f32_32x32x16_bf16 v[80:95], a[172:175], a[116:119], v[80:95]
    s_waitcnt lgkmcnt(8)
    ds_read_b64_tr_b16 a[168:169], v9 offset:0
    ds_read_b64_tr_b16 a[170:171], v9 offset:512
    v_exp_f32 v221, v221
    v_mul_f32 v222, v74, v138
    v_mfma_f32_32x32x16_bf16 v[80:95], a[144:147], a[120:123], v[80:95]
    ds_read_b64_tr_b16 a[172:173], v9 offset:2048
    ds_read_b64_tr_b16 a[174:175], v9 offset:2560
    buffer_load_dwordx4 v12, s[48:51], s3 offen offset:2048 lds
    v_mul_f32 v223, v75, v139
    v_fma_f32 v220, v220, v254, v254
    v_mfma_f32_32x32x16_bf16 v[80:95], a[148:151], a[124:127], v[80:95]
    s_waitcnt lgkmcnt(8)
    ds_read_b64_tr_b16 a[144:145], v9 offset:4096
    ds_read_b64_tr_b16 a[146:147], v9 offset:4608
    v_fma_f32 v221, v221, v254, v254
    v_rcp_f32 v220, v220
    v_mfma_f32_32x32x16_bf16 v[80:95], a[152:155], a[128:131], v[80:95]
    ds_read_b64_tr_b16 a[148:149], v9 offset:6144
    ds_read_b64_tr_b16 a[150:151], v9 offset:6656
    buffer_load_dwordx4 v13, s[48:51], s3 offen offset:3072 lds
    v_rcp_f32 v221, v221
    v_mul_f32 v222, v222, v220
    v_mfma_f32_32x32x16_bf16 v[80:95], a[156:159], a[132:135], v[80:95]
    s_waitcnt lgkmcnt(8)
    ds_read_b64_tr_b16 a[152:153], v9 offset:8192
    ds_read_b64_tr_b16 a[154:155], v9 offset:8704
    v_mul_f32 v223, v223, v221
    v_cvt_pk_bf16_f32 v173, v222, v223
    v_mfma_f32_32x32x16_bf16 v[80:95], a[160:163], a[136:139], v[80:95]
    s_add_u32 m0, s68, 81920
    s_add_u32 s3, s72, 589824
    ds_read_b64_tr_b16 a[156:157], v9 offset:10240
    ds_read_b64_tr_b16 a[158:159], v9 offset:10752
    buffer_load_dwordx4 v10, s[48:51], s3 offen offset:0 lds
    v_mul_f32 v216, v76, v76
    v_mfma_f32_32x32x16_bf16 v[80:95], a[164:167], a[140:143], v[80:95]
    s_waitcnt lgkmcnt(8)
    ds_read_b64_tr_b16 a[160:161], v9 offset:12288
    ds_read_b64_tr_b16 a[162:163], v9 offset:12800
    v_mul_f32 v217, v77, v77
    v_fma_f32 v216, v216, v15, v14
    v_fma_f32 v217, v217, v15, v14
    v_mfma_f32_32x32x16_bf16 v[96:111], a[168:171], a[72:75], v[96:111]
    ds_read_b64_tr_b16 a[164:165], v9 offset:14336
    ds_read_b64_tr_b16 a[166:167], v9 offset:14848
    v_mul_f32 v216, v76, v216
    v_mul_f32 v217, v77, v217
    v_exp_f32 v216, v216
    v_mfma_f32_32x32x16_bf16 v[96:111], a[172:175], a[76:79], v[96:111]
    s_waitcnt lgkmcnt(8)
    ds_read_b64_tr_b16 a[168:169], v9 offset:16384
    ds_read_b64_tr_b16 a[170:171], v9 offset:16896
    v_exp_f32 v217, v217
    v_mfma_f32_32x32x16_bf16 v[96:111], a[144:147], a[80:83], v[96:111]
    ds_read_b64_tr_b16 a[172:173], v9 offset:18432
    ds_read_b64_tr_b16 a[174:175], v9 offset:18944
    v_mul_f32 v218, v76, v140
    v_mul_f32 v219, v77, v141
    v_fma_f32 v216, v216, v254, v254
    v_mfma_f32_32x32x16_bf16 v[96:111], a[148:151], a[84:87], v[96:111]
    s_waitcnt lgkmcnt(8)
    ds_read_b64_tr_b16 a[144:145], v9 offset:20480
    ds_read_b64_tr_b16 a[146:147], v9 offset:20992
    v_fma_f32 v217, v217, v254, v254
    v_rcp_f32 v216, v216
    v_mfma_f32_32x32x16_bf16 v[96:111], a[152:155], a[88:91], v[96:111]
    ds_read_b64_tr_b16 a[148:149], v9 offset:22528
    ds_read_b64_tr_b16 a[150:151], v9 offset:23040
    v_rcp_f32 v217, v217
    v_mul_f32 v218, v218, v216
    v_mfma_f32_32x32x16_bf16 v[96:111], a[156:159], a[92:95], v[96:111]
    s_waitcnt lgkmcnt(8)
    ds_read_b64_tr_b16 a[152:153], v9 offset:24576
    ds_read_b64_tr_b16 a[154:155], v9 offset:25088
    v_mul_f32 v219, v219, v217
    v_cvt_pk_bf16_f32 v174, v218, v219
    v_mul_f32 v220, v78, v78
    v_mfma_f32_32x32x16_bf16 v[96:111], a[160:163], a[96:99], v[96:111]
    ds_read_b64_tr_b16 a[156:157], v9 offset:26624
    ds_read_b64_tr_b16 a[158:159], v9 offset:27136
    v_mul_f32 v221, v79, v79
    v_fma_f32 v220, v220, v15, v14
    v_fma_f32 v221, v221, v15, v14
    v_mfma_f32_32x32x16_bf16 v[96:111], a[164:167], a[100:103], v[96:111]
    s_waitcnt lgkmcnt(8)
    ds_read_b64_tr_b16 a[160:161], v9 offset:28672
    ds_read_b64_tr_b16 a[162:163], v9 offset:29184
    v_mul_f32 v220, v78, v220
    v_mul_f32 v221, v79, v221
    v_mfma_f32_32x32x16_bf16 v[96:111], a[168:171], a[104:107], v[96:111]
    ds_read_b64_tr_b16 a[164:165], v9 offset:30720
    ds_read_b64_tr_b16 a[166:167], v9 offset:31232
    v_exp_f32 v220, v220
    v_exp_f32 v221, v221
    v_mfma_f32_32x32x16_bf16 v[96:111], a[172:175], a[108:111], v[96:111]
    s_waitcnt lgkmcnt(8)
    ds_read_b64_tr_b16 a[168:169], v9 offset:32768
    ds_read_b64_tr_b16 a[170:171], v9 offset:33280
    v_mul_f32 v222, v78, v142
    v_mul_f32 v223, v79, v143
    v_fma_f32 v220, v220, v254, v254
    v_mfma_f32_32x32x16_bf16 v[96:111], a[144:147], a[112:115], v[96:111]
    ds_read_b64_tr_b16 a[172:173], v9 offset:34816
    ds_read_b64_tr_b16 a[174:175], v9 offset:35328
    v_fma_f32 v221, v221, v254, v254
    v_rcp_f32 v220, v220
    v_mfma_f32_32x32x16_bf16 v[96:111], a[148:151], a[116:119], v[96:111]
    s_waitcnt vmcnt(22)
    s_barrier
    s_waitcnt lgkmcnt(8)
    ds_read_b64_tr_b16 a[144:145], v2 offset:0
    ds_read_b64_tr_b16 a[146:147], v2 offset:512
    v_mfma_f32_32x32x16_bf16 v[96:111], a[152:155], a[120:123], v[96:111]
    ds_read_b64_tr_b16 a[148:149], v2 offset:2048
    ds_read_b64_tr_b16 a[150:151], v2 offset:2560
    v_rcp_f32 v221, v221
    v_mul_f32 v222, v222, v220
    v_mul_f32 v223, v223, v221
    v_mfma_f32_32x32x16_bf16 v[96:111], a[156:159], a[124:127], v[96:111]
    s_waitcnt lgkmcnt(8)
    ds_read_b64_tr_b16 a[152:153], v2 offset:4096
    ds_read_b64_tr_b16 a[154:155], v2 offset:4608
    v_cvt_pk_bf16_f32 v175, v222, v223
    v_mfma_f32_32x32x16_bf16 v[96:111], a[160:163], a[128:131], v[96:111]
    s_add_u32 s35, s32, 6144
    ds_read_b64_tr_b16 a[156:157], v2 offset:6144
    ds_read_b64_tr_b16 a[158:159], v2 offset:6656
    buffer_store_dwordx4 v[168:171], v1, s[56:59], s35 offen sc1
    v_mfma_f32_32x32x16_bf16 v[96:111], a[164:167], a[132:135], v[96:111]
    s_waitcnt lgkmcnt(8)
    ds_read_b64_tr_b16 a[160:161], v2 offset:8192
    ds_read_b64_tr_b16 a[162:163], v2 offset:8704
    v_mfma_f32_32x32x16_bf16 v[96:111], a[168:171], a[136:139], v[96:111]
    ds_read_b64_tr_b16 a[164:165], v2 offset:10240
    ds_read_b64_tr_b16 a[166:167], v2 offset:10752
    buffer_store_dwordx4 v[172:175], v1, s[56:59], s35 offen offset:1024 sc1
    v_mfma_f32_32x32x16_bf16 v[96:111], a[172:175], a[140:143], v[96:111]
    s_waitcnt lgkmcnt(8)
    s_barrier
    ds_read_b64_tr_b16 a[168:169], v2 offset:12288
    ds_read_b64_tr_b16 a[170:171], v2 offset:12800
    v_mfma_f32_32x32x16_bf16 v[48:63], a[144:147], a[0:3], 0
    s_add_u32 m0, s68, 110592
    s_add_u32 s3, s72, 2654208
    ds_read_b64_tr_b16 a[172:173], v2 offset:14336
    ds_read_b64_tr_b16 a[174:175], v2 offset:14848
    buffer_load_dwordx4 v10, s[48:51], s3 offen offset:0 lds
    v_mfma_f32_32x32x16_bf16 v[48:63], a[148:151], a[4:7], v[48:63]
    s_waitcnt lgkmcnt(8)
    ds_read_b64_tr_b16 a[144:145], v2 offset:16384
    ds_read_b64_tr_b16 a[146:147], v2 offset:16896
    v_mul_f32 v216, v16, v16
    v_mul_f32 v217, v17, v17
    v_mfma_f32_32x32x16_bf16 v[48:63], a[152:155], a[8:11], v[48:63]
    ds_read_b64_tr_b16 a[148:149], v2 offset:18432
    ds_read_b64_tr_b16 a[150:151], v2 offset:18944
    buffer_load_dwordx4 v11, s[48:51], s3 offen offset:1024 lds
    v_fma_f32 v216, v216, v15, v14
    v_fma_f32 v217, v217, v15, v14
    v_mul_f32 v216, v16, v216
    v_mfma_f32_32x32x16_bf16 v[48:63], a[156:159], a[12:15], v[48:63]
    s_waitcnt lgkmcnt(8)
    ds_read_b64_tr_b16 a[152:153], v2 offset:20480
    ds_read_b64_tr_b16 a[154:155], v2 offset:20992
    v_mul_f32 v217, v17, v217
    v_exp_f32 v216, v216
    v_mfma_f32_32x32x16_bf16 v[48:63], a[160:163], a[16:19], v[48:63]
    ds_read_b64_tr_b16 a[156:157], v2 offset:22528
    ds_read_b64_tr_b16 a[158:159], v2 offset:23040
    buffer_load_dwordx4 v12, s[48:51], s3 offen offset:2048 lds
    v_exp_f32 v217, v217
    v_mfma_f32_32x32x16_bf16 v[48:63], a[164:167], a[20:23], v[48:63]
    s_waitcnt lgkmcnt(8)
    ds_read_b64_tr_b16 a[160:161], v2 offset:24576
    ds_read_b64_tr_b16 a[162:163], v2 offset:25088
    v_mul_f32 v218, v16, v80
    v_mul_f32 v219, v17, v81
    v_mfma_f32_32x32x16_bf16 v[48:63], a[168:171], a[24:27], v[48:63]
    ds_read_b64_tr_b16 a[164:165], v2 offset:26624
    ds_read_b64_tr_b16 a[166:167], v2 offset:27136
    buffer_load_dwordx4 v13, s[48:51], s3 offen offset:3072 lds
    v_fma_f32 v216, v216, v254, v254
    v_fma_f32 v217, v217, v254, v254
    v_mfma_f32_32x32x16_bf16 v[48:63], a[172:175], a[28:31], v[48:63]
    s_waitcnt lgkmcnt(8)
    ds_read_b64_tr_b16 a[168:169], v2 offset:28672
    ds_read_b64_tr_b16 a[170:171], v2 offset:29184
    v_rcp_f32 v216, v216
    v_mfma_f32_32x32x16_bf16 v[48:63], a[144:147], a[32:35], v[48:63]
    s_add_u32 m0, s68, 114688
    s_add_u32 s3, s72, 2949120
    s_cmp_eq_u32 s64, 1
    s_cselect_b32 s96, 1, 0
    ds_read_b64_tr_b16 a[172:173], v2 offset:30720
    ds_read_b64_tr_b16 a[174:175], v2 offset:31232
    buffer_load_dwordx4 v10, s[48:51], s3 offen offset:0 lds
    v_mfma_f32_32x32x16_bf16 v[48:63], a[148:151], a[36:39], v[48:63]
    s_waitcnt lgkmcnt(8)
    ds_read_b64_tr_b16 a[144:145], v2 offset:32768
    ds_read_b64_tr_b16 a[146:147], v2 offset:33280
    v_rcp_f32 v217, v217
    v_mul_f32 v218, v218, v216
    v_mfma_f32_32x32x16_bf16 v[48:63], a[152:155], a[40:43], v[48:63]
    ds_read_b64_tr_b16 a[148:149], v2 offset:34816
    ds_read_b64_tr_b16 a[150:151], v2 offset:35328
    buffer_load_dwordx4 v11, s[48:51], s3 offen offset:1024 lds
    v_mul_f32 v219, v219, v217
    v_cvt_pk_bf16_f32 v176, v218, v219
    v_mul_f32 v220, v18, v18
    v_mfma_f32_32x32x16_bf16 v[48:63], a[156:159], a[44:47], v[48:63]
    s_waitcnt lgkmcnt(8)
    ds_read_b64_tr_b16 a[152:153], v6 offset:0
    ds_read_b64_tr_b16 a[154:155], v6 offset:512
    v_mul_f32 v221, v19, v19
    v_fma_f32 v220, v220, v15, v14
    v_fma_f32 v221, v221, v15, v14
    v_mov_b32 v228, v232
    v_mfma_f32_32x32x16_bf16 v[48:63], a[160:163], a[48:51], v[48:63]
    ds_read_b64_tr_b16 a[156:157], v6 offset:2048
    ds_read_b64_tr_b16 a[158:159], v6 offset:2560
    buffer_load_dwordx4 v12, s[48:51], s3 offen offset:2048 lds
    v_mul_f32 v220, v18, v220
    v_mul_f32 v221, v19, v221
    v_mfma_f32_32x32x16_bf16 v[48:63], a[164:167], a[52:55], v[48:63]
    s_waitcnt lgkmcnt(8)
    ds_read_b64_tr_b16 a[160:161], v6 offset:4096
    ds_read_b64_tr_b16 a[162:163], v6 offset:4608
    v_exp_f32 v220, v220
    v_mfma_f32_32x32x16_bf16 v[48:63], a[168:171], a[56:59], v[48:63]
    ds_read_b64_tr_b16 a[164:165], v6 offset:6144
    ds_read_b64_tr_b16 a[166:167], v6 offset:6656
    buffer_load_dwordx4 v13, s[48:51], s3 offen offset:3072 lds
    v_exp_f32 v221, v221
    v_mul_f32 v222, v18, v82
    v_mfma_f32_32x32x16_bf16 v[48:63], a[172:175], a[60:63], v[48:63]
    s_waitcnt lgkmcnt(8)
    ds_read_b64_tr_b16 a[168:169], v6 offset:8192
    ds_read_b64_tr_b16 a[170:171], v6 offset:8704
    v_mul_f32 v223, v19, v83
    v_fma_f32 v220, v220, v254, v254
    v_fma_f32 v221, v221, v254, v254
    v_mfma_f32_32x32x16_bf16 v[48:63], a[144:147], a[64:67], v[48:63]
    s_add_u32 m0, s68, 118784
    s_add_u32 s3, s72, 3244032
    ds_read_b64_tr_b16 a[172:173], v6 offset:10240
    ds_read_b64_tr_b16 a[174:175], v6 offset:10752
    buffer_load_dwordx4 v10, s[48:51], s3 offen offset:0 lds
    v_mfma_f32_32x32x16_bf16 v[48:63], a[148:151], a[68:71], v[48:63]
    s_waitcnt lgkmcnt(8)
    ds_read_b64_tr_b16 a[144:145], v6 offset:12288
    ds_read_b64_tr_b16 a[146:147], v6 offset:12800
    v_rcp_f32 v220, v220
    v_mfma_f32_32x32x16_bf16 v[64:79], a[152:155], a[0:3], 0
    ds_read_b64_tr_b16 a[148:149], v6 offset:14336
    ds_read_b64_tr_b16 a[150:151], v6 offset:14848
    v_rcp_f32 v221, v221
    v_mul_f32 v222, v222, v220
    v_mul_f32 v223, v223, v221
    v_mfma_f32_32x32x16_bf16 v[64:79], a[156:159], a[4:7], v[64:79]
    s_waitcnt lgkmcnt(8)
    ds_read_b64_tr_b16 a[152:153], v6 offset:16384
    ds_read_b64_tr_b16 a[154:155], v6 offset:16896
    v_cvt_pk_bf16_f32 v177, v222, v223
    v_mul_f32 v216, v20, v20
    v_mul_f32 v217, v21, v21
    v_mfma_f32_32x32x16_bf16 v[64:79], a[160:163], a[8:11], v[64:79]
    ds_read_b64_tr_b16 a[156:157], v6 offset:18432
    ds_read_b64_tr_b16 a[158:159], v6 offset:18944
    v_fma_f32 v216, v216, v15, v14
    v_fma_f32 v217, v217, v15, v14
    v_mul_f32 v216, v20, v216
    v_mul_f32 v217, v21, v217
    v_mfma_f32_32x32x16_bf16 v[64:79], a[164:167], a[12:15], v[64:79]
    s_waitcnt lgkmcnt(8)
    ds_read_b64_tr_b16 a[160:161], v6 offset:20480
    ds_read_b64_tr_b16 a[162:163], v6 offset:20992
    v_exp_f32 v216, v216
    v_mfma_f32_32x32x16_bf16 v[64:79], a[168:171], a[16:19], v[64:79]
    ds_read_b64_tr_b16 a[164:165], v6 offset:22528
    ds_read_b64_tr_b16 a[166:167], v6 offset:23040
    v_exp_f32 v217, v217
    v_mul_f32 v218, v20, v84
    v_mul_f32 v219, v21, v85
    v_mfma_f32_32x32x16_bf16 v[64:79], a[172:175], a[20:23], v[64:79]
    s_waitcnt lgkmcnt(8)
    ds_read_b64_tr_b16 a[168:169], v6 offset:24576
    ds_read_b64_tr_b16 a[170:171], v6 offset:25088
    v_fma_f32 v216, v216, v254, v254
    v_fma_f32 v217, v217, v254, v254
    v_mfma_f32_32x32x16_bf16 v[64:79], a[144:147], a[24:27], v[64:79]
    ds_read_b64_tr_b16 a[172:173], v6 offset:26624
    ds_read_b64_tr_b16 a[174:175], v6 offset:27136
    v_rcp_f32 v216, v216
    v_rcp_f32 v217, v217
    v_mfma_f32_32x32x16_bf16 v[64:79], a[148:151], a[28:31], v[64:79]
    s_waitcnt lgkmcnt(8)
    ds_read_b64_tr_b16 a[144:145], v6 offset:28672
    ds_read_b64_tr_b16 a[146:147], v6 offset:29184
    v_mul_f32 v218, v218, v216
    v_mul_f32 v219, v219, v217
    v_mfma_f32_32x32x16_bf16 v[64:79], a[152:155], a[32:35], v[64:79]
    ds_read_b64_tr_b16 a[148:149], v6 offset:30720
    ds_read_b64_tr_b16 a[150:151], v6 offset:31232
    v_cvt_pk_bf16_f32 v178, v218, v219
    v_mul_f32 v220, v22, v22
    v_mul_f32 v221, v23, v23
    v_fma_f32 v220, v220, v15, v14
    v_mfma_f32_32x32x16_bf16 v[64:79], a[156:159], a[36:39], v[64:79]
    s_waitcnt lgkmcnt(8)
    ds_read_b64_tr_b16 a[152:153], v6 offset:32768
    ds_read_b64_tr_b16 a[154:155], v6 offset:33280
    v_fma_f32 v221, v221, v15, v14
    v_mul_f32 v220, v22, v220
    v_mfma_f32_32x32x16_bf16 v[64:79], a[160:163], a[40:43], v[64:79]
    ds_read_b64_tr_b16 a[156:157], v6 offset:34816
    ds_read_b64_tr_b16 a[158:159], v6 offset:35328
    v_mul_f32 v221, v23, v221
    v_exp_f32 v220, v220
    v_mfma_f32_32x32x16_bf16 v[64:79], a[164:167], a[44:47], v[64:79]
    s_waitcnt vmcnt(20)
    s_barrier
    s_waitcnt lgkmcnt(8)
    ds_read_b64_tr_b16 a[160:161], v3 offset:0
    ds_read_b64_tr_b16 a[162:163], v3 offset:512
    v_mfma_f32_32x32x16_bf16 v[64:79], a[168:171], a[48:51], v[64:79]
    ds_read_b64_tr_b16 a[164:165], v3 offset:2048
    ds_read_b64_tr_b16 a[166:167], v3 offset:2560
    v_exp_f32 v221, v221
    v_mul_f32 v222, v22, v86
    v_mul_f32 v223, v23, v87
    v_mfma_f32_32x32x16_bf16 v[64:79], a[172:175], a[52:55], v[64:79]
    s_waitcnt lgkmcnt(8)
    ds_read_b64_tr_b16 a[168:169], v3 offset:4096
    ds_read_b64_tr_b16 a[170:171], v3 offset:4608
    v_fma_f32 v220, v220, v254, v254
    v_fma_f32 v221, v221, v254, v254
    v_mfma_f32_32x32x16_bf16 v[64:79], a[144:147], a[56:59], v[64:79]
    ds_read_b64_tr_b16 a[172:173], v3 offset:6144
    ds_read_b64_tr_b16 a[174:175], v3 offset:6656
    v_rcp_f32 v220, v220
    v_rcp_f32 v221, v221
    v_mfma_f32_32x32x16_bf16 v[64:79], a[148:151], a[60:63], v[64:79]
    s_waitcnt lgkmcnt(8)
    ds_read_b64_tr_b16 a[144:145], v3 offset:8192
    ds_read_b64_tr_b16 a[146:147], v3 offset:8704
    v_mul_f32 v222, v222, v220
    v_mul_f32 v223, v223, v221
    v_mfma_f32_32x32x16_bf16 v[64:79], a[152:155], a[64:67], v[64:79]
    ds_read_b64_tr_b16 a[148:149], v3 offset:10240
    ds_read_b64_tr_b16 a[150:151], v3 offset:10752
    v_cvt_pk_bf16_f32 v179, v222, v223
    v_mul_f32 v216, v24, v24
    v_mul_f32 v217, v25, v25
    v_fma_f32 v216, v216, v15, v14
    v_mfma_f32_32x32x16_bf16 v[64:79], a[156:159], a[68:71], v[64:79]
    s_waitcnt lgkmcnt(8)
    s_barrier
    ds_read_b64_tr_b16 a[152:153], v3 offset:12288
    ds_read_b64_tr_b16 a[154:155], v3 offset:12800
    buffer_load_dword v230, off, s[12:15], 0 offset:128 sc1
    v_mfma_f32_32x32x16_bf16 v[48:63], a[160:163], a[72:75], v[48:63]
    ds_read_b64_tr_b16 a[156:157], v3 offset:14336
    ds_read_b64_tr_b16 a[158:159], v3 offset:14848
    v_lshrrev_b32 v226, 2, v0
    v_and_b32 v227, 3, v0
    v_lshlrev_b32 v227, 4, v227
    v_mfma_f32_32x32x16_bf16 v[48:63], a[164:167], a[76:79], v[48:63]
    s_waitcnt lgkmcnt(8)
    ds_read_b64_tr_b16 a[160:161], v3 offset:16384
    ds_read_b64_tr_b16 a[162:163], v3 offset:16896
    v_fma_f32 v217, v217, v15, v14
    v_mul_f32 v216, v24, v216
    v_mul_f32 v217, v25, v217
    v_mov_b32 v229, s64
    v_cmp_eq_u32 vcc, 1, v229
    v_nop
    v_nop
    v_cndmask_b32 v228, v228, v233, vcc
    v_cmp_eq_u32 vcc, 2, v229
    v_nop
    v_nop
    v_cndmask_b32 v228, v228, v234, vcc
    v_cmp_eq_u32 vcc, 3, v229
    v_nop
    v_nop
    v_cndmask_b32 v228, v228, v235, vcc
    v_mfma_f32_32x32x16_bf16 v[48:63], a[168:171], a[80:83], v[48:63]
    s_lshl_b32 s96, s64, 8
    s_sub_u32 s96, 1024, s96
    ds_read_b64_tr_b16 a[164:165], v3 offset:18432
    ds_read_b64_tr_b16 a[166:167], v3 offset:18944
    v_mul_u32_u24 v226, 9216, v226
    v_add_u32 v10, v226, v227
    v_add_u32 v11, 146432, v10
    v_add_u32 v12, 292864, v10
    v_add_u32 v13, 439296, v10
    v_add_u32 v228, s96, v228
    v_mfma_f32_32x32x16_bf16 v[48:63], a[172:175], a[84:87], v[48:63]
    s_waitcnt lgkmcnt(8)
    ds_read_b64_tr_b16 a[168:169], v3 offset:20480
    ds_read_b64_tr_b16 a[170:171], v3 offset:20992
    v_exp_f32 v216, v216
    v_mfma_f32_32x32x16_bf16 v[48:63], a[144:147], a[88:91], v[48:63]
    s_add_u32 m0, s68, 0
    s_add_u32 s3, s73, 0
    ds_read_b64_tr_b16 a[172:173], v3 offset:22528
    ds_read_b64_tr_b16 a[174:175], v3 offset:23040
    buffer_load_dwordx4 v10, s[44:47], s3 offen offset:0 lds
    v_mfma_f32_32x32x16_bf16 v[48:63], a[148:151], a[92:95], v[48:63]
    s_waitcnt lgkmcnt(8)
    ds_read_b64_tr_b16 a[144:145], v3 offset:24576
    ds_read_b64_tr_b16 a[146:147], v3 offset:25088
    v_exp_f32 v217, v217
    v_mul_f32 v218, v24, v88
    v_mfma_f32_32x32x16_bf16 v[48:63], a[152:155], a[96:99], v[48:63]
    ds_read_b64_tr_b16 a[148:149], v3 offset:26624
    ds_read_b64_tr_b16 a[150:151], v3 offset:27136
    buffer_load_dwordx4 v11, s[44:47], s3 offen offset:1024 lds
    v_mul_f32 v219, v25, v89
    v_fma_f32 v216, v216, v254, v254
    v_fma_f32 v217, v217, v254, v254
    v_mfma_f32_32x32x16_bf16 v[48:63], a[156:159], a[100:103], v[48:63]
    s_waitcnt lgkmcnt(8)
    ds_read_b64_tr_b16 a[152:153], v3 offset:28672
    ds_read_b64_tr_b16 a[154:155], v3 offset:29184
    v_rcp_f32 v216, v216
    v_mfma_f32_32x32x16_bf16 v[48:63], a[160:163], a[104:107], v[48:63]
    ds_read_b64_tr_b16 a[156:157], v3 offset:30720
    ds_read_b64_tr_b16 a[158:159], v3 offset:31232
    buffer_load_dwordx4 v12, s[44:47], s3 offen offset:2048 lds
    v_rcp_f32 v217, v217
    v_mul_f32 v218, v218, v216
    v_mfma_f32_32x32x16_bf16 v[48:63], a[164:167], a[108:111], v[48:63]
    s_waitcnt lgkmcnt(8)
    ds_read_b64_tr_b16 a[160:161], v3 offset:32768
    ds_read_b64_tr_b16 a[162:163], v3 offset:33280
    v_mul_f32 v219, v219, v217
    v_cvt_pk_bf16_f32 v180, v218, v219
    v_mul_f32 v220, v26, v26
    v_mfma_f32_32x32x16_bf16 v[48:63], a[168:171], a[112:115], v[48:63]
    ds_read_b64_tr_b16 a[164:165], v3 offset:34816
    ds_read_b64_tr_b16 a[166:167], v3 offset:35328
    buffer_load_dwordx4 v13, s[44:47], s3 offen offset:3072 lds
    v_mul_f32 v221, v27, v27
    v_fma_f32 v220, v220, v15, v14
    v_mfma_f32_32x32x16_bf16 v[48:63], a[172:175], a[116:119], v[48:63]
    s_waitcnt lgkmcnt(8)
    ds_read_b64_tr_b16 a[168:169], v7 offset:0
    ds_read_b64_tr_b16 a[170:171], v7 offset:512
    v_fma_f32 v221, v221, v15, v14
    v_mul_f32 v220, v26, v220
    v_mul_f32 v221, v27, v221
    v_mfma_f32_32x32x16_bf16 v[48:63], a[144:147], a[120:123], v[48:63]
    s_add_u32 m0, s68, 4096
    s_add_u32 s3, s73, 589824
    ds_read_b64_tr_b16 a[172:173], v7 offset:2048
    ds_read_b64_tr_b16 a[174:175], v7 offset:2560
    buffer_load_dwordx4 v10, s[44:47], s3 offen offset:0 lds
    v_mfma_f32_32x32x16_bf16 v[48:63], a[148:151], a[124:127], v[48:63]
    s_waitcnt lgkmcnt(8)
    ds_read_b64_tr_b16 a[144:145], v7 offset:4096
    ds_read_b64_tr_b16 a[146:147], v7 offset:4608
    v_exp_f32 v220, v220
    v_mfma_f32_32x32x16_bf16 v[48:63], a[152:155], a[128:131], v[48:63]
    ds_read_b64_tr_b16 a[148:149], v7 offset:6144
    ds_read_b64_tr_b16 a[150:151], v7 offset:6656
    buffer_load_dwordx4 v11, s[44:47], s3 offen offset:1024 lds
    v_exp_f32 v221, v221
    v_mul_f32 v222, v26, v90
    v_mfma_f32_32x32x16_bf16 v[48:63], a[156:159], a[132:135], v[48:63]
    s_waitcnt lgkmcnt(8)
    ds_read_b64_tr_b16 a[152:153], v7 offset:8192
    ds_read_b64_tr_b16 a[154:155], v7 offset:8704
    v_mul_f32 v223, v27, v91
    v_fma_f32 v220, v220, v254, v254
    v_fma_f32 v221, v221, v254, v254
    v_mfma_f32_32x32x16_bf16 v[48:63], a[160:163], a[136:139], v[48:63]
    ds_read_b64_tr_b16 a[156:157], v7 offset:10240
    ds_read_b64_tr_b16 a[158:159], v7 offset:10752
    buffer_load_dwordx4 v12, s[44:47], s3 offen offset:2048 lds
    v_rcp_f32 v220, v220
    v_mfma_f32_32x32x16_bf16 v[48:63], a[164:167], a[140:143], v[48:63]
    s_waitcnt lgkmcnt(8)
    ds_read_b64_tr_b16 a[160:161], v7 offset:12288
    ds_read_b64_tr_b16 a[162:163], v7 offset:12800
    v_rcp_f32 v221, v221
    v_mul_f32 v222, v222, v220
    v_mfma_f32_32x32x16_bf16 v[64:79], a[168:171], a[72:75], v[64:79]
    ds_read_b64_tr_b16 a[164:165], v7 offset:14336
    ds_read_b64_tr_b16 a[166:167], v7 offset:14848
    buffer_load_dwordx4 v13, s[44:47], s3 offen offset:3072 lds
    v_mul_f32 v223, v223, v221
    v_cvt_pk_bf16_f32 v181, v222, v223
    v_mul_f32 v216, v28, v28
    v_mfma_f32_32x32x16_bf16 v[64:79], a[172:175], a[76:79], v[64:79]
    s_waitcnt lgkmcnt(8)
    ds_read_b64_tr_b16 a[168:169], v7 offset:16384
    ds_read_b64_tr_b16 a[170:171], v7 offset:16896
    v_mul_f32 v217, v29, v29
    v_fma_f32 v216, v216, v15, v14
    v_mfma_f32_32x32x16_bf16 v[64:79], a[144:147], a[80:83], v[64:79]
    s_add_u32 m0, s68, 8192
    s_add_u32 s3, s73, 1179648
    ds_read_b64_tr_b16 a[172:173], v7 offset:18432
    ds_read_b64_tr_b16 a[174:175], v7 offset:18944
    buffer_load_dwordx4 v10, s[44:47], s3 offen offset:0 lds
    v_fma_f32 v217, v217, v15, v14
    v_mfma_f32_32x32x16_bf16 v[64:79], a[148:151], a[84:87], v[64:79]
    s_waitcnt lgkmcnt(8)
    ds_read_b64_tr_b16 a[144:145], v7 offset:20480
    ds_read_b64_tr_b16 a[146:147], v7 offset:20992
    v_mul_f32 v216, v28, v216
    v_mul_f32 v217, v29, v217
    v_mfma_f32_32x32x16_bf16 v[64:79], a[152:155], a[88:91], v[64:79]
    ds_read_b64_tr_b16 a[148:149], v7 offset:22528
    ds_read_b64_tr_b16 a[150:151], v7 offset:23040
    v_exp_f32 v216, v216
    v_exp_f32 v217, v217
    v_mfma_f32_32x32x16_bf16 v[64:79], a[156:159], a[92:95], v[64:79]
    s_waitcnt lgkmcnt(8)
    ds_read_b64_tr_b16 a[152:153], v7 offset:24576
    ds_read_b64_tr_b16 a[154:155], v7 offset:25088
    v_mul_f32 v218, v28, v92
    v_mul_f32 v219, v29, v93
    v_mfma_f32_32x32x16_bf16 v[64:79], a[160:163], a[96:99], v[64:79]
    ds_read_b64_tr_b16 a[156:157], v7 offset:26624
    ds_read_b64_tr_b16 a[158:159], v7 offset:27136
    v_fma_f32 v216, v216, v254, v254
    v_fma_f32 v217, v217, v254, v254
    v_rcp_f32 v216, v216
    v_mfma_f32_32x32x16_bf16 v[64:79], a[164:167], a[100:103], v[64:79]
    s_waitcnt lgkmcnt(8)
    ds_read_b64_tr_b16 a[160:161], v7 offset:28672
    ds_read_b64_tr_b16 a[162:163], v7 offset:29184
    v_rcp_f32 v217, v217
    v_mfma_f32_32x32x16_bf16 v[64:79], a[168:171], a[104:107], v[64:79]
    ds_read_b64_tr_b16 a[164:165], v7 offset:30720
    ds_read_b64_tr_b16 a[166:167], v7 offset:31232
    v_mul_f32 v218, v218, v216
    v_mul_f32 v219, v219, v217
    v_cvt_pk_bf16_f32 v182, v218, v219
    v_mfma_f32_32x32x16_bf16 v[64:79], a[172:175], a[108:111], v[64:79]
    s_waitcnt lgkmcnt(8)
    ds_read_b64_tr_b16 a[168:169], v7 offset:32768
    ds_read_b64_tr_b16 a[170:171], v7 offset:33280
    v_mul_f32 v220, v30, v30
    v_mul_f32 v221, v31, v31
    v_fma_f32 v220, v220, v15, v14
    v_mfma_f32_32x32x16_bf16 v[64:79], a[144:147], a[112:115], v[64:79]
    ds_read_b64_tr_b16 a[172:173], v7 offset:34816
    ds_read_b64_tr_b16 a[174:175], v7 offset:35328
    v_fma_f32 v221, v221, v15, v14
    v_mul_f32 v220, v30, v220
    v_mul_f32 v221, v31, v221
    v_mfma_f32_32x32x16_bf16 v[64:79], a[148:151], a[116:119], v[64:79]
    s_waitcnt vmcnt(21)
    s_barrier
    s_waitcnt lgkmcnt(8)
    ds_read_b64_tr_b16 a[144:145], v4 offset:0
    ds_read_b64_tr_b16 a[146:147], v4 offset:512
    v_mfma_f32_32x32x16_bf16 v[64:79], a[152:155], a[120:123], v[64:79]
    ds_read_b64_tr_b16 a[148:149], v4 offset:2048
    ds_read_b64_tr_b16 a[150:151], v4 offset:2560
    v_exp_f32 v220, v220
    v_exp_f32 v221, v221
    v_mfma_f32_32x32x16_bf16 v[64:79], a[156:159], a[124:127], v[64:79]
    s_waitcnt lgkmcnt(8)
    ds_read_b64_tr_b16 a[152:153], v4 offset:4096
    ds_read_b64_tr_b16 a[154:155], v4 offset:4608
    v_mul_f32 v222, v30, v94
    v_mul_f32 v223, v31, v95
    v_mfma_f32_32x32x16_bf16 v[64:79], a[160:163], a[128:131], v[64:79]
    ds_read_b64_tr_b16 a[156:157], v4 offset:6144
    ds_read_b64_tr_b16 a[158:159], v4 offset:6656
    v_fma_f32 v220, v220, v254, v254
    v_fma_f32 v221, v221, v254, v254
    v_rcp_f32 v220, v220
    v_mfma_f32_32x32x16_bf16 v[64:79], a[164:167], a[132:135], v[64:79]
    s_waitcnt lgkmcnt(8)
    ds_read_b64_tr_b16 a[160:161], v4 offset:8192
    ds_read_b64_tr_b16 a[162:163], v4 offset:8704
    v_rcp_f32 v221, v221
    v_mfma_f32_32x32x16_bf16 v[64:79], a[168:171], a[136:139], v[64:79]
    ds_read_b64_tr_b16 a[164:165], v4 offset:10240
    ds_read_b64_tr_b16 a[166:167], v4 offset:10752
    v_mul_f32 v222, v222, v220
    v_mul_f32 v223, v223, v221
    v_cvt_pk_bf16_f32 v183, v222, v223
    v_mfma_f32_32x32x16_bf16 v[64:79], a[172:175], a[140:143], v[64:79]
    s_waitcnt lgkmcnt(8)
    s_barrier
    ds_read_b64_tr_b16 a[168:169], v4 offset:12288
    ds_read_b64_tr_b16 a[170:171], v4 offset:12800
    v_mfma_f32_32x32x16_bf16 v[112:127], a[144:147], a[0:3], 0
    s_add_u32 m0, s68, 36864
    s_add_u32 s3, s73, 0
    s_add_u32 s34, s32, 8192
    ds_read_b64_tr_b16 a[172:173], v4 offset:14336
    ds_read_b64_tr_b16 a[174:175], v4 offset:14848
    buffer_load_dwordx4 v10, s[48:51], s3 offen offset:0 lds
    v_mfma_f32_32x32x16_bf16 v[112:127], a[148:151], a[4:7], v[112:127]
    s_waitcnt lgkmcnt(8)
    ds_read_b64_tr_b16 a[144:145], v4 offset:16384
    ds_read_b64_tr_b16 a[146:147], v4 offset:16896
    buffer_store_dwordx4 v[176:179], v1, s[56:59], s34 offen sc1
    v_mfma_f32_32x32x16_bf16 v[112:127], a[152:155], a[8:11], v[112:127]
    ds_read_b64_tr_b16 a[148:149], v4 offset:18432
    ds_read_b64_tr_b16 a[150:151], v4 offset:18944
    buffer_load_dwordx4 v11, s[48:51], s3 offen offset:1024 lds
    v_mfma_f32_32x32x16_bf16 v[112:127], a[156:159], a[12:15], v[112:127]
    s_waitcnt lgkmcnt(8)
    ds_read_b64_tr_b16 a[152:153], v4 offset:20480
    ds_read_b64_tr_b16 a[154:155], v4 offset:20992
    buffer_store_dwordx4 v[180:183], v1, s[56:59], s34 offen offset:1024 sc1
    v_mfma_f32_32x32x16_bf16 v[112:127], a[160:163], a[16:19], v[112:127]
    ds_read_b64_tr_b16 a[156:157], v4 offset:22528
    ds_read_b64_tr_b16 a[158:159], v4 offset:23040
    buffer_load_dwordx4 v12, s[48:51], s3 offen offset:2048 lds
    v_mul_f32 v224, v64, v64
    v_mul_f32 v225, v65, v65
    v_fma_f32 v224, v224, v15, v14
    v_fma_f32 v225, v225, v15, v14
    v_mfma_f32_32x32x16_bf16 v[112:127], a[164:167], a[20:23], v[112:127]
    s_waitcnt lgkmcnt(8)
    ds_read_b64_tr_b16 a[160:161], v4 offset:24576
    ds_read_b64_tr_b16 a[162:163], v4 offset:25088
    v_mul_f32 v216, v32, v32
    v_mul_f32 v217, v33, v33
    v_mul_f32 v224, v64, v224
    v_mul_f32 v225, v65, v225
    v_mfma_f32_32x32x16_bf16 v[112:127], a[168:171], a[24:27], v[112:127]
    ds_read_b64_tr_b16 a[164:165], v4 offset:26624
    ds_read_b64_tr_b16 a[166:167], v4 offset:27136
    buffer_load_dwordx4 v13, s[48:51], s3 offen offset:3072 lds
    v_fma_f32 v216, v216, v15, v14
    v_fma_f32 v217, v217, v15, v14
    v_mul_f32 v216, v32, v216
    v_exp_f32 v224, v224
    v_mfma_f32_32x32x16_bf16 v[112:127], a[172:175], a[28:31], v[112:127]
    s_waitcnt lgkmcnt(8)
    ds_read_b64_tr_b16 a[168:169], v4 offset:28672
    ds_read_b64_tr_b16 a[170:171], v4 offset:29184
    v_mul_f32 v217, v33, v217
    v_exp_f32 v216, v216
    v_exp_f32 v225, v225
    v_mfma_f32_32x32x16_bf16 v[112:127], a[144:147], a[32:35], v[112:127]
    s_add_u32 m0, s68, 40960
    s_add_u32 s3, s73, 589824
    ds_read_b64_tr_b16 a[172:173], v4 offset:30720
    ds_read_b64_tr_b16 a[174:175], v4 offset:31232
    buffer_load_dwordx4 v10, s[48:51], s3 offen offset:0 lds
    v_fma_f32 v224, v224, v254, v254
    v_fma_f32 v225, v225, v254, v254
    v_mfma_f32_32x32x16_bf16 v[112:127], a[148:151], a[36:39], v[112:127]
    s_waitcnt lgkmcnt(8)
    ds_read_b64_tr_b16 a[144:145], v4 offset:32768
    ds_read_b64_tr_b16 a[146:147], v4 offset:33280
    v_exp_f32 v217, v217
    v_mul_f32 v218, v32, v96
    v_rcp_f32 v224, v224
    v_mfma_f32_32x32x16_bf16 v[112:127], a[152:155], a[40:43], v[112:127]
    ds_read_b64_tr_b16 a[148:149], v4 offset:34816
    ds_read_b64_tr_b16 a[150:151], v4 offset:35328
    buffer_load_dwordx4 v11, s[48:51], s3 offen offset:1024 lds
    v_mul_f32 v219, v33, v97
    v_fma_f32 v216, v216, v254, v254
    v_rcp_f32 v225, v225
    v_mul_f32 v64, v64, v224
    v_mfma_f32_32x32x16_bf16 v[112:127], a[156:159], a[44:47], v[112:127]
    s_waitcnt lgkmcnt(8)
    ds_read_b64_tr_b16 a[152:153], v8 offset:0
    ds_read_b64_tr_b16 a[154:155], v8 offset:512
    v_fma_f32 v217, v217, v254, v254
    v_rcp_f32 v216, v216
    v_mul_f32 v65, v65, v225
    v_mul_f32 v226, v66, v66
    v_mfma_f32_32x32x16_bf16 v[112:127], a[160:163], a[48:51], v[112:127]
    ds_read_b64_tr_b16 a[156:157], v8 offset:2048
    ds_read_b64_tr_b16 a[158:159], v8 offset:2560
    buffer_load_dwordx4 v12, s[48:51], s3 offen offset:2048 lds
    v_rcp_f32 v217, v217
    v_mul_f32 v227, v67, v67
    v_fma_f32 v226, v226, v15, v14
    v_mfma_f32_32x32x16_bf16 v[112:127], a[164:167], a[52:55], v[112:127]
    s_waitcnt lgkmcnt(8)
    ds_read_b64_tr_b16 a[160:161], v8 offset:4096
    ds_read_b64_tr_b16 a[162:163], v8 offset:4608
    v_mul_f32 v218, v218, v216
    v_mul_f32 v219, v219, v217
    v_cvt_pk_bf16_f32 v184, v218, v219
    v_fma_f32 v227, v227, v15, v14
    v_mul_f32 v226, v66, v226
    v_mfma_f32_32x32x16_bf16 v[112:127], a[168:171], a[56:59], v[112:127]
    ds_read_b64_tr_b16 a[164:165], v8 offset:6144
    ds_read_b64_tr_b16 a[166:167], v8 offset:6656
    buffer_load_dwordx4 v13, s[48:51], s3 offen offset:3072 lds
    v_mul_f32 v220, v34, v34
    v_mul_f32 v221, v35, v35
    v_mul_f32 v227, v67, v227
    v_exp_f32 v226, v226
    v_mfma_f32_32x32x16_bf16 v[112:127], a[172:175], a[60:63], v[112:127]
    s_waitcnt lgkmcnt(8)
    ds_read_b64_tr_b16 a[168:169], v8 offset:8192
    ds_read_b64_tr_b16 a[170:171], v8 offset:8704
    v_fma_f32 v220, v220, v15, v14
    v_fma_f32 v221, v221, v15, v14
    v_mul_f32 v220, v34, v220
    v_exp_f32 v227, v227
    v_mfma_f32_32x32x16_bf16 v[112:127], a[144:147], a[64:67], v[112:127]
    s_add_u32 m0, s68, 45056
    s_add_u32 s3, s73, 1179648
    ds_read_b64_tr_b16 a[172:173], v8 offset:10240
    ds_read_b64_tr_b16 a[174:175], v8 offset:10752
    buffer_load_dwordx4 v10, s[48:51], s3 offen offset:0 lds
    v_mul_f32 v221, v35, v221
    v_fma_f32 v226, v226, v254, v254
    v_mfma_f32_32x32x16_bf16 v[112:127], a[148:151], a[68:71], v[112:127]
    s_waitcnt lgkmcnt(8)
    ds_read_b64_tr_b16 a[144:145], v8 offset:12288
    ds_read_b64_tr_b16 a[146:147], v8 offset:12800
    v_exp_f32 v220, v220
    v_fma_f32 v227, v227, v254, v254
    v_rcp_f32 v226, v226
    v_mfma_f32_32x32x16_bf16 v[128:143], a[152:155], a[0:3], 0
    ds_read_b64_tr_b16 a[148:149], v8 offset:14336
    ds_read_b64_tr_b16 a[150:151], v8 offset:14848
    v_exp_f32 v221, v221
    v_mul_f32 v222, v34, v98
    v_rcp_f32 v227, v227
    v_mfma_f32_32x32x16_bf16 v[128:143], a[156:159], a[4:7], v[128:143]
    s_waitcnt lgkmcnt(8)
    ds_read_b64_tr_b16 a[152:153], v8 offset:16384
    ds_read_b64_tr_b16 a[154:155], v8 offset:16896
    v_mul_f32 v223, v35, v99
    v_fma_f32 v220, v220, v254, v254
    v_fma_f32 v221, v221, v254, v254
    v_mul_f32 v66, v66, v226
    v_mul_f32 v67, v67, v227
    v_mfma_f32_32x32x16_bf16 v[128:143], a[160:163], a[8:11], v[128:143]
    ds_read_b64_tr_b16 a[156:157], v8 offset:18432
    ds_read_b64_tr_b16 a[158:159], v8 offset:18944
    v_rcp_f32 v220, v220
    v_rcp_f32 v221, v221
    v_mul_f32 v224, v68, v68
    v_mfma_f32_32x32x16_bf16 v[128:143], a[164:167], a[12:15], v[128:143]
    s_waitcnt lgkmcnt(8)
    ds_read_b64_tr_b16 a[160:161], v8 offset:20480
    ds_read_b64_tr_b16 a[162:163], v8 offset:20992
    v_mul_f32 v222, v222, v220
    v_mul_f32 v223, v223, v221
    v_mul_f32 v225, v69, v69
    v_fma_f32 v224, v224, v15, v14
    v_fma_f32 v225, v225, v15, v14
    v_mfma_f32_32x32x16_bf16 v[128:143], a[168:171], a[16:19], v[128:143]
    ds_read_b64_tr_b16 a[164:165], v8 offset:22528
    ds_read_b64_tr_b16 a[166:167], v8 offset:23040
    v_cvt_pk_bf16_f32 v185, v222, v223
    v_mul_f32 v216, v36, v36
    v_mul_f32 v217, v37, v37
    v_mul_f32 v224, v68, v224
    v_mul_f32 v225, v69, v225
    v_mfma_f32_32x32x16_bf16 v[128:143], a[172:175], a[20:23], v[128:143]
    s_waitcnt lgkmcnt(8)
    ds_read_b64_tr_b16 a[168:169], v8 offset:24576
    ds_read_b64_tr_b16 a[170:171], v8 offset:25088
    v_fma_f32 v216, v216, v15, v14
    v_fma_f32 v217, v217, v15, v14
    v_mul_f32 v216, v36, v216
    v_exp_f32 v224, v224
    v_mfma_f32_32x32x16_bf16 v[128:143], a[144:147], a[24:27], v[128:143]
    ds_read_b64_tr_b16 a[172:173], v8 offset:26624
    ds_read_b64_tr_b16 a[174:175], v8 offset:27136
    v_mul_f32 v217, v37, v217
    v_exp_f32 v216, v216
    v_exp_f32 v225, v225
    v_fma_f32 v224, v224, v254, v254
    v_mfma_f32_32x32x16_bf16 v[128:143], a[148:151], a[28:31], v[128:143]
    s_waitcnt lgkmcnt(8)
    ds_read_b64_tr_b16 a[144:145], v8 offset:28672
    ds_read_b64_tr_b16 a[146:147], v8 offset:29184
    v_exp_f32 v217, v217
    v_fma_f32 v225, v225, v254, v254
    v_rcp_f32 v224, v224
    v_mfma_f32_32x32x16_bf16 v[128:143], a[152:155], a[32:35], v[128:143]
    ds_read_b64_tr_b16 a[148:149], v8 offset:30720
    ds_read_b64_tr_b16 a[150:151], v8 offset:31232
    v_mul_f32 v218, v36, v100
    v_mul_f32 v219, v37, v101
    v_fma_f32 v216, v216, v254, v254
    v_fma_f32 v217, v217, v254, v254
    v_mfma_f32_32x32x16_bf16 v[128:143], a[156:159], a[36:39], v[128:143]
    s_waitcnt lgkmcnt(8)
    ds_read_b64_tr_b16 a[152:153], v8 offset:32768
    ds_read_b64_tr_b16 a[154:155], v8 offset:33280
    v_rcp_f32 v216, v216
    v_rcp_f32 v225, v225
    v_mul_f32 v68, v68, v224
    v_mfma_f32_32x32x16_bf16 v[128:143], a[160:163], a[40:43], v[128:143]
    ds_read_b64_tr_b16 a[156:157], v8 offset:34816
    ds_read_b64_tr_b16 a[158:159], v8 offset:35328
    v_rcp_f32 v217, v217
    v_mul_f32 v218, v218, v216
    v_mul_f32 v219, v219, v217
    v_mul_f32 v69, v69, v225
    v_mul_f32 v226, v70, v70
    v_mfma_f32_32x32x16_bf16 v[128:143], a[164:167], a[44:47], v[128:143]
    s_waitcnt vmcnt(21)
    s_barrier
    s_waitcnt lgkmcnt(8)
    ds_read_b64_tr_b16 a[160:161], v5 offset:0
    ds_read_b64_tr_b16 a[162:163], v5 offset:512
    v_mul_f32 v227, v71, v71
    v_fma_f32 v226, v226, v15, v14
    v_mfma_f32_32x32x16_bf16 v[128:143], a[168:171], a[48:51], v[128:143]
    ds_read_b64_tr_b16 a[164:165], v5 offset:2048
    ds_read_b64_tr_b16 a[166:167], v5 offset:2560
    v_cvt_pk_bf16_f32 v186, v218, v219
    v_mul_f32 v220, v38, v38
    v_mul_f32 v221, v39, v39
    v_fma_f32 v227, v227, v15, v14
    v_mul_f32 v226, v70, v226
    v_mfma_f32_32x32x16_bf16 v[128:143], a[172:175], a[52:55], v[128:143]
    s_waitcnt lgkmcnt(8)
    ds_read_b64_tr_b16 a[168:169], v5 offset:4096
    ds_read_b64_tr_b16 a[170:171], v5 offset:4608
    v_fma_f32 v220, v220, v15, v14
    v_fma_f32 v221, v221, v15, v14
    v_mul_f32 v227, v71, v227
    v_exp_f32 v226, v226
    v_mfma_f32_32x32x16_bf16 v[128:143], a[144:147], a[56:59], v[128:143]
    ds_read_b64_tr_b16 a[172:173], v5 offset:6144
    ds_read_b64_tr_b16 a[174:175], v5 offset:6656
    v_mul_f32 v220, v38, v220
    v_mul_f32 v221, v39, v221
    v_exp_f32 v220, v220
    v_exp_f32 v227, v227
    v_mfma_f32_32x32x16_bf16 v[128:143], a[148:151], a[60:63], v[128:143]
    s_waitcnt lgkmcnt(8)
    ds_read_b64_tr_b16 a[144:145], v5 offset:8192
    ds_read_b64_tr_b16 a[146:147], v5 offset:8704
    v_exp_f32 v221, v221
    v_fma_f32 v226, v226, v254, v254
    v_fma_f32 v227, v227, v254, v254
    v_mfma_f32_32x32x16_bf16 v[128:143], a[152:155], a[64:67], v[128:143]
    ds_read_b64_tr_b16 a[148:149], v5 offset:10240
    ds_read_b64_tr_b16 a[150:151], v5 offset:10752
    v_mul_f32 v222, v38, v102
    v_mul_f32 v223, v39, v103
    v_fma_f32 v220, v220, v254, v254
    v_fma_f32 v221, v221, v254, v254
    v_rcp_f32 v226, v226
    v_mfma_f32_32x32x16_bf16 v[128:143], a[156:159], a[68:71], v[128:143]
    s_waitcnt lgkmcnt(8)
    s_barrier
    ds_read_b64_tr_b16 a[152:153], v5 offset:12288
    ds_read_b64_tr_b16 a[154:155], v5 offset:12800
    v_rcp_f32 v220, v220
    v_rcp_f32 v227, v227
    v_mfma_f32_32x32x16_bf16 v[112:127], a[160:163], a[72:75], v[112:127]
    s_add_u32 m0, s94, 73728
    ds_read_b64_tr_b16 a[156:157], v5 offset:14336
    ds_read_b64_tr_b16 a[158:159], v5 offset:14848
    buffer_load_dwordx4 v232, s[4:7], 0 offen offset:0 lds
    v_rcp_f32 v221, v221
    v_mul_f32 v222, v222, v220
    v_mul_f32 v70, v70, v226
    v_mfma_f32_32x32x16_bf16 v[112:127], a[164:167], a[76:79], v[112:127]
    s_waitcnt lgkmcnt(8)
    ds_read_b64_tr_b16 a[160:161], v5 offset:16384
    ds_read_b64_tr_b16 a[162:163], v5 offset:16896
    v_mul_f32 v223, v223, v221
    v_cvt_pk_bf16_f32 v187, v222, v223
    v_mul_f32 v216, v40, v40
    v_mul_f32 v71, v71, v227
    v_mul_f32 v224, v72, v72
    v_mfma_f32_32x32x16_bf16 v[112:127], a[168:171], a[80:83], v[112:127]
    s_add_u32 m0, s94, 74752
    ds_read_b64_tr_b16 a[164:165], v5 offset:18432
    ds_read_b64_tr_b16 a[166:167], v5 offset:18944
    buffer_load_dwordx4 v233, s[4:7], 0 offen offset:0 lds
    v_mul_f32 v217, v41, v41
    v_fma_f32 v216, v216, v15, v14
    v_fma_f32 v217, v217, v15, v14
    v_mul_f32 v225, v73, v73
    v_fma_f32 v224, v224, v15, v14
    v_mfma_f32_32x32x16_bf16 v[112:127], a[172:175], a[84:87], v[112:127]
    s_waitcnt lgkmcnt(8)
    ds_read_b64_tr_b16 a[168:169], v5 offset:20480
    ds_read_b64_tr_b16 a[170:171], v5 offset:20992
    v_mul_f32 v216, v40, v216
    v_mul_f32 v217, v41, v217
    v_fma_f32 v225, v225, v15, v14
    v_mul_f32 v224, v72, v224
    v_mfma_f32_32x32x16_bf16 v[112:127], a[144:147], a[88:91], v[112:127]
    s_add_u32 m0, s94, 75776
    ds_read_b64_tr_b16 a[172:173], v5 offset:22528
    ds_read_b64_tr_b16 a[174:175], v5 offset:23040
    buffer_load_dwordx4 v234, s[4:7], 0 offen offset:0 lds
    v_exp_f32 v216, v216
    v_exp_f32 v217, v217
    v_mul_f32 v225, v73, v225
    v_mfma_f32_32x32x16_bf16 v[112:127], a[148:151], a[92:95], v[112:127]
    s_waitcnt lgkmcnt(8)
    ds_read_b64_tr_b16 a[144:145], v5 offset:24576
    ds_read_b64_tr_b16 a[146:147], v5 offset:25088
    v_mul_f32 v218, v40, v104
    v_mul_f32 v219, v41, v105
    v_fma_f32 v216, v216, v254, v254
    v_exp_f32 v224, v224
    v_mfma_f32_32x32x16_bf16 v[112:127], a[152:155], a[96:99], v[112:127]
    s_add_u32 m0, s94, 76800
    ds_read_b64_tr_b16 a[148:149], v5 offset:26624
    ds_read_b64_tr_b16 a[150:151], v5 offset:27136
    buffer_load_dwordx4 v235, s[4:7], 0 offen offset:0 lds
    v_fma_f32 v217, v217, v254, v254
    v_rcp_f32 v216, v216
    v_exp_f32 v225, v225
    v_mfma_f32_32x32x16_bf16 v[112:127], a[156:159], a[100:103], v[112:127]
    s_waitcnt lgkmcnt(8)
    ds_read_b64_tr_b16 a[152:153], v5 offset:28672
    ds_read_b64_tr_b16 a[154:155], v5 offset:29184
    v_rcp_f32 v217, v217
    v_fma_f32 v224, v224, v254, v254
    v_fma_f32 v225, v225, v254, v254
    v_mfma_f32_32x32x16_bf16 v[112:127], a[160:163], a[104:107], v[112:127]
    s_add_u32 m0, s94, 77696
    ds_read_b64_tr_b16 a[156:157], v5 offset:30720
    ds_read_b64_tr_b16 a[158:159], v5 offset:31232
    buffer_load_dwordx4 v232, s[4:7], 0 offen offset:128 lds
    v_mul_f32 v218, v218, v216
    v_mul_f32 v219, v219, v217
    v_cvt_pk_bf16_f32 v188, v218, v219
    v_mul_f32 v220, v42, v42
    v_rcp_f32 v224, v224
    v_mfma_f32_32x32x16_bf16 v[112:127], a[164:167], a[108:111], v[112:127]
    s_waitcnt lgkmcnt(8)
    ds_read_b64_tr_b16 a[160:161], v5 offset:32768
    ds_read_b64_tr_b16 a[162:163], v5 offset:33280
    v_mul_f32 v221, v43, v43
    v_fma_f32 v220, v220, v15, v14
    v_rcp_f32 v225, v225
    v_mul_f32 v72, v72, v224
    v_mfma_f32_32x32x16_bf16 v[112:127], a[168:171], a[112:115], v[112:127]
    s_add_u32 m0, s94, 78720
    ds_read_b64_tr_b16 a[164:165], v5 offset:34816
    ds_read_b64_tr_b16 a[166:167], v5 offset:35328
    buffer_load_dwordx4 v233, s[4:7], 0 offen offset:128 lds
    v_fma_f32 v221, v221, v15, v14
    v_mul_f32 v220, v42, v220
    v_mul_f32 v221, v43, v221
    v_mul_f32 v73, v73, v225
    v_mul_f32 v226, v74, v74
    v_mfma_f32_32x32x16_bf16 v[112:127], a[172:175], a[116:119], v[112:127]
    s_waitcnt lgkmcnt(8)
    ds_read_b64_tr_b16 a[168:169], v9 offset:0
    ds_read_b64_tr_b16 a[170:171], v9 offset:512
    v_exp_f32 v220, v220
    v_mul_f32 v227, v75, v75
    v_fma_f32 v226, v226, v15, v14
    v_mfma_f32_32x32x16_bf16 v[112:127], a[144:147], a[120:123], v[112:127]
    s_add_u32 m0, s94, 79744
    ds_read_b64_tr_b16 a[172:173], v9 offset:2048
    ds_read_b64_tr_b16 a[174:175], v9 offset:2560
    buffer_load_dwordx4 v234, s[4:7], 0 offen offset:128 lds
    v_exp_f32 v221, v221
    v_mul_f32 v222, v42, v106
    v_mul_f32 v223, v43, v107
    v_fma_f32 v227, v227, v15, v14
    v_mul_f32 v226, v74, v226
    v_mfma_f32_32x32x16_bf16 v[112:127], a[148:151], a[124:127], v[112:127]
    s_waitcnt lgkmcnt(8)
    ds_read_b64_tr_b16 a[144:145], v9 offset:4096
    ds_read_b64_tr_b16 a[146:147], v9 offset:4608
    v_fma_f32 v220, v220, v254, v254
    v_fma_f32 v221, v221, v254, v254
    v_mul_f32 v227, v75, v227
    v_exp_f32 v226, v226
    v_mfma_f32_32x32x16_bf16 v[112:127], a[152:155], a[128:131], v[112:127]
    s_add_u32 m0, s94, 80768
    ds_read_b64_tr_b16 a[148:149], v9 offset:6144
    ds_read_b64_tr_b16 a[150:151], v9 offset:6656
    buffer_load_dwordx4 v235, s[4:7], 0 offen offset:128 lds
    v_rcp_f32 v220, v220
    v_rcp_f32 v221, v221
    v_exp_f32 v227, v227
    v_mfma_f32_32x32x16_bf16 v[112:127], a[156:159], a[132:135], v[112:127]
    s_waitcnt lgkmcnt(8)
    ds_read_b64_tr_b16 a[152:153], v9 offset:8192
    ds_read_b64_tr_b16 a[154:155], v9 offset:8704
    v_mul_f32 v222, v222, v220
    v_mul_f32 v223, v223, v221
    v_cvt_pk_bf16_f32 v189, v222, v223
    v_fma_f32 v226, v226, v254, v254
    v_mfma_f32_32x32x16_bf16 v[112:127], a[160:163], a[136:139], v[112:127]
    s_add_u32 m0, s95, 147456
    s_nop 0
    ds_read_b64_tr_b16 a[156:157], v9 offset:10240
    ds_read_b64_tr_b16 a[158:159], v9 offset:10752
    buffer_load_dwordx4 v228, s[4:7], 0 offen lds
    v_mul_f32 v216, v44, v44
    v_mul_f32 v217, v45, v45
    v_fma_f32 v216, v216, v15, v14
    v_fma_f32 v227, v227, v254, v254
    v_mfma_f32_32x32x16_bf16 v[112:127], a[164:167], a[140:143], v[112:127]
    s_waitcnt lgkmcnt(8)
    ds_read_b64_tr_b16 a[160:161], v9 offset:12288
    ds_read_b64_tr_b16 a[162:163], v9 offset:12800
    v_fma_f32 v217, v217, v15, v14
    v_mul_f32 v216, v44, v216
    v_mul_f32 v217, v45, v217
    v_rcp_f32 v226, v226
    v_mfma_f32_32x32x16_bf16 v[128:143], a[168:171], a[72:75], v[128:143]
    s_add_u32 m0, s95, 151552
    s_nop 0
    ds_read_b64_tr_b16 a[164:165], v9 offset:14336
    ds_read_b64_tr_b16 a[166:167], v9 offset:14848
    buffer_load_dwordx4 v228, s[8:11], 0 offen lds
    v_exp_f32 v216, v216
    v_rcp_f32 v227, v227
    v_mfma_f32_32x32x16_bf16 v[128:143], a[172:175], a[76:79], v[128:143]
    s_waitcnt lgkmcnt(8)
    ds_read_b64_tr_b16 a[168:169], v9 offset:16384
    ds_read_b64_tr_b16 a[170:171], v9 offset:16896
    v_exp_f32 v217, v217
    v_mul_f32 v218, v44, v108
    v_mul_f32 v74, v74, v226
    v_mul_f32 v75, v75, v227
    v_mfma_f32_32x32x16_bf16 v[128:143], a[144:147], a[80:83], v[128:143]
    ds_read_b64_tr_b16 a[172:173], v9 offset:18432
    ds_read_b64_tr_b16 a[174:175], v9 offset:18944
    v_mul_f32 v219, v45, v109
    v_fma_f32 v216, v216, v254, v254
    v_fma_f32 v217, v217, v254, v254
    v_mul_f32 v224, v76, v76
    v_mul_f32 v225, v77, v77
    v_mfma_f32_32x32x16_bf16 v[128:143], a[148:151], a[84:87], v[128:143]
    s_waitcnt lgkmcnt(8)
    ds_read_b64_tr_b16 a[144:145], v9 offset:20480
    ds_read_b64_tr_b16 a[146:147], v9 offset:20992
    v_rcp_f32 v216, v216
    v_fma_f32 v224, v224, v15, v14
    v_fma_f32 v225, v225, v15, v14
    v_mul_f32 v224, v76, v224
    v_mfma_f32_32x32x16_bf16 v[128:143], a[152:155], a[88:91], v[128:143]
    ds_read_b64_tr_b16 a[148:149], v9 offset:22528
    ds_read_b64_tr_b16 a[150:151], v9 offset:23040
    v_rcp_f32 v217, v217
    v_mul_f32 v218, v218, v216
    v_mul_f32 v219, v219, v217
    v_mul_f32 v225, v77, v225
    v_mfma_f32_32x32x16_bf16 v[128:143], a[156:159], a[92:95], v[128:143]
    s_waitcnt lgkmcnt(8)
    ds_read_b64_tr_b16 a[152:153], v9 offset:24576
    ds_read_b64_tr_b16 a[154:155], v9 offset:25088
    v_cvt_pk_bf16_f32 v190, v218, v219
    v_mul_f32 v220, v46, v46
    v_mul_f32 v221, v47, v47
    v_exp_f32 v224, v224
    v_mfma_f32_32x32x16_bf16 v[128:143], a[160:163], a[96:99], v[128:143]
    ds_read_b64_tr_b16 a[156:157], v9 offset:26624
    ds_read_b64_tr_b16 a[158:159], v9 offset:27136
    v_fma_f32 v220, v220, v15, v14
    v_fma_f32 v221, v221, v15, v14
    v_mul_f32 v220, v46, v220
    v_exp_f32 v225, v225
    v_fma_f32 v224, v224, v254, v254
    v_mfma_f32_32x32x16_bf16 v[128:143], a[164:167], a[100:103], v[128:143]
    s_waitcnt lgkmcnt(8)
    ds_read_b64_tr_b16 a[160:161], v9 offset:28672
    ds_read_b64_tr_b16 a[162:163], v9 offset:29184
    v_mul_f32 v221, v47, v221
    v_exp_f32 v220, v220
    v_fma_f32 v225, v225, v254, v254
    v_mfma_f32_32x32x16_bf16 v[128:143], a[168:171], a[104:107], v[128:143]
    ds_read_b64_tr_b16 a[164:165], v9 offset:30720
    ds_read_b64_tr_b16 a[166:167], v9 offset:31232
    v_exp_f32 v221, v221
    v_mul_f32 v222, v46, v110
    v_rcp_f32 v224, v224
    v_mfma_f32_32x32x16_bf16 v[128:143], a[172:175], a[108:111], v[128:143]
    s_waitcnt lgkmcnt(8)
    ds_read_b64_tr_b16 a[168:169], v9 offset:32768
    ds_read_b64_tr_b16 a[170:171], v9 offset:33280
    v_mul_f32 v223, v47, v111
    v_fma_f32 v220, v220, v254, v254
    v_fma_f32 v221, v221, v254, v254
    v_rcp_f32 v225, v225
    v_mfma_f32_32x32x16_bf16 v[128:143], a[144:147], a[112:115], v[128:143]
    ds_read_b64_tr_b16 a[172:173], v9 offset:34816
    ds_read_b64_tr_b16 a[174:175], v9 offset:35328
    v_rcp_f32 v220, v220
    v_rcp_f32 v221, v221
    v_mul_f32 v76, v76, v224
    v_mul_f32 v77, v77, v225
    v_mfma_f32_32x32x16_bf16 v[128:143], a[148:151], a[116:119], v[128:143]
    s_waitcnt vmcnt(21)
    s_barrier
    s_waitcnt lgkmcnt(8)
    ds_read_b64_tr_b16 a[144:145], v248 offset:0
    ds_read_b64_tr_b16 a[146:147], v248 offset:256
    v_mul_f32 v226, v78, v78
    v_mul_f32 v227, v79, v79
    v_mfma_f32_32x32x16_bf16 v[128:143], a[152:155], a[120:123], v[128:143]
    ds_read_b64_tr_b16 a[148:149], v248 offset:1024
    ds_read_b64_tr_b16 a[150:151], v248 offset:1280
    v_mul_f32 v222, v222, v220
    v_mul_f32 v223, v223, v221
    v_fma_f32 v226, v226, v15, v14
    v_fma_f32 v227, v227, v15, v14
    v_mul_f32 v226, v78, v226
    v_mfma_f32_32x32x16_bf16 v[128:143], a[156:159], a[124:127], v[128:143]
    s_waitcnt lgkmcnt(8)
    ds_read_b64_tr_b16 a[152:153], v248 offset:2048
    ds_read_b64_tr_b16 a[154:155], v248 offset:2304
    v_cvt_pk_bf16_f32 v191, v222, v223
    v_mul_f32 v227, v79, v227
    v_exp_f32 v226, v226
    v_mfma_f32_32x32x16_bf16 v[128:143], a[160:163], a[128:131], v[128:143]
    s_add_u32 s35, s32, 10240
    ds_read_b64_tr_b16 a[156:157], v248 offset:3072
    ds_read_b64_tr_b16 a[158:159], v248 offset:3328
    buffer_store_dwordx4 v[184:187], v1, s[56:59], s35 offen sc1
    v_exp_f32 v227, v227
    v_mfma_f32_32x32x16_bf16 v[128:143], a[164:167], a[132:135], v[128:143]
    s_waitcnt lgkmcnt(8)
    ds_read_b64_tr_b16 a[160:161], v248 offset:4096
    ds_read_b64_tr_b16 a[162:163], v248 offset:4352
    v_fma_f32 v226, v226, v254, v254
    v_fma_f32 v227, v227, v254, v254
    v_rcp_f32 v226, v226
    v_mfma_f32_32x32x16_bf16 v[128:143], a[168:171], a[136:139], v[128:143]
    ds_read_b64_tr_b16 a[164:165], v248 offset:5120
    ds_read_b64_tr_b16 a[166:167], v248 offset:5376
    buffer_store_dwordx4 v[188:191], v1, s[56:59], s35 offen offset:1024 sc1
    v_rcp_f32 v227, v227
    v_mfma_f32_32x32x16_bf16 v[128:143], a[172:175], a[140:143], v[128:143]
    s_waitcnt lgkmcnt(8)
    s_barrier
    ds_read_b64_tr_b16 a[168:169], v248 offset:6144
    ds_read_b64_tr_b16 a[170:171], v248 offset:6400
    v_mul_f32 v78, v78, v226
    v_mul_f32 v79, v79, v227
    v_readfirstlane_b32 s76, v230
    v_mfma_f32_32x32x16_bf16 v[16:31], a[144:147], a[0:3], 0
    s_add_u32 m0, s94, 110592
    ds_read_b64_tr_b16 a[172:173], v248 offset:7168
    ds_read_b64_tr_b16 a[174:175], v248 offset:7424
    buffer_load_dwordx4 v232, s[8:11], 0 offen offset:0 lds
    v_mfma_f32_32x32x16_bf16 v[16:31], a[148:151], a[4:7], v[16:31]
    s_waitcnt lgkmcnt(8)
    ds_read_b64_tr_b16 a[144:145], v248 offset:8192
    ds_read_b64_tr_b16 a[146:147], v248 offset:8448
    v_mul_f32 v216, v48, v48
    v_mul_f32 v217, v49, v49
    v_fma_f32 v216, v216, v15, v14
    v_fma_f32 v217, v217, v15, v14
    s_cmp_ge_u32 s76, 256
    s_cbranch_scc1 L_zp_ok
    s_mov_b32 s93, 0
L_zp:
    buffer_load_dword v252, off, s[12:15], 0 offset:128 sc1
    s_waitcnt vmcnt(0)
    v_readfirstlane_b32 s76, v252
    s_nop 3
    s_cmp_ge_u32 s76, 256
    s_cbranch_scc1 L_zp_ok
    s_add_u32 s93, s93, 1
    s_cmp_gt_u32 s93, 0x40000
    s_cbranch_scc1 L_zp_ok
    s_sleep 1
    s_branch L_zp
L_zp_ok:
    v_mfma_f32_32x32x16_bf16 v[16:31], a[152:155], a[8:11], v[16:31]
    s_add_u32 m0, s94, 111616
    ds_read_b64_tr_b16 a[148:149], v248 offset:9216
    ds_read_b64_tr_b16 a[150:151], v248 offset:9472
    buffer_load_dwordx4 v233, s[8:11], 0 offen offset:0 lds
    v_mul_f32 v216, v48, v216
    v_mul_f32 v217, v49, v217
    v_exp_f32 v216, v216
    v_mfma_f32_32x32x16_bf16 v[16:31], a[156:159], a[12:15], v[16:31]
    s_waitcnt lgkmcnt(8)
    s_add_u32 s96, s39, 0
    ds_read_b64_tr_b16 a[152:153], v248 offset:10240
    ds_read_b64_tr_b16 a[154:155], v248 offset:10496
    v_exp_f32 v217, v217
    v_mul_f32 v218, v48, v112
    v_mul_f32 v219, v49, v113
    v_mfma_f32_32x32x16_bf16 v[16:31], a[160:163], a[16:19], v[16:31]
    s_add_u32 m0, s94, 112640
    ds_read_b64_tr_b16 a[156:157], v248 offset:11264
    ds_read_b64_tr_b16 a[158:159], v248 offset:11520
    buffer_load_dwordx4 v234, s[8:11], 0 offen offset:0 lds
    v_fma_f32 v216, v216, v254, v254
    v_fma_f32 v217, v217, v254, v254
    v_rcp_f32 v216, v216
    v_mfma_f32_32x32x16_bf16 v[16:31], a[164:167], a[20:23], v[16:31]
    s_waitcnt lgkmcnt(8)
    ds_read_b64_tr_b16 a[160:161], v248 offset:12288
    ds_read_b64_tr_b16 a[162:163], v248 offset:12544
    buffer_load_dwordx4 a[176:179], v241, s[56:59], s96 offen sc1
    v_rcp_f32 v217, v217
    v_mul_f32 v218, v218, v216
    v_mul_f32 v219, v219, v217
    v_mfma_f32_32x32x16_bf16 v[16:31], a[168:171], a[24:27], v[16:31]
    s_add_u32 m0, s94, 113664
    ds_read_b64_tr_b16 a[164:165], v248 offset:13312
    ds_read_b64_tr_b16 a[166:167], v248 offset:13568
    buffer_load_dwordx4 v235, s[8:11], 0 offen offset:0 lds
    v_cvt_pk_bf16_f32 v192, v218, v219
    v_mul_f32 v220, v50, v50
    v_mul_f32 v221, v51, v51
    v_fma_f32 v220, v220, v15, v14
    v_mfma_f32_32x32x16_bf16 v[16:31], a[172:175], a[28:31], v[16:31]
    s_waitcnt lgkmcnt(8)
    ds_read_b64_tr_b16 a[168:169], v248 offset:14336
    ds_read_b64_tr_b16 a[170:171], v248 offset:14592
    buffer_load_dwordx4 a[180:183], v242, s[56:59], s96 offen sc1
    v_fma_f32 v221, v221, v15, v14
    v_mul_f32 v220, v50, v220
    v_mul_f32 v221, v51, v221
    v_mfma_f32_32x32x16_bf16 v[16:31], a[144:147], a[32:35], v[16:31]
    s_add_u32 m0, s94, 114560
    ds_read_b64_tr_b16 a[172:173], v248 offset:15360
    ds_read_b64_tr_b16 a[174:175], v248 offset:15616
    buffer_load_dwordx4 v232, s[8:11], 0 offen offset:128 lds
    buffer_load_dwordx4 a[184:187], v243, s[56:59], s96 offen sc1
    v_exp_f32 v220, v220
    v_exp_f32 v221, v221
    v_mfma_f32_32x32x16_bf16 v[16:31], a[148:151], a[36:39], v[16:31]
    s_waitcnt lgkmcnt(8)
    ds_read_b64_tr_b16 a[144:145], v248 offset:16384
    ds_read_b64_tr_b16 a[146:147], v248 offset:16640
    v_mul_f32 v222, v50, v114
    v_mul_f32 v223, v51, v115
    v_fma_f32 v220, v220, v254, v254
    v_fma_f32 v221, v221, v254, v254
    v_mfma_f32_32x32x16_bf16 v[16:31], a[152:155], a[40:43], v[16:31]
    s_add_u32 m0, s94, 115584
    s_add_u32 s96, s39, 2048
    ds_read_b64_tr_b16 a[148:149], v248 offset:17408
    ds_read_b64_tr_b16 a[150:151], v248 offset:17664
    buffer_load_dwordx4 v233, s[8:11], 0 offen offset:128 lds
    v_rcp_f32 v220, v220
    v_rcp_f32 v221, v221
    v_mfma_f32_32x32x16_bf16 v[16:31], a[156:159], a[44:47], v[16:31]
    s_waitcnt lgkmcnt(8)
    ds_read_b64_tr_b16 a[152:153], v248 offset:18432
    ds_read_b64_tr_b16 a[154:155], v248 offset:18688
    v_mul_f32 v222, v222, v220
    v_mul_f32 v223, v223, v221
    v_cvt_pk_bf16_f32 v193, v222, v223
    v_mul_f32 v216, v52, v52
    v_mul_f32 v217, v53, v53
    v_mfma_f32_32x32x16_bf16 v[16:31], a[160:163], a[48:51], v[16:31]
    s_add_u32 m0, s94, 116608
    ds_read_b64_tr_b16 a[156:157], v248 offset:19456
    ds_read_b64_tr_b16 a[158:159], v248 offset:19712
    buffer_load_dwordx4 v234, s[8:11], 0 offen offset:128 lds
    buffer_load_dwordx4 a[188:191], v241, s[56:59], s96 offen sc1
    v_fma_f32 v216, v216, v15, v14
    v_fma_f32 v217, v217, v15, v14
    v_mul_f32 v216, v52, v216
    v_mfma_f32_32x32x16_bf16 v[16:31], a[164:167], a[52:55], v[16:31]
    s_waitcnt lgkmcnt(8)
    ds_read_b64_tr_b16 a[160:161], v248 offset:20480
    ds_read_b64_tr_b16 a[162:163], v248 offset:20736
    buffer_load_dwordx4 a[192:195], v242, s[56:59], s96 offen sc1
    v_mul_f32 v217, v53, v217
    v_exp_f32 v216, v216
    v_exp_f32 v217, v217
    v_mfma_f32_32x32x16_bf16 v[16:31], a[168:171], a[56:59], v[16:31]
    s_lshl_b32 s1, s33, 7
    s_add_u32 s1, s1, 48234496
    s_add_u32 m0, s94, 117632
    ds_read_b64_tr_b16 a[164:165], v248 offset:21504
    ds_read_b64_tr_b16 a[166:167], v248 offset:21760
    buffer_load_dwordx4 v235, s[8:11], 0 offen offset:128 lds
    v_mul_f32 v218, v52, v116
    v_mfma_f32_32x32x16_bf16 v[16:31], a[172:175], a[60:63], v[16:31]
    s_waitcnt lgkmcnt(8)
    ds_read_b64_tr_b16 a[168:169], v248 offset:22528
    ds_read_b64_tr_b16 a[170:171], v248 offset:22784
    buffer_load_dwordx4 a[196:199], v243, s[56:59], s96 offen sc1
    v_mul_f32 v219, v53, v117
    v_fma_f32 v216, v216, v254, v254
    v_fma_f32 v217, v217, v254, v254
    v_rcp_f32 v216, v216
    v_mfma_f32_32x32x16_bf16 v[16:31], a[144:147], a[64:67], v[16:31]
    ds_read_b64_tr_b16 a[172:173], v248 offset:23552
    ds_read_b64_tr_b16 a[174:175], v248 offset:23808
    v_mov_b32 v231, 1
    v_rcp_f32 v217, v217
    v_mul_f32 v218, v218, v216
    v_mul_f32 v219, v219, v217
    v_mfma_f32_32x32x16_bf16 v[16:31], a[148:151], a[68:71], v[16:31]
    s_waitcnt lgkmcnt(8)
    s_add_u32 s96, s39, 4096
    ds_read_b64_tr_b16 a[144:145], v248 offset:24576
    ds_read_b64_tr_b16 a[146:147], v248 offset:24832
    v_cvt_pk_bf16_f32 v194, v218, v219
    v_mul_f32 v220, v54, v54
    v_mul_f32 v221, v55, v55
    v_fma_f32 v220, v220, v15, v14
    v_mfma_f32_32x32x16_bf16 v[16:31], a[152:155], a[72:75], v[16:31]
    ds_read_b64_tr_b16 a[148:149], v248 offset:25600
    ds_read_b64_tr_b16 a[150:151], v248 offset:25856
    buffer_load_dwordx4 a[200:203], v241, s[56:59], s96 offen sc1
    v_fma_f32 v221, v221, v15, v14
    v_mul_f32 v220, v54, v220
    v_mul_f32 v221, v55, v221
    v_exp_f32 v220, v220
    v_mfma_f32_32x32x16_bf16 v[16:31], a[156:159], a[76:79], v[16:31]
    s_waitcnt lgkmcnt(8)
    ds_read_b64_tr_b16 a[152:153], v248 offset:26624
    ds_read_b64_tr_b16 a[154:155], v248 offset:26880
    v_exp_f32 v221, v221
    v_mul_f32 v222, v54, v118
    v_mul_f32 v223, v55, v119
    v_fma_f32 v220, v220, v254, v254
    v_mfma_f32_32x32x16_bf16 v[16:31], a[160:163], a[80:83], v[16:31]
    ds_read_b64_tr_b16 a[156:157], v248 offset:27648
    ds_read_b64_tr_b16 a[158:159], v248 offset:27904
    buffer_load_dwordx4 a[204:207], v242, s[56:59], s96 offen sc1
    v_fma_f32 v221, v221, v254, v254
    v_rcp_f32 v220, v220
    v_rcp_f32 v221, v221
    v_mfma_f32_32x32x16_bf16 v[16:31], a[164:167], a[84:87], v[16:31]
    s_waitcnt lgkmcnt(8)
    ds_read_b64_tr_b16 a[160:161], v248 offset:28672
    ds_read_b64_tr_b16 a[162:163], v248 offset:28928
    v_mul_f32 v222, v222, v220
    v_mul_f32 v223, v223, v221
    v_cvt_pk_bf16_f32 v195, v222, v223
    v_mul_f32 v216, v56, v56
    v_mul_f32 v217, v57, v57
    v_mfma_f32_32x32x16_bf16 v[16:31], a[168:171], a[88:91], v[16:31]
    ds_read_b64_tr_b16 a[164:165], v248 offset:29696
    ds_read_b64_tr_b16 a[166:167], v248 offset:29952
    buffer_load_dwordx4 a[208:211], v243, s[56:59], s96 offen sc1
    v_fma_f32 v216, v216, v15, v14
    v_fma_f32 v217, v217, v15, v14
    v_mul_f32 v216, v56, v216
    v_mul_f32 v217, v57, v217
    v_mfma_f32_32x32x16_bf16 v[16:31], a[172:175], a[92:95], v[16:31]
    s_waitcnt lgkmcnt(8)
    s_add_u32 s96, s39, 6144
    ds_read_b64_tr_b16 a[168:169], v248 offset:30720
    ds_read_b64_tr_b16 a[170:171], v248 offset:30976
    v_exp_f32 v216, v216
    v_exp_f32 v217, v217
    v_mul_f32 v218, v56, v120
    v_mfma_f32_32x32x16_bf16 v[16:31], a[144:147], a[96:99], v[16:31]
    ds_read_b64_tr_b16 a[172:173], v248 offset:31744
    ds_read_b64_tr_b16 a[174:175], v248 offset:32000
    v_mul_f32 v219, v57, v121
    v_fma_f32 v216, v216, v254, v254
    v_fma_f32 v217, v217, v254, v254
    v_rcp_f32 v216, v216
    v_mfma_f32_32x32x16_bf16 v[16:31], a[148:151], a[100:103], v[16:31]
    s_waitcnt lgkmcnt(8)
    ds_read_b64_tr_b16 a[144:145], v248 offset:32768
    ds_read_b64_tr_b16 a[146:147], v248 offset:33024
    buffer_load_dwordx4 a[212:215], v241, s[56:59], s96 offen sc1
    v_rcp_f32 v217, v217
    v_mul_f32 v218, v218, v216
    v_mul_f32 v219, v219, v217
    v_cvt_pk_bf16_f32 v196, v218, v219
    v_mfma_f32_32x32x16_bf16 v[16:31], a[152:155], a[104:107], v[16:31]
    ds_read_b64_tr_b16 a[148:149], v248 offset:33792
    ds_read_b64_tr_b16 a[150:151], v248 offset:34048
    v_mul_f32 v220, v58, v58
    v_mul_f32 v221, v59, v59
    v_fma_f32 v220, v220, v15, v14
    v_fma_f32 v221, v221, v15, v14
    v_mul_f32 v220, v58, v220
    v_mfma_f32_32x32x16_bf16 v[16:31], a[156:159], a[108:111], v[16:31]
    s_waitcnt lgkmcnt(8)
    ds_read_b64_tr_b16 a[152:153], v248 offset:34816
    ds_read_b64_tr_b16 a[154:155], v248 offset:35072
    buffer_load_dwordx4 a[216:219], v242, s[56:59], s96 offen sc1
    v_mul_f32 v221, v59, v221
    v_exp_f32 v220, v220
    v_exp_f32 v221, v221
    v_mfma_f32_32x32x16_bf16 v[16:31], a[160:163], a[112:115], v[16:31]
    ds_read_b64_tr_b16 a[156:157], v248 offset:35840
    ds_read_b64_tr_b16 a[158:159], v248 offset:36096
    buffer_load_dwordx4 a[220:223], v243, s[56:59], s96 offen sc1
    v_mul_f32 v222, v58, v122
    v_mul_f32 v223, v59, v123
    v_fma_f32 v220, v220, v254, v254
    v_fma_f32 v221, v221, v254, v254
    v_mfma_f32_32x32x16_bf16 v[16:31], a[164:167], a[116:119], v[16:31]
    s_waitcnt vmcnt(32)
    s_barrier
    s_waitcnt lgkmcnt(8)
    ds_read_b64_tr_b16 a[160:161], v249 offset:0
    ds_read_b64_tr_b16 a[162:163], v249 offset:256
    v_rcp_f32 v220, v220
    v_mfma_f32_32x32x16_bf16 v[16:31], a[168:171], a[120:123], v[16:31]
    ds_read_b64_tr_b16 a[164:165], v249 offset:1024
    ds_read_b64_tr_b16 a[166:167], v249 offset:1280
    v_rcp_f32 v221, v221
    v_mul_f32 v222, v222, v220
    v_mul_f32 v223, v223, v221
    v_cvt_pk_bf16_f32 v197, v222, v223
    v_mul_f32 v216, v60, v60
    v_mfma_f32_32x32x16_bf16 v[16:31], a[172:175], a[124:127], v[16:31]
    s_waitcnt lgkmcnt(8)
    ds_read_b64_tr_b16 a[168:169], v249 offset:2048
    ds_read_b64_tr_b16 a[170:171], v249 offset:2304
    v_mul_f32 v217, v61, v61
    v_fma_f32 v216, v216, v15, v14
    v_fma_f32 v217, v217, v15, v14
    v_mul_f32 v216, v60, v216
    v_mfma_f32_32x32x16_bf16 v[16:31], a[144:147], a[128:131], v[16:31]
    ds_read_b64_tr_b16 a[172:173], v249 offset:3072
    ds_read_b64_tr_b16 a[174:175], v249 offset:3328
    v_mul_f32 v217, v61, v217
    v_exp_f32 v216, v216
    v_exp_f32 v217, v217
    v_mfma_f32_32x32x16_bf16 v[16:31], a[148:151], a[132:135], v[16:31]
    s_waitcnt lgkmcnt(8)
    ds_read_b64_tr_b16 a[144:145], v249 offset:4096
    ds_read_b64_tr_b16 a[146:147], v249 offset:4352
    v_mul_f32 v218, v60, v124
    v_mul_f32 v219, v61, v125
    v_fma_f32 v216, v216, v254, v254
    v_fma_f32 v217, v217, v254, v254
    v_mfma_f32_32x32x16_bf16 v[16:31], a[152:155], a[136:139], v[16:31]
    ds_read_b64_tr_b16 a[148:149], v249 offset:5120
    ds_read_b64_tr_b16 a[150:151], v249 offset:5376
    v_rcp_f32 v216, v216
    v_rcp_f32 v217, v217
    v_mul_f32 v218, v218, v216
    v_mul_f32 v219, v219, v217
    v_mfma_f32_32x32x16_bf16 v[16:31], a[156:159], a[140:143], v[16:31]
    s_waitcnt lgkmcnt(8)
    s_barrier
    ds_read_b64_tr_b16 a[152:153], v249 offset:6144
    ds_read_b64_tr_b16 a[154:155], v249 offset:6400
    v_cvt_pk_bf16_f32 v198, v218, v219
    v_mul_f32 v220, v62, v62
    v_mul_f32 v221, v63, v63
    v_fma_f32 v220, v220, v15, v14
    v_mfma_f32_32x32x16_bf16 v[80:95], a[160:163], a[0:3], 0
    ds_read_b64_tr_b16 a[156:157], v249 offset:7168
    ds_read_b64_tr_b16 a[158:159], v249 offset:7424
    v_fma_f32 v221, v221, v15, v14
    v_mul_f32 v220, v62, v220
    v_mul_f32 v221, v63, v221
    v_exp_f32 v220, v220
    v_lshrrev_b32 v12, 3, v0
    v_and_b32 v13, 7, v0
    v_bfe_u32 v252, v0, 4, 1
    v_mfma_f32_32x32x16_bf16 v[80:95], a[164:167], a[4:7], v[80:95]
    s_waitcnt lgkmcnt(8)
    ds_read_b64_tr_b16 a[160:161], v249 offset:8192
    ds_read_b64_tr_b16 a[162:163], v249 offset:8448
    v_exp_f32 v221, v221
    v_mul_f32 v222, v62, v126
    v_mul_f32 v223, v63, v127
    v_fma_f32 v220, v220, v254, v254
    v_lshlrev_b32 v252, 2, v252
    v_xor_b32 v13, v13, v252
    v_lshlrev_b32 v13, 4, v13
    v_mfma_f32_32x32x16_bf16 v[80:95], a[168:171], a[8:11], v[80:95]
    s_mul_i32 s74, s64, 9216
    ds_read_b64_tr_b16 a[164:165], v249 offset:9216
    ds_read_b64_tr_b16 a[166:167], v249 offset:9472
    v_fma_f32 v221, v221, v254, v254
    v_rcp_f32 v220, v220
    v_rcp_f32 v221, v221
    v_mfma_f32_32x32x16_bf16 v[80:95], a[172:175], a[12:15], v[80:95]
    s_waitcnt lgkmcnt(8)
    ds_read_b64_tr_b16 a[168:169], v249 offset:10240
    ds_read_b64_tr_b16 a[170:171], v249 offset:10496
    v_mul_f32 v222, v222, v220
    v_mul_f32 v223, v223, v221
    v_cvt_pk_bf16_f32 v199, v222, v223
    v_mul_u32_u24 v12, 1152, v12
    v_add_u32 v10, v12, v13
    v_add_u32 v10, s74, v10
    v_mfma_f32_32x32x16_bf16 v[80:95], a[144:147], a[16:19], v[80:95]
    s_add_u32 s34, s32, 12288
    s_lshl_b32 s74, s64, 10
    ds_read_b64_tr_b16 a[172:173], v249 offset:11264
    ds_read_b64_tr_b16 a[174:175], v249 offset:11520
    buffer_store_dwordx4 v[192:195], v1, s[56:59], s34 offen sc1
    v_mul_f32 v224, v16, v16
    v_mul_f32 v225, v17, v17
    v_mfma_f32_32x32x16_bf16 v[80:95], a[148:151], a[20:23], v[80:95]
    s_waitcnt lgkmcnt(8)
    s_add_u32 m0, s74, 0
    s_add_u32 s3, s84, s25
    ds_read_b64_tr_b16 a[144:145], v249 offset:12288
    ds_read_b64_tr_b16 a[146:147], v249 offset:12544
    buffer_store_dwordx4 v[196:199], v1, s[56:59], s34 offen offset:1024 sc1
    buffer_load_dwordx4 v10, s[52:55], s3 offen lds
    v_fma_f32 v224, v224, v15, v14
    v_fma_f32 v225, v225, v15, v14
    v_mfma_f32_32x32x16_bf16 v[80:95], a[152:155], a[24:27], v[80:95]
    s_add_u32 m0, s74, 4096
    s_add_u32 s3, s85, s25
    ds_read_b64_tr_b16 a[148:149], v249 offset:13312
    ds_read_b64_tr_b16 a[150:151], v249 offset:13568
    buffer_load_dwordx4 v10, s[52:55], s3 offen lds
    v_mul_f32 v64, v64, v128
    v_mul_f32 v65, v65, v129
    v_cvt_pk_bf16_f32 v200, v64, v65
    v_mul_f32 v66, v66, v130
    v_mul_f32 v67, v67, v131
    v_mul_f32 v224, v16, v224
    v_mfma_f32_32x32x16_bf16 v[80:95], a[156:159], a[28:31], v[80:95]
    s_waitcnt lgkmcnt(8)
    s_add_u32 m0, s74, 8192
    s_add_u32 s3, s86, s25
    ds_read_b64_tr_b16 a[152:153], v249 offset:14336
    ds_read_b64_tr_b16 a[154:155], v249 offset:14592
    buffer_load_dwordx4 v10, s[52:55], s3 offen lds
    v_cvt_pk_bf16_f32 v201, v66, v67
    v_mul_f32 v68, v68, v132
    v_mul_f32 v69, v69, v133
    v_cvt_pk_bf16_f32 v202, v68, v69
    v_mul_f32 v225, v17, v225
    v_mfma_f32_32x32x16_bf16 v[80:95], a[160:163], a[32:35], v[80:95]
    s_add_u32 m0, s74, 12288
    s_add_u32 s3, s87, s25
    ds_read_b64_tr_b16 a[156:157], v249 offset:15360
    ds_read_b64_tr_b16 a[158:159], v249 offset:15616
    buffer_load_dwordx4 v10, s[52:55], s3 offen lds
    v_mul_f32 v70, v70, v134
    v_mul_f32 v71, v71, v135
    v_cvt_pk_bf16_f32 v203, v70, v71
    v_mul_f32 v72, v72, v136
    v_mul_f32 v73, v73, v137
    v_exp_f32 v224, v224
    v_mfma_f32_32x32x16_bf16 v[80:95], a[164:167], a[36:39], v[80:95]
    s_waitcnt lgkmcnt(8)
    s_add_u32 m0, s74, 16384
    s_add_u32 s3, s88, s25
    ds_read_b64_tr_b16 a[160:161], v249 offset:16384
    ds_read_b64_tr_b16 a[162:163], v249 offset:16640
    buffer_load_dwordx4 v10, s[52:55], s3 offen lds
    v_cvt_pk_bf16_f32 v204, v72, v73
    v_mul_f32 v74, v74, v138
    v_mul_f32 v75, v75, v139
    v_cvt_pk_bf16_f32 v205, v74, v75
    v_exp_f32 v225, v225
    v_mfma_f32_32x32x16_bf16 v[80:95], a[168:171], a[40:43], v[80:95]
    s_add_u32 m0, s74, 20480
    s_add_u32 s3, s89, s25
    ds_read_b64_tr_b16 a[164:165], v249 offset:17408
    ds_read_b64_tr_b16 a[166:167], v249 offset:17664
    buffer_load_dwordx4 v10, s[52:55], s3 offen lds
    v_mul_f32 v76, v76, v140
    v_mul_f32 v77, v77, v141
    v_cvt_pk_bf16_f32 v206, v76, v77
    v_mul_f32 v78, v78, v142
    v_fma_f32 v224, v224, v254, v254
    v_fma_f32 v225, v225, v254, v254
    v_mfma_f32_32x32x16_bf16 v[80:95], a[172:175], a[44:47], v[80:95]
    s_waitcnt lgkmcnt(8)
    s_add_u32 m0, s74, 24576
    s_add_u32 s3, s90, s25
    ds_read_b64_tr_b16 a[168:169], v249 offset:18432
    ds_read_b64_tr_b16 a[170:171], v249 offset:18688
    buffer_load_dwordx4 v10, s[52:55], s3 offen lds
    v_mul_f32 v79, v79, v143
    v_cvt_pk_bf16_f32 v207, v78, v79
    v_rcp_f32 v224, v224
    v_mfma_f32_32x32x16_bf16 v[80:95], a[144:147], a[48:51], v[80:95]
    s_add_u32 s35, s32, 14336
    s_add_u32 m0, s74, 28672
    s_add_u32 s3, s91, s25
    ds_read_b64_tr_b16 a[172:173], v249 offset:19456
    ds_read_b64_tr_b16 a[174:175], v249 offset:19712
    buffer_store_dwordx4 v[200:203], v1, s[56:59], s35 offen sc1
    buffer_load_dwordx4 v10, s[52:55], s3 offen lds
    v_rcp_f32 v225, v225
    v_mfma_f32_32x32x16_bf16 v[80:95], a[148:151], a[52:55], v[80:95]
    s_waitcnt lgkmcnt(8)
    s_add_u32 m0, s74, 32768
    s_add_u32 s3, s92, s25
    ds_read_b64_tr_b16 a[144:145], v249 offset:20480
    ds_read_b64_tr_b16 a[146:147], v249 offset:20736
    buffer_store_dwordx4 v[204:207], v1, s[56:59], s35 offen offset:1024 sc1
    buffer_load_dwordx4 v10, s[52:55], s3 offen lds
    v_mul_f32 v16, v16, v224
    v_mul_f32 v17, v17, v225
    v_mfma_f32_32x32x16_bf16 v[80:95], a[152:155], a[56:59], v[80:95]
    ds_read_b64_tr_b16 a[148:149], v249 offset:21504
    ds_read_b64_tr_b16 a[150:151], v249 offset:21760
    v_mul_f32 v226, v18, v18
    v_mul_f32 v227, v19, v19
    v_fma_f32 v226, v226, v15, v14
    v_fma_f32 v227, v227, v15, v14
    v_mul_f32 v226, v18, v226
    v_mul_f32 v227, v19, v227
    v_mfma_f32_32x32x16_bf16 v[80:95], a[156:159], a[60:63], v[80:95]
    s_waitcnt lgkmcnt(8)
    ds_read_b64_tr_b16 a[152:153], v249 offset:22528
    ds_read_b64_tr_b16 a[154:155], v249 offset:22784
    v_exp_f32 v226, v226
    v_exp_f32 v227, v227
    v_fma_f32 v226, v226, v254, v254
    v_mfma_f32_32x32x16_bf16 v[80:95], a[160:163], a[64:67], v[80:95]
    ds_read_b64_tr_b16 a[156:157], v249 offset:23552
    ds_read_b64_tr_b16 a[158:159], v249 offset:23808
    v_fma_f32 v227, v227, v254, v254
    v_rcp_f32 v226, v226
    v_rcp_f32 v227, v227
    v_mfma_f32_32x32x16_bf16 v[80:95], a[164:167], a[68:71], v[80:95]
    s_waitcnt lgkmcnt(8)
    ds_read_b64_tr_b16 a[160:161], v249 offset:24576
    ds_read_b64_tr_b16 a[162:163], v249 offset:24832
    v_mul_f32 v18, v18, v226
    v_mul_f32 v19, v19, v227
    v_mul_f32 v224, v20, v20
    v_mul_f32 v225, v21, v21
    v_mfma_f32_32x32x16_bf16 v[80:95], a[168:171], a[72:75], v[80:95]
    ds_read_b64_tr_b16 a[164:165], v249 offset:25600
    ds_read_b64_tr_b16 a[166:167], v249 offset:25856
    v_fma_f32 v224, v224, v15, v14
    v_fma_f32 v225, v225, v15, v14
    v_mul_f32 v224, v20, v224
    v_mul_f32 v225, v21, v225
    v_exp_f32 v224, v224
    v_mfma_f32_32x32x16_bf16 v[80:95], a[172:175], a[76:79], v[80:95]
    s_waitcnt lgkmcnt(8)
    ds_read_b64_tr_b16 a[168:169], v249 offset:26624
    ds_read_b64_tr_b16 a[170:171], v249 offset:26880
    v_exp_f32 v225, v225
    v_fma_f32 v224, v224, v254, v254
    v_fma_f32 v225, v225, v254, v254
    v_mfma_f32_32x32x16_bf16 v[80:95], a[144:147], a[80:83], v[80:95]
    ds_read_b64_tr_b16 a[172:173], v249 offset:27648
    ds_read_b64_tr_b16 a[174:175], v249 offset:27904
    v_rcp_f32 v224, v224
    v_rcp_f32 v225, v225
    v_mul_f32 v20, v20, v224
    v_mul_f32 v21, v21, v225
    v_mfma_f32_32x32x16_bf16 v[80:95], a[148:151], a[84:87], v[80:95]
    s_waitcnt lgkmcnt(8)
    ds_read_b64_tr_b16 a[144:145], v249 offset:28672
    ds_read_b64_tr_b16 a[146:147], v249 offset:28928
    v_mul_f32 v226, v22, v22
    v_mul_f32 v227, v23, v23
    v_fma_f32 v226, v226, v15, v14
    v_fma_f32 v227, v227, v15, v14
    v_mfma_f32_32x32x16_bf16 v[80:95], a[152:155], a[88:91], v[80:95]
    ds_read_b64_tr_b16 a[148:149], v249 offset:29696
    ds_read_b64_tr_b16 a[150:151], v249 offset:29952
    v_mul_f32 v226, v22, v226
    v_mul_f32 v227, v23, v227
    v_exp_f32 v226, v226
    v_exp_f32 v227, v227
    v_mfma_f32_32x32x16_bf16 v[80:95], a[156:159], a[92:95], v[80:95]
    s_waitcnt lgkmcnt(8)
    ds_read_b64_tr_b16 a[152:153], v249 offset:30720
    ds_read_b64_tr_b16 a[154:155], v249 offset:30976
    v_fma_f32 v226, v226, v254, v254
    v_fma_f32 v227, v227, v254, v254
    v_rcp_f32 v226, v226
    v_mfma_f32_32x32x16_bf16 v[80:95], a[160:163], a[96:99], v[80:95]
    ds_read_b64_tr_b16 a[156:157], v249 offset:31744
    ds_read_b64_tr_b16 a[158:159], v249 offset:32000
    v_rcp_f32 v227, v227
    v_mul_f32 v22, v22, v226
    v_mul_f32 v23, v23, v227
    v_mul_f32 v224, v24, v24
    v_mfma_f32_32x32x16_bf16 v[80:95], a[164:167], a[100:103], v[80:95]
    s_waitcnt lgkmcnt(8)
    ds_read_b64_tr_b16 a[160:161], v249 offset:32768
    ds_read_b64_tr_b16 a[162:163], v249 offset:33024
    v_mul_f32 v225, v25, v25
    v_fma_f32 v224, v224, v15, v14
    v_fma_f32 v225, v225, v15, v14
    v_mul_f32 v224, v24, v224
    v_mul_f32 v225, v25, v225
    v_mfma_f32_32x32x16_bf16 v[80:95], a[168:171], a[104:107], v[80:95]
    ds_read_b64_tr_b16 a[164:165], v249 offset:33792
    ds_read_b64_tr_b16 a[166:167], v249 offset:34048
    v_exp_f32 v224, v224
    v_exp_f32 v225, v225
    v_fma_f32 v224, v224, v254, v254
    v_mfma_f32_32x32x16_bf16 v[80:95], a[172:175], a[108:111], v[80:95]
    s_waitcnt lgkmcnt(8)
    ds_read_b64_tr_b16 a[168:169], v249 offset:34816
    ds_read_b64_tr_b16 a[170:171], v249 offset:35072
    v_fma_f32 v225, v225, v254, v254
    v_rcp_f32 v224, v224
    v_rcp_f32 v225, v225
    v_mfma_f32_32x32x16_bf16 v[80:95], a[144:147], a[112:115], v[80:95]
    s_waitcnt vmcnt(37)
    ds_read_b64_tr_b16 a[172:173], v249 offset:35840
    ds_read_b64_tr_b16 a[174:175], v249 offset:36096
    ds_read_b128 a[144:147], v236 offset:0
    v_mul_f32 v24, v24, v224
    v_mul_f32 v25, v25, v225
    v_mul_f32 v226, v26, v26
    v_mfma_f32_32x32x16_bf16 v[80:95], a[148:151], a[116:119], v[80:95]
    s_waitcnt lgkmcnt(9)
    v_mul_f32 v227, v27, v27
    v_fma_f32 v226, v226, v15, v14
    v_fma_f32 v227, v227, v15, v14
    v_mul_f32 v226, v26, v226
    v_mul_f32 v227, v27, v227
    v_exp_f32 v226, v226
    v_mfma_f32_32x32x16_bf16 v[80:95], a[152:155], a[120:123], v[80:95]
    v_exp_f32 v227, v227
    v_fma_f32 v226, v226, v254, v254
    v_fma_f32 v227, v227, v254, v254
    v_rcp_f32 v226, v226
    v_mfma_f32_32x32x16_bf16 v[80:95], a[156:159], a[124:127], v[80:95]
    s_waitcnt lgkmcnt(5)
    ds_read_b128 a[148:151], v236 offset:2048
    v_rcp_f32 v227, v227
    v_mul_f32 v26, v26, v226
    v_mul_f32 v27, v27, v227
    v_mul_f32 v224, v28, v28
    v_mul_f32 v225, v29, v29
    v_mfma_f32_32x32x16_bf16 v[80:95], a[160:163], a[128:131], v[80:95]
    v_fma_f32 v224, v224, v15, v14
    v_fma_f32 v225, v225, v15, v14
    v_mul_f32 v224, v28, v224
    v_mul_f32 v225, v29, v225
    v_exp_f32 v224, v224
    v_exp_f32 v225, v225
    v_mfma_f32_32x32x16_bf16 v[80:95], a[164:167], a[132:135], v[80:95]
    s_waitcnt lgkmcnt(2)
    v_fma_f32 v224, v224, v254, v254
    v_fma_f32 v225, v225, v254, v254
    v_rcp_f32 v224, v224
    v_rcp_f32 v225, v225
    v_mfma_f32_32x32x16_bf16 v[80:95], a[168:171], a[136:139], v[80:95]
    ds_read_b128 a[152:155], v237 offset:0
    v_mul_f32 v28, v28, v224
    v_mul_f32 v29, v29, v225
    v_mul_f32 v226, v30, v30
    v_mul_f32 v227, v31, v31
    v_fma_f32 v226, v226, v15, v14
    v_fma_f32 v227, v227, v15, v14
    v_mfma_f32_32x32x16_bf16 v[80:95], a[172:175], a[140:143], v[80:95]
    s_waitcnt lgkmcnt(2)
    s_waitcnt vmcnt(25)
    s_barrier
    v_mul_f32 v226, v30, v226
    v_mul_f32 v227, v31, v227
    v_exp_f32 v226, v226
    v_exp_f32 v227, v227
    v_mfma_f32_16x16x32_bf16 v[48:51], a[144:147], a[176:179], 0
    s_add_u32 m0, s74, 36864
    s_add_u32 s3, s84, s26
    buffer_load_dwordx4 v10, s[52:55], s3 offen lds
    v_fma_f32 v226, v226, v254, v254
    v_fma_f32 v227, v227, v254, v254
    v_rcp_f32 v226, v226
    v_mfma_f32_16x16x32_bf16 v[52:55], a[144:147], a[180:183], 0
    s_cmp_eq_u32 s64, 3
    s_cselect_b32 s96, 0, 0x40000000
    s_add_u32 s96, s96, s39
    s_add_u32 s96, s96, 8192
    s_add_u32 m0, s74, 40960
    s_add_u32 s3, s85, s26
    ds_read_b128 a[156:159], v237 offset:2048
    buffer_load_dwordx4 a[224:227], v241, s[56:59], s96 offen sc1
    buffer_load_dwordx4 a[228:231], v242, s[56:59], s96 offen sc1
    buffer_load_dwordx4 a[232:235], v243, s[56:59], s96 offen sc1
    buffer_load_dwordx4 v10, s[52:55], s3 offen lds
    v_rcp_f32 v227, v227
    v_mul_f32 v30, v30, v226
    v_mul_f32 v31, v31, v227
    v_mfma_f32_16x16x32_bf16 v[56:59], a[144:147], a[184:187], 0
    s_waitcnt lgkmcnt(2)
    s_add_u32 s96, s39, 0
    s_add_u32 m0, s74, 45056
    s_add_u32 s3, s86, s26
    buffer_load_dwordx4 a[236:239], v244, s[56:59], s96 offen sc1
    buffer_load_dwordx4 a[240:243], v245, s[56:59], s96 offen sc1
    buffer_load_dwordx4 a[244:247], v246, s[56:59], s96 offen sc1
    buffer_load_dwordx4 v10, s[52:55], s3 offen lds
    v_lshrrev_b32 v252, 5, v0
    v_mfma_f32_16x16x32_bf16 v[60:63], a[148:151], a[176:179], 0
    s_add_u32 s96, s39, 2048
    s_add_u32 m0, s74, 49152
    s_add_u32 s3, s87, s26
    buffer_load_dwordx4 a[248:251], v244, s[56:59], s96 offen sc1
    buffer_load_dwordx4 a[252:255], v245, s[56:59], s96 offen sc1
    buffer_load_dwordx4 v[32:35], v246, s[56:59], s96 offen sc1
    buffer_load_dwordx4 v10, s[52:55], s3 offen lds
    v_mfma_f32_16x16x32_bf16 v[112:115], a[148:151], a[180:183], 0
    s_add_u32 s96, s39, 4096
    s_add_u32 m0, s74, 53248
    s_add_u32 s3, s88, s26
    ds_read_b128 a[160:163], v236 offset:4096
    buffer_load_dwordx4 v[36:39], v244, s[56:59], s96 offen sc1
    buffer_load_dwordx4 v[40:43], v245, s[56:59], s96 offen sc1
    buffer_load_dwordx4 v[44:47], v246, s[56:59], s96 offen sc1
    buffer_load_dwordx4 v10, s[52:55], s3 offen lds
    v_mul_f32 v16, v16, v80
    v_mul_f32 v17, v17, v81
    v_cvt_pk_bf16_f32 v208, v16, v17
    v_lshlrev_b32 v252, 9, v252
    v_mfma_f32_16x16x32_bf16 v[116:119], a[148:151], a[184:187], 0
    s_waitcnt lgkmcnt(2)
    s_add_u32 s96, s39, 6144
    s_waitcnt vmcnt(36)
    s_add_u32 m0, s74, 57344
    s_add_u32 s3, s89, s26
    buffer_load_dwordx4 v[96:99], v244, s[56:59], s96 offen sc1
    buffer_load_dwordx4 v[100:103], v245, s[56:59], s96 offen sc1
    buffer_load_dwordx4 v[104:107], v246, s[56:59], s96 offen sc1
    buffer_load_dwordx4 v10, s[52:55], s3 offen lds
    v_mul_f32 v18, v18, v82
    v_mul_f32 v19, v19, v83
    v_sub_u32 v2, v2, v252
    v_mfma_f32_16x16x32_bf16 v[48:51], a[152:155], a[188:191], v[48:51]
    s_add_u32 m0, s74, 61440
    s_add_u32 s3, s90, s26
    buffer_load_dwordx4 v10, s[52:55], s3 offen lds
    v_cvt_pk_bf16_f32 v209, v18, v19
    v_mul_f32 v20, v20, v84
    v_mul_f32 v21, v21, v85
    v_cvt_pk_bf16_f32 v210, v20, v21
    v_sub_u32 v6, v6, v252
    v_mfma_f32_16x16x32_bf16 v[52:55], a[152:155], a[192:195], v[52:55]
    s_add_u32 m0, s74, 65536
    s_add_u32 s3, s91, s26
    ds_read_b128 a[164:167], v236 offset:6144
    buffer_load_dwordx4 v10, s[52:55], s3 offen lds
    v_mul_f32 v22, v22, v86
    v_mul_f32 v23, v23, v87
    v_mfma_f32_16x16x32_bf16 v[56:59], a[152:155], a[196:199], v[56:59]
    s_waitcnt lgkmcnt(2)
    s_add_u32 m0, s74, 69632
    s_add_u32 s3, s92, s26
    buffer_load_dwordx4 v10, s[52:55], s3 offen lds
    v_cvt_pk_bf16_f32 v211, v22, v23
    v_mul_f32 v24, v24, v88
    v_mul_f32 v25, v25, v89
    v_sub_u32 v3, v3, v252
    v_mfma_f32_16x16x32_bf16 v[60:63], a[156:159], a[188:191], v[60:63]
    v_cvt_pk_bf16_f32 v212, v24, v25
    v_mul_f32 v26, v26, v90
    v_mul_f32 v27, v27, v91
    v_cvt_pk_bf16_f32 v213, v26, v27
    v_sub_u32 v7, v7, v252
    v_mfma_f32_16x16x32_bf16 v[112:115], a[156:159], a[192:195], v[112:115]
    ds_read_b128 a[168:171], v237 offset:4096
    v_mul_f32 v28, v28, v92
    v_mul_f32 v29, v29, v93
    v_mfma_f32_16x16x32_bf16 v[116:119], a[156:159], a[196:199], v[116:119]
    s_waitcnt lgkmcnt(2)
    s_waitcnt vmcnt(40)
    v_cvt_pk_bf16_f32 v214, v28, v29
    v_mul_f32 v30, v30, v94
    v_mul_f32 v31, v31, v95
    v_sub_u32 v4, v4, v252
    v_mfma_f32_16x16x32_bf16 v[48:51], a[160:163], a[200:203], v[48:51]
    s_cmp_eq_u32 s64, 3
    s_cselect_b32 s96, 0, 0x40000000
    s_add_u32 s96, s96, s39
    s_xor_b32 s76, s33, 1
    s_lshl_b32 s77, s76, 7
    s_add_u32 s77, s77, 48234496
    v_cvt_pk_bf16_f32 v215, v30, v31
    v_sub_u32 v8, v8, v252
    v_mfma_f32_16x16x32_bf16 v[52:55], a[160:163], a[204:207], v[52:55]
    s_add_u32 s34, s32, 16384
    s_add_u32 s96, s96, 8192
    s_lshl_b32 s76, s76, 2
    s_add_u32 s76, s76, s64
    s_mul_i32 s76, s76, 18432
    s_add_u32 s76, s76, 20971520
    ds_read_b128 a[172:175], v237 offset:6144
    buffer_load_dwordx4 v[108:111], v244, s[56:59], s96 offen sc1
    buffer_load_dwordx4 a[0:3], v245, s[56:59], s96 offen sc1
    buffer_load_dwordx4 a[4:7], v246, s[56:59], s96 offen sc1
    v_sub_u32 v5, v5, v252
    v_mfma_f32_16x16x32_bf16 v[56:59], a[160:163], a[208:211], v[56:59]
    s_waitcnt lgkmcnt(2)
    buffer_store_dwordx4 v[208:211], v1, s[56:59], s34 offen sc1
    v_mfma_f32_16x16x32_bf16 v[60:63], a[164:167], a[200:203], v[60:63]
    buffer_store_dwordx4 v[212:215], v1, s[56:59], s34 offen offset:1024 sc1
    v_sub_u32 v9, v9, v252
    v_mfma_f32_16x16x32_bf16 v[112:115], a[164:167], a[204:207], v[112:115]
    s_barrier
    ds_read_b128 a[144:147], v238 offset:0
    v_mfma_f32_16x16x32_bf16 v[116:119], a[164:167], a[208:211], v[116:119]
    s_waitcnt lgkmcnt(2)
    s_waitcnt vmcnt(42)
    v_mfma_f32_16x16x32_bf16 v[48:51], a[168:171], a[212:215], v[48:51]
    v_mfma_f32_16x16x32_bf16 v[52:55], a[168:171], a[216:219], v[52:55]
    ds_read_b128 a[148:151], v238 offset:2048
    v_mfma_f32_16x16x32_bf16 v[56:59], a[168:171], a[220:223], v[56:59]
    s_waitcnt lgkmcnt(2)
    v_mfma_f32_16x16x32_bf16 v[60:63], a[172:175], a[212:215], v[60:63]
    v_mfma_f32_16x16x32_bf16 v[112:115], a[172:175], a[216:219], v[112:115]
    ds_read_b128 a[152:155], v236 offset:36864
    v_mfma_f32_16x16x32_bf16 v[116:119], a[172:175], a[220:223], v[116:119]
    s_waitcnt lgkmcnt(2)
    s_waitcnt vmcnt(25)
    v_mfma_f32_16x16x32_bf16 v[48:51], a[144:147], a[224:227], v[48:51]
    v_mfma_f32_16x16x32_bf16 v[52:55], a[144:147], a[228:231], v[52:55]
    ds_read_b128 a[156:159], v236 offset:38912
    v_mfma_f32_16x16x32_bf16 v[56:59], a[144:147], a[232:235], v[56:59]
    s_waitcnt lgkmcnt(2)
    v_mfma_f32_16x16x32_bf16 v[60:63], a[148:151], a[224:227], v[60:63]
    v_mfma_f32_16x16x32_bf16 v[112:115], a[148:151], a[228:231], v[112:115]
    ds_read_b128 a[160:163], v237 offset:36864
    v_mfma_f32_16x16x32_bf16 v[116:119], a[148:151], a[232:235], v[116:119]
    s_waitcnt lgkmcnt(2)
    s_waitcnt vmcnt(21)
    s_waitcnt vmcnt(0)
    s_barrier
    v_mfma_f32_16x16x32_bf16 v[64:67], a[152:155], a[236:239], 0
    v_mov_b32 v252, 2
    v_mfma_f32_16x16x32_bf16 v[68:71], a[152:155], a[240:243], 0
    ds_read_b128 a[164:167], v237 offset:38912
    buffer_store_dword v252, v253, s[56:59], s1 offen sc1
    v_mfma_f32_16x16x32_bf16 v[72:75], a[152:155], a[244:247], 0
    s_waitcnt lgkmcnt(2)
    s_add_u32 m0, s74, 73728
    s_add_u32 s3, s84, s27
    buffer_load_dwordx4 v10, s[52:55], s3 offen lds
    v_mfma_f32_16x16x32_bf16 v[76:79], a[156:159], a[236:239], 0
    s_add_u32 m0, s74, 77824
    s_add_u32 s3, s85, s27
    buffer_load_dwordx4 v10, s[52:55], s3 offen lds
    v_mfma_f32_16x16x32_bf16 v[128:131], a[156:159], a[240:243], 0
    s_add_u32 m0, s74, 81920
    s_add_u32 s3, s86, s27
    ds_read_b128 a[168:171], v236 offset:40960
    buffer_load_dwordx4 v10, s[52:55], s3 offen lds
    v_mfma_f32_16x16x32_bf16 v[132:135], a[156:159], a[244:247], 0
    s_waitcnt lgkmcnt(2)
    s_add_u32 m0, s74, 86016
    s_add_u32 s3, s87, s27
    buffer_load_dwordx4 v10, s[52:55], s3 offen lds
    v_mfma_f32_16x16x32_bf16 v[64:67], a[160:163], a[248:251], v[64:67]
    s_add_u32 m0, s74, 90112
    s_add_u32 s3, s88, s27
    buffer_load_dwordx4 v10, s[52:55], s3 offen lds
    v_mfma_f32_16x16x32_bf16 v[68:71], a[160:163], a[252:255], v[68:71]
    s_add_u32 m0, s74, 94208
    s_add_u32 s3, s89, s27
    ds_read_b128 a[172:175], v236 offset:43008
    buffer_load_dwordx4 v10, s[52:55], s3 offen lds
    v_mfma_f32_16x16x32_bf16 v[72:75], a[160:163], v[32:35], v[72:75]
    s_waitcnt lgkmcnt(2)
    s_add_u32 m0, s74, 98304
    s_add_u32 s3, s90, s27
    buffer_load_dwordx4 v10, s[52:55], s3 offen lds
    v_mfma_f32_16x16x32_bf16 v[76:79], a[164:167], a[248:251], v[76:79]
    s_add_u32 m0, s74, 102400
    s_add_u32 s3, s91, s27
    buffer_load_dwordx4 v10, s[52:55], s3 offen lds
    v_mfma_f32_16x16x32_bf16 v[128:131], a[164:167], a[252:255], v[128:131]
    s_add_u32 m0, s74, 106496
    s_add_u32 s3, s92, s27
    ds_read_b128 a[144:147], v237 offset:40960
    buffer_load_dwordx4 v10, s[52:55], s3 offen lds
    v_mfma_f32_16x16x32_bf16 v[132:135], a[164:167], v[32:35], v[132:135]
    s_waitcnt lgkmcnt(2)
    v_mfma_f32_16x16x32_bf16 v[64:67], a[168:171], v[36:39], v[64:67]
    v_mfma_f32_16x16x32_bf16 v[68:71], a[168:171], v[40:43], v[68:71]
    ds_read_b128 a[148:151], v237 offset:43008
    v_mfma_f32_16x16x32_bf16 v[72:75], a[168:171], v[44:47], v[72:75]
    s_waitcnt lgkmcnt(2)
    v_mfma_f32_16x16x32_bf16 v[76:79], a[172:175], v[36:39], v[76:79]
    v_mfma_f32_16x16x32_bf16 v[128:131], a[172:175], v[40:43], v[128:131]
    ds_read_b128 a[152:155], v239 offset:0
    v_mfma_f32_16x16x32_bf16 v[132:135], a[172:175], v[44:47], v[132:135]
    s_waitcnt lgkmcnt(2)
    v_mfma_f32_16x16x32_bf16 v[64:67], a[144:147], v[96:99], v[64:67]
    v_mfma_f32_16x16x32_bf16 v[68:71], a[144:147], v[100:103], v[68:71]
    ds_read_b128 a[156:159], v239 offset:2048
    v_mfma_f32_16x16x32_bf16 v[72:75], a[144:147], v[104:107], v[72:75]
    s_waitcnt lgkmcnt(2)
    v_mfma_f32_16x16x32_bf16 v[76:79], a[148:151], v[96:99], v[76:79]
    v_mfma_f32_16x16x32_bf16 v[128:131], a[148:151], v[100:103], v[128:131]
    v_mfma_f32_16x16x32_bf16 v[132:135], a[148:151], v[104:107], v[132:135]
    s_barrier
    s_waitcnt lgkmcnt(1)
    ds_read_b64_tr_b16 a[160:161], v2 offset:0
    ds_read_b64_tr_b16 a[162:163], v2 offset:1024
    v_mfma_f32_16x16x32_bf16 v[64:67], a[152:155], v[108:111], v[64:67]
    ds_read_b64_tr_b16 a[164:165], v2 offset:2048
    ds_read_b64_tr_b16 a[166:167], v2 offset:3072
    v_mfma_f32_16x16x32_bf16 v[68:71], a[152:155], a[0:3], v[68:71]
    ds_read_b64_tr_b16 a[168:169], v2 offset:4096
    ds_read_b64_tr_b16 a[170:171], v2 offset:5120
    v_mfma_f32_16x16x32_bf16 v[72:75], a[152:155], a[4:7], v[72:75]
    s_waitcnt lgkmcnt(6)
    ds_read_b64_tr_b16 a[172:173], v2 offset:6144
    ds_read_b64_tr_b16 a[174:175], v2 offset:7168
    v_mfma_f32_16x16x32_bf16 v[76:79], a[156:159], v[108:111], v[76:79]
    ds_read_b64_tr_b16 a[144:145], v2 offset:8192
    ds_read_b64_tr_b16 a[146:147], v2 offset:9216
    v_mfma_f32_16x16x32_bf16 v[128:131], a[156:159], a[0:3], v[128:131]
    ds_read_b64_tr_b16 a[148:149], v2 offset:10240
    ds_read_b64_tr_b16 a[150:151], v2 offset:11264
    v_mfma_f32_16x16x32_bf16 v[132:135], a[156:159], a[4:7], v[132:135]
    s_waitcnt lgkmcnt(8)
    s_barrier
    ds_read_b64_tr_b16 a[152:153], v2 offset:12288
    ds_read_b64_tr_b16 a[154:155], v2 offset:13312
    s_or_b32 s79, s65, s38
    s_cmp_eq_u32 s79, 0
    s_cbranch_scc0 L_s_n512
    v_mov_b32 v232, 0x3f80
    v_mov_b32 v233, 0xbf80
    v_mov_b32 v234, v232
    v_mov_b32 v235, v233
    v_mov_b32 v236, 0xbf800000
    v_mov_b32 v237, 0x3f800000
    v_mov_b32 v238, v236
    v_mov_b32 v239, v237
    s_nop 1
    v_mfma_f32_16x16x32_bf16 v[120:123], v[232:235], a[176:179], 0
    v_mfma_f32_16x16x32_bf16 v[140:143], v[236:239], a[236:239], 0
    v_mfma_f32_16x16x32_bf16 v[124:127], v[232:235], a[180:183], 0
    v_mfma_f32_16x16x32_bf16 v[224:227], v[236:239], a[240:243], 0
    v_mfma_f32_16x16x32_bf16 v[136:139], v[232:235], a[184:187], 0
    v_mfma_f32_16x16x32_bf16 v[228:231], v[236:239], a[244:247], 0
    v_mfma_f32_16x16x32_bf16 v[120:123], v[232:235], a[188:191], v[120:123]
    v_mfma_f32_16x16x32_bf16 v[140:143], v[236:239], a[248:251], v[140:143]
    v_mfma_f32_16x16x32_bf16 v[124:127], v[232:235], a[192:195], v[124:127]
    v_mfma_f32_16x16x32_bf16 v[224:227], v[236:239], a[252:255], v[224:227]
    v_mfma_f32_16x16x32_bf16 v[136:139], v[232:235], a[196:199], v[136:139]
    v_mfma_f32_16x16x32_bf16 v[228:231], v[236:239], v[32:35], v[228:231]
    v_mfma_f32_16x16x32_bf16 v[120:123], v[232:235], a[200:203], v[120:123]
    v_mfma_f32_16x16x32_bf16 v[140:143], v[236:239], v[36:39], v[140:143]
    v_mfma_f32_16x16x32_bf16 v[124:127], v[232:235], a[204:207], v[124:127]
    v_mfma_f32_16x16x32_bf16 v[224:227], v[236:239], v[40:43], v[224:227]
    v_mfma_f32_16x16x32_bf16 v[136:139], v[232:235], a[208:211], v[136:139]
    v_mfma_f32_16x16x32_bf16 v[228:231], v[236:239], v[44:47], v[228:231]
    v_mfma_f32_16x16x32_bf16 v[120:123], v[232:235], a[212:215], v[120:123]
    v_mfma_f32_16x16x32_bf16 v[140:143], v[236:239], v[96:99], v[140:143]
    v_mfma_f32_16x16x32_bf16 v[124:127], v[232:235], a[216:219], v[124:127]
    v_mfma_f32_16x16x32_bf16 v[224:227], v[236:239], v[100:103], v[224:227]
    v_mfma_f32_16x16x32_bf16 v[136:139], v[232:235], a[220:223], v[136:139]
    v_mfma_f32_16x16x32_bf16 v[228:231], v[236:239], v[104:107], v[228:231]
    v_mfma_f32_16x16x32_bf16 v[120:123], v[232:235], a[224:227], v[120:123]
    v_mfma_f32_16x16x32_bf16 v[140:143], v[236:239], v[108:111], v[140:143]
    v_mfma_f32_16x16x32_bf16 v[124:127], v[232:235], a[228:231], v[124:127]
    v_mfma_f32_16x16x32_bf16 v[224:227], v[236:239], a[0:3], v[224:227]
    v_mfma_f32_16x16x32_bf16 v[136:139], v[232:235], a[232:235], v[136:139]
    v_mfma_f32_16x16x32_bf16 v[228:231], v[236:239], a[4:7], v[228:231]
    s_nop 7
L_s_n512:
    v_mfma_f32_32x32x16_bf16 v[32:47], a[160:163], v[144:147], 0
    ds_read_b64_tr_b16 a[156:157], v2 offset:14336
    ds_read_b64_tr_b16 a[158:159], v2 offset:15360
    v_mfma_f32_32x32x16_bf16 v[32:47], a[164:167], v[148:151], v[32:47]
    s_waitcnt lgkmcnt(8)
    ds_read_b64_tr_b16 a[160:161], v2 offset:16384
    ds_read_b64_tr_b16 a[162:163], v2 offset:17408
    v_mfma_f32_32x32x16_bf16 v[32:47], a[168:171], v[152:155], v[32:47]
    ds_read_b64_tr_b16 a[164:165], v2 offset:18432
    ds_read_b64_tr_b16 a[166:167], v2 offset:19456
    v_mfma_f32_32x32x16_bf16 v[32:47], a[172:175], v[156:159], v[32:47]
    s_waitcnt lgkmcnt(8)
    s_mul_i32 s96, s64, 12288
    s_add_u32 s96, s96, 110592
    ds_read_b64_tr_b16 a[168:169], v2 offset:20480
    ds_read_b64_tr_b16 a[170:171], v2 offset:21504
    v_mfma_f32_32x32x16_bf16 v[32:47], a[144:147], v[160:163], v[32:47]
    ds_read_b64_tr_b16 a[172:173], v2 offset:22528
    ds_read_b64_tr_b16 a[174:175], v2 offset:23552
    buffer_load_dword v242, off, s[56:59], s77 sc1
    v_lshrrev_b32 v240, 4, v0
    v_mul_u32_u24 v240, 768, v240
    v_and_b32 v241, 15, v0
    v_mfma_f32_32x32x16_bf16 v[32:47], a[148:151], v[164:167], v[32:47]
    s_waitcnt lgkmcnt(8)
    ds_read_b64_tr_b16 a[144:145], v2 offset:24576
    ds_read_b64_tr_b16 a[146:147], v2 offset:25600
    v_lshlrev_b32 v241, 2, v241
    v_add_u32 v240, v240, v241
    v_add_u32 v240, s96, v240
    v_mfma_f32_32x32x16_bf16 v[32:47], a[152:155], v[168:171], v[32:47]
    s_lshl_b32 s79, s65, 5
    s_add_u32 s79, s79, s38
    s_and_b32 s80, s64, 1
    ds_read_b64_tr_b16 a[148:149], v2 offset:26624
    ds_read_b64_tr_b16 a[150:151], v2 offset:27648
    v_add_u32 v243, 3072, v240
    v_add_u32 v244, 6144, v240
    v_add_u32 v246, 9216, v240
    v_mfma_f32_32x32x16_bf16 v[32:47], a[156:159], v[172:175], v[32:47]
    s_waitcnt lgkmcnt(8)
    s_lshl_b32 s80, s80, 4
    s_add_u32 s80, s80, s79
    s_sub_u32 s79, 1024, s80
    ds_read_b64_tr_b16 a[152:153], v2 offset:28672
    ds_read_b64_tr_b16 a[154:155], v2 offset:29696
    ds_write2_b32 v240, v48, v49 offset0:0 offset1:48
    v_mfma_f32_32x32x16_bf16 v[32:47], a[160:163], v[176:179], v[32:47]
    ds_read_b64_tr_b16 a[156:157], v2 offset:30720
    ds_read_b64_tr_b16 a[158:159], v2 offset:31744
    ds_write2_b32 v240, v50, v51 offset0:96 offset1:144
    ds_write2_b32 v240, v52, v53 offset0:16 offset1:64
    v_mfma_f32_32x32x16_bf16 v[32:47], a[164:167], v[180:183], v[32:47]
    s_waitcnt lgkmcnt(11)
    s_cmp_lt_u32 s64, 2
    s_cselect_b32 s80, s80, s79
    s_cselect_b32 s83, 2, -2
    ds_read_b64_tr_b16 a[160:161], v2 offset:32768
    ds_read_b64_tr_b16 a[162:163], v2 offset:33792
    ds_write2_b32 v240, v54, v55 offset0:112 offset1:160
    v_mfma_f32_32x32x16_bf16 v[32:47], a[168:171], v[184:187], v[32:47]
    s_lshl_b32 s79, s64, 3
    s_mul_i32 s79, s79, 192
    s_add_u32 s79, s79, 110592
    ds_read_b64_tr_b16 a[164:165], v2 offset:34816
    ds_read_b64_tr_b16 a[166:167], v2 offset:35840
    ds_write2_b32 v240, v56, v57 offset0:32 offset1:80
    v_mfma_f32_32x32x16_bf16 v[32:47], a[172:175], v[188:191], v[32:47]
    s_waitcnt lgkmcnt(13)
    s_and_b32 s81, s66, 7
    s_mul_i32 s81, s81, 144
    ds_read_b64_tr_b16 a[168:169], v6 offset:0
    ds_read_b64_tr_b16 a[170:171], v6 offset:1024
    ds_write2_b32 v240, v58, v59 offset0:128 offset1:176
    v_lshrrev_b32 v238, 3, v0
    v_mfma_f32_32x32x16_bf16 v[32:47], a[144:147], v[192:195], v[32:47]
    ds_read_b64_tr_b16 a[172:173], v6 offset:2048
    ds_read_b64_tr_b16 a[174:175], v6 offset:3072
    ds_write2_b32 v243, v60, v61 offset0:0 offset1:48
    ds_write2_b32 v243, v62, v63 offset0:96 offset1:144
    v_and_b32 v239, 7, v0
    v_mul_u32_u24 v232, 192, v238
    v_mfma_f32_32x32x16_bf16 v[32:47], a[148:151], v[196:199], v[32:47]
    s_waitcnt lgkmcnt(15)
    ds_read_b64_tr_b16 a[144:145], v6 offset:4096
    ds_read_b64_tr_b16 a[146:147], v6 offset:5120
    ds_write2_b32 v243, v112, v113 offset0:16 offset1:64
    v_lshlrev_b32 v239, 4, v239
    v_add_u32 v232, v232, v239
    v_add_u32 v232, s79, v232
    v_mfma_f32_32x32x16_bf16 v[32:47], a[152:155], v[200:203], v[32:47]
    s_waitcnt vmcnt(0)
    ds_read_b64_tr_b16 a[148:149], v6 offset:6144
    ds_read_b64_tr_b16 a[150:151], v6 offset:7168
    ds_write2_b32 v243, v114, v115 offset0:112 offset1:160
    ds_write2_b32 v243, v116, v117 offset0:32 offset1:80
    v_mul_lo_u32 v238, v238, s83
    v_add_u32 v238, s80, v238
    v_mfma_f32_32x32x16_bf16 v[32:47], a[156:159], v[204:207], v[32:47]
    s_waitcnt lgkmcnt(15)
    ds_read_b64_tr_b16 a[152:153], v6 offset:8192
    ds_read_b64_tr_b16 a[154:155], v6 offset:9216
    ds_write2_b32 v243, v118, v119 offset0:128 offset1:176
    v_add_u32 v239, s81, v239
    v_mul_u32_u24 v234, 1280, v238
    v_add_u32 v234, v234, v239
    v_readfirstlane_b32 s78, v242
    v_mfma_f32_32x32x16_bf16 v[32:47], a[160:163], v[208:211], v[32:47]
    ds_read_b64_tr_b16 a[156:157], v6 offset:10240
    ds_read_b64_tr_b16 a[158:159], v6 offset:11264
    ds_write2_b32 v244, v64, v65 offset0:0 offset1:48
    v_sub_u32 v235, 2048, v238
    v_mul_u32_u24 v235, 1280, v235
    v_add_u32 v235, v235, v239
    v_and_b32 v238, 0x3ff, v238
    v_mfma_f32_32x32x16_bf16 v[32:47], a[164:167], v[212:215], v[32:47]
    s_waitcnt lgkmcnt(15)
    ds_read_b64_tr_b16 a[160:161], v6 offset:12288
    ds_read_b64_tr_b16 a[162:163], v6 offset:13312
    ds_write2_b32 v244, v66, v67 offset0:96 offset1:144
    v_cmp_eq_u32 vcc, 0, v238
    v_mov_b32 v238, 0x40000000
    v_nop
    v_cndmask_b32 v235, v235, v238, vcc
    s_cmp_ge_u32 s78, 2
    s_cbranch_scc1 L_hp_ok
    s_mov_b32 s93, 0
L_hp:
    buffer_load_dword v242, off, s[56:59], s77 sc1
    s_waitcnt vmcnt(0)
    v_readfirstlane_b32 s78, v242
    s_nop 3
    s_cmp_ge_u32 s78, 2
    s_cbranch_scc1 L_hp_ok
    s_add_u32 s93, s93, 1
    s_cmp_gt_u32 s93, 0x40000
    s_cbranch_scc1 L_hp_ok
    s_sleep 1
    s_branch L_hp
L_hp_ok:
    v_mfma_f32_32x32x16_bf16 v[96:111], a[168:171], v[144:147], 0
    ds_read_b64_tr_b16 a[164:165], v6 offset:14336
    ds_read_b64_tr_b16 a[166:167], v6 offset:15360
    ds_write2_b32 v244, v68, v69 offset0:16 offset1:64
    ds_write2_b32 v244, v70, v71 offset0:112 offset1:160
    v_and_b32 v238, 7, v0
    v_mfma_f32_32x32x16_bf16 v[96:111], a[172:175], v[148:151], v[96:111]
    s_waitcnt lgkmcnt(15)
    s_add_u32 s82, s76, 0
    ds_read_b64_tr_b16 a[168:169], v6 offset:16384
    ds_read_b64_tr_b16 a[170:171], v6 offset:17408
    ds_write2_b32 v244, v72, v73 offset0:32 offset1:80
    v_lshrrev_b32 v239, 3, v0
    v_add_u32 v239, 8, v239
    v_min_u32 v239, 9, v239
    v_mfma_f32_32x32x16_bf16 v[96:111], a[144:147], v[152:155], v[96:111]
    ds_read_b64_tr_b16 a[172:173], v6 offset:18432
    ds_read_b64_tr_b16 a[174:175], v6 offset:19456
    ds_write2_b32 v244, v74, v75 offset0:128 offset1:176
    ds_write2_b32 v246, v76, v77 offset0:0 offset1:48
    buffer_load_dwordx4 a[8:11], v1, s[56:59], s82 offen offset:0 sc1
    buffer_load_dwordx4 a[12:15], v1, s[56:59], s82 offen offset:1024 sc1
    v_mul_u32_u24 v233, 192, v238
    v_lshlrev_b32 v239, 4, v239
    v_mfma_f32_32x32x16_bf16 v[96:111], a[148:151], v[156:159], v[96:111]
    s_waitcnt lgkmcnt(15)
    ds_read_b64_tr_b16 a[144:145], v6 offset:20480
    ds_read_b64_tr_b16 a[146:147], v6 offset:21504
    ds_write2_b32 v246, v78, v79 offset0:96 offset1:144
    v_add_u32 v233, v233, v239
    v_add_u32 v233, s79, v233
    v_mfma_f32_32x32x16_bf16 v[96:111], a[152:155], v[160:163], v[96:111]
    ds_read_b64_tr_b16 a[148:149], v6 offset:22528
    ds_read_b64_tr_b16 a[150:151], v6 offset:23552
    ds_write2_b32 v246, v128, v129 offset0:16 offset1:64
    v_mul_lo_u32 v238, v238, s83
    v_add_u32 v238, s80, v238
    v_add_u32 v239, s81, v239
    v_mul_u32_u24 v236, 1280, v238
    v_mfma_f32_32x32x16_bf16 v[96:111], a[156:159], v[164:167], v[96:111]
    s_waitcnt lgkmcnt(15)
    ds_read_b64_tr_b16 a[152:153], v6 offset:24576
    ds_read_b64_tr_b16 a[154:155], v6 offset:25600
    ds_write2_b32 v246, v130, v131 offset0:112 offset1:160
    v_add_u32 v236, v236, v239
    v_sub_u32 v237, 2048, v238
    v_mfma_f32_32x32x16_bf16 v[96:111], a[160:163], v[168:171], v[96:111]
    ds_read_b64_tr_b16 a[156:157], v6 offset:26624
    ds_read_b64_tr_b16 a[158:159], v6 offset:27648
    ds_write2_b32 v246, v132, v133 offset0:32 offset1:80
    ds_write2_b32 v246, v134, v135 offset0:128 offset1:176
    v_mul_u32_u24 v237, 1280, v237
    v_add_u32 v237, v237, v239
    v_mfma_f32_32x32x16_bf16 v[96:111], a[164:167], v[172:175], v[96:111]
    s_waitcnt lgkmcnt(15)
    s_mul_i32 s96, s64, 384
    s_add_u32 s96, s96, 159744
    ds_read_b64_tr_b16 a[160:161], v6 offset:28672
    ds_read_b64_tr_b16 a[162:163], v6 offset:29696
    v_add_u32 v241, s96, v241
    v_and_b32 v238, 0x3ff, v238
    v_mfma_f32_32x32x16_bf16 v[96:111], a[168:171], v[176:179], v[96:111]
    ds_read_b64_tr_b16 a[164:165], v6 offset:30720
    ds_read_b64_tr_b16 a[166:167], v6 offset:31744
    v_mov_b32 v245, 0x30000
    v_cmp_gt_u32 vcc, 16, v0
    v_nop
    v_nop
    v_cndmask_b32 v241, v245, v241, vcc
    v_mfma_f32_32x32x16_bf16 v[96:111], a[172:175], v[180:183], v[96:111]
    s_waitcnt lgkmcnt(12)
    ds_read_b64_tr_b16 a[168:169], v6 offset:32768
    ds_read_b64_tr_b16 a[170:171], v6 offset:33792
    ds_write_b32 v241, v120 offset:0
    v_cmp_eq_u32 vcc, 0, v238
    v_mov_b32 v238, 0x40000000
    v_nop
    v_cndmask_b32 v237, v237, v238, vcc
    v_mfma_f32_32x32x16_bf16 v[96:111], a[144:147], v[184:187], v[96:111]
    s_cmp_eq_u32 s81, 1008
    s_cselect_b32 s81, 16, 8
    s_add_u32 s82, s76, 2048
    ds_read_b64_tr_b16 a[172:173], v6 offset:34816
    ds_read_b64_tr_b16 a[174:175], v6 offset:35840
    ds_write_b32 v241, v140 offset:192
    ds_write_b32 v241, v124 offset:64
    v_mfma_f32_32x32x16_bf16 v[96:111], a[148:151], v[188:191], v[96:111]
    s_barrier
    s_waitcnt lgkmcnt(13)
    ds_read_b64_tr_b16 a[144:145], v3 offset:0
    ds_read_b64_tr_b16 a[146:147], v3 offset:1024
    buffer_load_dwordx4 a[16:19], v1, s[56:59], s82 offen offset:0 sc1
    buffer_load_dwordx4 a[20:23], v1, s[56:59], s82 offen offset:1024 sc1
    v_mov_b32 v238, 0x40000000
    v_mfma_f32_32x32x16_bf16 v[96:111], a[152:155], v[192:195], v[96:111]
    ds_read_b64_tr_b16 a[148:149], v3 offset:2048
    ds_read_b64_tr_b16 a[150:151], v3 offset:3072
    ds_write_b32 v241, v224 offset:256
    ds_write_b32 v241, v136 offset:128
    v_mfma_f32_32x32x16_bf16 v[96:111], a[156:159], v[196:199], v[96:111]
    s_waitcnt lgkmcnt(13)
    ds_read_b64_tr_b16 a[152:153], v3 offset:4096
    ds_read_b64_tr_b16 a[154:155], v3 offset:5120
    ds_write_b32 v241, v228 offset:320
    v_cmp_gt_u32 vcc, s81, v0
    v_nop
    v_nop
    v_cndmask_b32 v236, v238, v236, vcc
    v_cndmask_b32 v237, v238, v237, vcc
    v_mfma_f32_32x32x16_bf16 v[96:111], a[160:163], v[200:203], v[96:111]
    s_waitcnt lgkmcnt(0)
    s_barrier
    s_mov_b32 s80, 44040192
    ds_read_b64_tr_b16 a[156:157], v3 offset:6144
    ds_read_b64_tr_b16 a[158:159], v3 offset:7168
    v_mfma_f32_32x32x16_bf16 v[96:111], a[164:167], v[204:207], v[96:111]
    ds_read_b64_tr_b16 a[160:161], v3 offset:8192
    ds_read_b64_tr_b16 a[162:163], v3 offset:9216
    ds_read_b128 v[112:115], v232 offset:0
    ds_read_b128 v[116:119], v232 offset:12288
    v_mfma_f32_32x32x16_bf16 v[96:111], a[168:171], v[208:211], v[96:111]
    ds_read_b64_tr_b16 a[164:165], v3 offset:10240
    ds_read_b64_tr_b16 a[166:167], v3 offset:11264
    ds_read_b128 v[120:123], v232 offset:24576
    ds_read_b128 v[124:127], v232 offset:36864
    v_mfma_f32_32x32x16_bf16 v[96:111], a[172:175], v[212:215], v[96:111]
    s_barrier
    ds_read_b64_tr_b16 a[168:169], v3 offset:12288
    ds_read_b64_tr_b16 a[170:171], v3 offset:13312
    ds_read_b128 v[128:131], v232 offset:6144
    v_mfma_f32_32x32x16_bf16 v[16:31], a[144:147], v[144:147], 0
    s_add_u32 m0, s74, 0
    s_add_u32 s3, s16, s25
    ds_read_b64_tr_b16 a[172:173], v3 offset:14336
    ds_read_b64_tr_b16 a[174:175], v3 offset:15360
    ds_read_b128 v[132:135], v232 offset:18432
    ds_read_b128 v[136:139], v232 offset:30720
    buffer_load_dwordx4 v10, s[52:55], s3 offen lds
    v_mfma_f32_32x32x16_bf16 v[16:31], a[148:151], v[148:151], v[16:31]
    s_waitcnt lgkmcnt(15)
    s_add_u32 s82, s76, 4096
    ds_read_b64_tr_b16 a[144:145], v3 offset:16384
    ds_read_b64_tr_b16 a[146:147], v3 offset:17408
    ds_read_b128 v[140:143], v232 offset:43008
    ds_read_b128 v[48:51], v233 offset:0
    v_mfma_f32_32x32x16_bf16 v[16:31], a[152:155], v[152:155], v[16:31]
    s_add_u32 m0, s74, 4096
    s_add_u32 s3, s17, s25
    ds_read_b64_tr_b16 a[148:149], v3 offset:18432
    ds_read_b64_tr_b16 a[150:151], v3 offset:19456
    ds_read_b128 v[52:55], v233 offset:12288
    ds_read_b128 v[56:59], v233 offset:24576
    buffer_load_dwordx4 a[24:27], v1, s[56:59], s82 offen offset:0 sc1
    buffer_load_dwordx4 a[28:31], v1, s[56:59], s82 offen offset:1024 sc1
    buffer_load_dwordx4 v10, s[52:55], s3 offen lds
    v_mfma_f32_32x32x16_bf16 v[16:31], a[156:159], v[156:159], v[16:31]
    s_waitcnt lgkmcnt(15)
    ds_read_b64_tr_b16 a[152:153], v3 offset:20480
    ds_read_b64_tr_b16 a[154:155], v3 offset:21504
    ds_read_b128 v[60:63], v233 offset:36864
    v_mfma_f32_32x32x16_bf16 v[16:31], a[160:163], v[160:163], v[16:31]
    s_add_u32 m0, s74, 8192
    s_add_u32 s3, s18, s25
    ds_read_b64_tr_b16 a[156:157], v3 offset:22528
    ds_read_b64_tr_b16 a[158:159], v3 offset:23552
    ds_read_b128 v[64:67], v233 offset:6144
    ds_read_b128 v[68:71], v233 offset:18432
    buffer_load_dwordx4 v10, s[52:55], s3 offen lds
    v_mfma_f32_32x32x16_bf16 v[16:31], a[164:167], v[164:167], v[16:31]
    s_waitcnt lgkmcnt(15)
    ds_read_b64_tr_b16 a[160:161], v3 offset:24576
    ds_read_b64_tr_b16 a[162:163], v3 offset:25600
    ds_read_b128 v[72:75], v233 offset:30720
    ds_read_b128 v[76:79], v233 offset:43008
    v_mfma_f32_32x32x16_bf16 v[16:31], a[168:171], v[168:171], v[16:31]
    s_add_u32 m0, s74, 12288
    s_add_u32 s3, s19, s25
    ds_read_b64_tr_b16 a[164:165], v3 offset:26624
    ds_read_b64_tr_b16 a[166:167], v3 offset:27648
    buffer_load_dwordx4 v10, s[52:55], s3 offen lds
    v_mfma_f32_32x32x16_bf16 v[16:31], a[172:175], v[172:175], v[16:31]
    s_waitcnt lgkmcnt(15)
    ds_read_b64_tr_b16 a[168:169], v3 offset:28672
    ds_read_b64_tr_b16 a[170:171], v3 offset:29696
    v_mfma_f32_32x32x16_bf16 v[16:31], a[144:147], v[176:179], v[16:31]
    s_waitcnt lgkmcnt(4)
    s_barrier
    s_add_u32 m0, s74, 16384
    s_add_u32 s3, s20, s25
    ds_read_b64_tr_b16 a[172:173], v3 offset:30720
    ds_read_b64_tr_b16 a[174:175], v3 offset:31744
    buffer_load_dwordx4 v10, s[52:55], s3 offen lds
    v_mfma_f32_32x32x16_bf16 v[16:31], a[148:151], v[180:183], v[16:31]
    ds_read_b64_tr_b16 a[144:145], v3 offset:32768
    ds_read_b64_tr_b16 a[146:147], v3 offset:33792
    v_add_f32 v48, v48, v52
    v_add_f32 v56, v56, v60
    v_add_f32 v48, v48, v56
    v_add_f32 v49, v49, v53
    v_mfma_f32_32x32x16_bf16 v[16:31], a[152:155], v[184:187], v[16:31]
    s_add_u32 s82, s76, 6144
    s_add_u32 m0, s74, 20480
    s_add_u32 s3, s21, s25
    ds_read_b64_tr_b16 a[148:149], v3 offset:34816
    ds_read_b64_tr_b16 a[150:151], v3 offset:35840
    buffer_load_dwordx4 v10, s[52:55], s3 offen lds
    v_add_f32 v57, v57, v61
    v_add_f32 v49, v49, v57
    v_add_f32 v50, v50, v54
    v_add_f32 v58, v58, v62
    v_mfma_f32_32x32x16_bf16 v[16:31], a[156:159], v[188:191], v[16:31]
    s_waitcnt lgkmcnt(8)
    ds_read_b64_tr_b16 a[152:153], v7 offset:0
    ds_read_b64_tr_b16 a[154:155], v7 offset:1024
    buffer_load_dwordx4 a[32:35], v1, s[56:59], s82 offen offset:0 sc1
    buffer_load_dwordx4 a[36:39], v1, s[56:59], s82 offen offset:1024 sc1
    v_add_f32 v50, v50, v58
    v_add_f32 v51, v51, v55
    v_add_f32 v59, v59, v63
    v_add_f32 v51, v51, v59
    v_mfma_f32_32x32x16_bf16 v[16:31], a[160:163], v[192:195], v[16:31]
    s_add_u32 m0, s74, 24576
    s_add_u32 s3, s22, s25
    ds_read_b64_tr_b16 a[156:157], v7 offset:2048
    ds_read_b64_tr_b16 a[158:159], v7 offset:3072
    buffer_load_dwordx4 v10, s[52:55], s3 offen lds
    v_add_f32 v64, v64, v68
    v_add_f32 v72, v72, v76
    v_add_f32 v64, v64, v72
    v_add_f32 v65, v65, v69
    v_add_f32 v73, v73, v77
    v_mfma_f32_32x32x16_bf16 v[16:31], a[164:167], v[196:199], v[16:31]
    s_waitcnt lgkmcnt(8)
    ds_read_b64_tr_b16 a[160:161], v7 offset:4096
    ds_read_b64_tr_b16 a[162:163], v7 offset:5120
    v_add_f32 v65, v65, v73
    v_add_f32 v66, v66, v70
    v_add_f32 v74, v74, v78
    v_mfma_f32_32x32x16_bf16 v[16:31], a[168:171], v[200:203], v[16:31]
    s_add_u32 m0, s74, 28672
    s_add_u32 s3, s23, s25
    ds_read_b64_tr_b16 a[164:165], v7 offset:6144
    ds_read_b64_tr_b16 a[166:167], v7 offset:7168
    buffer_load_dwordx4 v10, s[52:55], s3 offen lds
    v_add_f32 v66, v66, v74
    v_add_f32 v67, v67, v71
    v_add_f32 v75, v75, v79
    v_add_f32 v67, v67, v75
    v_sub_f32 v52, v48, v64
    v_mfma_f32_32x32x16_bf16 v[16:31], a[172:175], v[204:207], v[16:31]
    s_waitcnt lgkmcnt(8)
    ds_read_b64_tr_b16 a[168:169], v7 offset:8192
    ds_read_b64_tr_b16 a[170:171], v7 offset:9216
    v_add_f32 v56, v48, v64
    v_sub_f32 v53, v49, v65
    v_add_f32 v57, v49, v65
    v_sub_f32 v54, v50, v66
    v_mfma_f32_32x32x16_bf16 v[16:31], a[144:147], v[208:211], v[16:31]
    s_add_u32 m0, s74, 32768
    s_add_u32 s3, s24, s25
    ds_read_b64_tr_b16 a[172:173], v7 offset:10240
    ds_read_b64_tr_b16 a[174:175], v7 offset:11264
    buffer_load_dwordx4 v10, s[52:55], s3 offen lds
    v_add_f32 v58, v50, v66
    v_sub_f32 v55, v51, v67
    v_add_f32 v59, v51, v67
    v_mfma_f32_32x32x16_bf16 v[16:31], a[148:151], v[212:215], v[16:31]
    s_waitcnt lgkmcnt(8)
    s_add_u32 m0, s74, 110592
    s_add_u32 s3, s16, s26
    ds_read_b64_tr_b16 a[144:145], v7 offset:12288
    ds_read_b64_tr_b16 a[146:147], v7 offset:13312
    buffer_store_dwordx4 v[52:55], v236, s[56:59], s80 offen sc1
    buffer_load_dwordx4 v10, s[52:55], s3 offen lds
    v_mfma_f32_32x32x16_bf16 v[80:95], a[152:155], v[144:147], 0
    ds_read_b64_tr_b16 a[148:149], v7 offset:14336
    ds_read_b64_tr_b16 a[150:151], v7 offset:15360
    buffer_store_dwordx4 v[56:59], v237, s[56:59], s80 offen sc1
    v_mfma_f32_32x32x16_bf16 v[80:95], a[156:159], v[148:151], v[80:95]
    s_waitcnt lgkmcnt(8)
    s_add_u32 s82, s76, 8192
    s_add_u32 m0, s74, 114688
    s_add_u32 s3, s17, s26
    ds_read_b64_tr_b16 a[152:153], v7 offset:16384
    ds_read_b64_tr_b16 a[154:155], v7 offset:17408
    buffer_load_dwordx4 v10, s[52:55], s3 offen lds
    v_add_f32 v112, v112, v116
    v_add_f32 v120, v120, v124
    v_add_f32 v112, v112, v120
    v_mfma_f32_32x32x16_bf16 v[80:95], a[160:163], v[152:155], v[80:95]
    ds_read_b64_tr_b16 a[156:157], v7 offset:18432
    ds_read_b64_tr_b16 a[158:159], v7 offset:19456
    buffer_load_dwordx4 a[40:43], v1, s[56:59], s82 offen offset:0 sc1
    buffer_load_dwordx4 a[44:47], v1, s[56:59], s82 offen offset:1024 sc1
    v_add_f32 v113, v113, v117
    v_add_f32 v121, v121, v125
    v_add_f32 v113, v113, v121
    v_add_f32 v114, v114, v118
    v_add_f32 v122, v122, v126
    v_mfma_f32_32x32x16_bf16 v[80:95], a[164:167], v[156:159], v[80:95]
    s_waitcnt lgkmcnt(8)
    s_add_u32 m0, s74, 118784
    s_add_u32 s3, s18, s26
    ds_read_b64_tr_b16 a[160:161], v7 offset:20480
    ds_read_b64_tr_b16 a[162:163], v7 offset:21504
    buffer_load_dwordx4 v10, s[52:55], s3 offen lds
    v_add_f32 v114, v114, v122
    v_add_f32 v115, v115, v119
    v_add_f32 v123, v123, v127
    v_add_f32 v115, v115, v123
    v_mfma_f32_32x32x16_bf16 v[80:95], a[168:171], v[160:163], v[80:95]
    ds_read_b64_tr_b16 a[164:165], v7 offset:22528
    ds_read_b64_tr_b16 a[166:167], v7 offset:23552
    v_add_f32 v128, v128, v132
    v_add_f32 v136, v136, v140
    v_add_f32 v128, v128, v136
    v_add_f32 v129, v129, v133
    v_mfma_f32_32x32x16_bf16 v[80:95], a[172:175], v[164:167], v[80:95]
    s_waitcnt lgkmcnt(8)
    s_add_u32 m0, s74, 122880
    s_add_u32 s3, s19, s26
    ds_read_b64_tr_b16 a[168:169], v7 offset:24576
    ds_read_b64_tr_b16 a[170:171], v7 offset:25600
    buffer_load_dwordx4 v10, s[52:55], s3 offen lds
    v_add_f32 v137, v137, v141
    v_add_f32 v129, v129, v137
    v_add_f32 v130, v130, v134
    v_add_f32 v138, v138, v142
    v_mfma_f32_32x32x16_bf16 v[80:95], a[144:147], v[168:171], v[80:95]
    ds_read_b64_tr_b16 a[172:173], v7 offset:26624
    ds_read_b64_tr_b16 a[174:175], v7 offset:27648
    v_add_f32 v130, v130, v138
    v_add_f32 v131, v131, v135
    v_add_f32 v139, v139, v143
    v_add_f32 v131, v131, v139
    v_mfma_f32_32x32x16_bf16 v[80:95], a[148:151], v[172:175], v[80:95]
    s_waitcnt lgkmcnt(8)
    s_add_u32 m0, s74, 126976
    s_add_u32 s3, s20, s26
    ds_read_b64_tr_b16 a[144:145], v7 offset:28672
    ds_read_b64_tr_b16 a[146:147], v7 offset:29696
    buffer_load_dwordx4 v10, s[52:55], s3 offen lds
    v_sub_f32 v116, v112, v128
    v_add_f32 v120, v112, v128
    v_sub_f32 v117, v113, v129
    v_add_f32 v121, v113, v129
    v_mfma_f32_32x32x16_bf16 v[80:95], a[152:155], v[176:179], v[80:95]
    ds_read_b64_tr_b16 a[148:149], v7 offset:30720
    ds_read_b64_tr_b16 a[150:151], v7 offset:31744
    v_sub_f32 v118, v114, v130
    v_add_f32 v122, v114, v130
    v_sub_f32 v119, v115, v131
    v_add_f32 v123, v115, v131
    v_mfma_f32_32x32x16_bf16 v[80:95], a[156:159], v[180:183], v[80:95]
    s_waitcnt lgkmcnt(8)
    s_add_u32 m0, s74, 131072
    s_add_u32 s3, s21, s26
    ds_read_b64_tr_b16 a[152:153], v7 offset:32768
    ds_read_b64_tr_b16 a[154:155], v7 offset:33792
    buffer_store_dwordx4 v[116:119], v234, s[56:59], s80 offen sc1
    buffer_load_dwordx4 v10, s[52:55], s3 offen lds
    v_mfma_f32_32x32x16_bf16 v[80:95], a[160:163], v[184:187], v[80:95]
    s_add_u32 s82, s76, 10240
    ds_read_b64_tr_b16 a[156:157], v7 offset:34816
    ds_read_b64_tr_b16 a[158:159], v7 offset:35840
    buffer_store_dwordx4 v[120:123], v235, s[56:59], s80 offen sc1
    v_mfma_f32_32x32x16_bf16 v[80:95], a[164:167], v[188:191], v[80:95]
    s_barrier
    s_waitcnt lgkmcnt(8)
    s_add_u32 m0, s74, 135168
    s_add_u32 s3, s22, s26
    ds_read_b64_tr_b16 a[160:161], v4 offset:0
    ds_read_b64_tr_b16 a[162:163], v4 offset:1024
    buffer_load_dwordx4 a[48:51], v1, s[56:59], s82 offen offset:0 sc1
    buffer_load_dwordx4 a[52:55], v1, s[56:59], s82 offen offset:1024 sc1
    buffer_load_dwordx4 v10, s[52:55], s3 offen lds
    v_mfma_f32_32x32x16_bf16 v[80:95], a[168:171], v[192:195], v[80:95]
    ds_read_b64_tr_b16 a[164:165], v4 offset:2048
    ds_read_b64_tr_b16 a[166:167], v4 offset:3072
    v_mfma_f32_32x32x16_bf16 v[80:95], a[172:175], v[196:199], v[80:95]
    s_waitcnt lgkmcnt(8)
    s_add_u32 m0, s74, 139264
    s_add_u32 s3, s23, s26
    ds_read_b64_tr_b16 a[168:169], v4 offset:4096
    ds_read_b64_tr_b16 a[170:171], v4 offset:5120
    buffer_load_dwordx4 v10, s[52:55], s3 offen lds
    v_mfma_f32_32x32x16_bf16 v[80:95], a[144:147], v[200:203], v[80:95]
    ds_read_b64_tr_b16 a[172:173], v4 offset:6144
    ds_read_b64_tr_b16 a[174:175], v4 offset:7168
    v_mfma_f32_32x32x16_bf16 v[80:95], a[148:151], v[204:207], v[80:95]
    s_waitcnt lgkmcnt(8)
    s_add_u32 m0, s74, 143360
    s_add_u32 s3, s24, s26
    ds_read_b64_tr_b16 a[144:145], v4 offset:8192
    ds_read_b64_tr_b16 a[146:147], v4 offset:9216
    buffer_load_dwordx4 v10, s[52:55], s3 offen lds
    s_or_b32 s79, s38, s65
    s_cmp_eq_u32 s79, 0
    s_cbranch_scc0 L_no512b
    v_and_b32 v238, 15, v0
    v_lshlrev_b32 v238, 2, v238
    v_add_u32 v238, 159744, v238
    ds_read_b32 v64, v238 offset:0
    ds_read_b32 v128, v238 offset:192
    ds_read_b32 v65, v238 offset:384
    ds_read_b32 v129, v238 offset:576
    ds_read_b32 v66, v238 offset:768
    ds_read_b32 v130, v238 offset:960
    ds_read_b32 v67, v238 offset:1152
    ds_read_b32 v131, v238 offset:1344
    ds_read_b32 v68, v238 offset:64
    ds_read_b32 v132, v238 offset:256
    ds_read_b32 v69, v238 offset:448
    ds_read_b32 v133, v238 offset:640
    ds_read_b32 v70, v238 offset:832
    ds_read_b32 v134, v238 offset:1024
    ds_read_b32 v71, v238 offset:1216
    ds_read_b32 v135, v238 offset:1408
    ds_read_b32 v72, v238 offset:128
    ds_read_b32 v136, v238 offset:320
    ds_read_b32 v73, v238 offset:512
    ds_read_b32 v137, v238 offset:704
    ds_read_b32 v74, v238 offset:896
    ds_read_b32 v138, v238 offset:1088
    ds_read_b32 v75, v238 offset:1280
    ds_read_b32 v139, v238 offset:1472
    s_waitcnt lgkmcnt(0)
    v_add_f32 v64, v64, v65
    v_add_f32 v66, v66, v67
    v_add_f32 v64, v64, v66
    v_add_f32 v128, v128, v129
    v_add_f32 v130, v130, v131
    v_add_f32 v128, v128, v130
    v_sub_f32 v65, v64, v128
    v_add_f32 v66, v64, v128
    v_add_f32 v68, v68, v69
    v_add_f32 v70, v70, v71
    v_add_f32 v68, v68, v70
    v_add_f32 v132, v132, v133
    v_add_f32 v134, v134, v135
    v_add_f32 v132, v132, v134
    v_sub_f32 v69, v68, v132
    v_add_f32 v70, v68, v132
    v_add_f32 v72, v72, v73
    v_add_f32 v74, v74, v75
    v_add_f32 v72, v72, v74
    v_add_f32 v136, v136, v137
    v_add_f32 v138, v138, v139
    v_add_f32 v136, v136, v138
    v_sub_f32 v73, v72, v136
    v_add_f32 v74, v72, v136
    s_or_b32 s79, s38, s64
    s_or_b32 s79, s79, s65
    s_cmp_eq_u32 s79, 0
    s_cselect_b32 s79, 16, 0
    v_cmp_gt_u32 vcc, s79, v0
    v_mov_b32 v238, 0
    v_mov_b32 v239, 0x40000000
    v_cndmask_b32 v238, v239, v238, vcc
    v_add_u32 v129, v238, v247
    v_add_u32 v133, v238, v250
    v_add_u32 v137, v238, v251
    s_mov_b32 s79, 44695552
    s_mov_b32 s81, 46006272
    buffer_store_dword v65, v129, s[56:59], s79 offen sc1
    buffer_store_dword v66, v129, s[56:59], s81 offen sc1
    buffer_store_dword v69, v133, s[56:59], s79 offen sc1
    buffer_store_dword v70, v133, s[56:59], s81 offen sc1
    buffer_store_dword v73, v137, s[56:59], s79 offen sc1
    buffer_store_dword v74, v137, s[56:59], s81 offen sc1
L_no512b:
    v_mfma_f32_32x32x16_bf16 v[80:95], a[152:155], v[208:211], v[80:95]
    ds_read_b64_tr_b16 a[148:149], v4 offset:10240
    ds_read_b64_tr_b16 a[150:151], v4 offset:11264
    v_mfma_f32_32x32x16_bf16 v[80:95], a[156:159], v[212:215], v[80:95]
    s_waitcnt lgkmcnt(8)
    s_barrier
    ds_read_b64_tr_b16 a[152:153], v4 offset:12288
    ds_read_b64_tr_b16 a[154:155], v4 offset:13312
    v_mfma_f32_32x32x16_bf16 v[48:63], a[160:163], v[144:147], 0
    s_add_u32 m0, s74, 36864
    s_add_u32 s3, s16, s27
    ds_read_b64_tr_b16 a[156:157], v4 offset:14336
    ds_read_b64_tr_b16 a[158:159], v4 offset:15360
    buffer_load_dwordx4 v10, s[52:55], s3 offen lds
    v_mfma_f32_32x32x16_bf16 v[48:63], a[164:167], v[148:151], v[48:63]
    s_waitcnt lgkmcnt(8)
    s_add_u32 s82, s76, 12288
    ds_read_b64_tr_b16 a[160:161], v4 offset:16384
    ds_read_b64_tr_b16 a[162:163], v4 offset:17408
    v_mfma_f32_32x32x16_bf16 v[48:63], a[168:171], v[152:155], v[48:63]
    s_add_u32 m0, s74, 40960
    s_add_u32 s3, s17, s27
    ds_read_b64_tr_b16 a[164:165], v4 offset:18432
    ds_read_b64_tr_b16 a[166:167], v4 offset:19456
    buffer_load_dwordx4 a[56:59], v1, s[56:59], s82 offen offset:0 sc1
    buffer_load_dwordx4 a[60:63], v1, s[56:59], s82 offen offset:1024 sc1
    buffer_load_dwordx4 v10, s[52:55], s3 offen lds
    v_mfma_f32_32x32x16_bf16 v[48:63], a[172:175], v[156:159], v[48:63]
    s_waitcnt lgkmcnt(8)
    ds_read_b64_tr_b16 a[168:169], v4 offset:20480
    ds_read_b64_tr_b16 a[170:171], v4 offset:21504
    v_mfma_f32_32x32x16_bf16 v[48:63], a[144:147], v[160:163], v[48:63]
    s_add_u32 m0, s74, 45056
    s_add_u32 s3, s18, s27
    ds_read_b64_tr_b16 a[172:173], v4 offset:22528
    ds_read_b64_tr_b16 a[174:175], v4 offset:23552
    buffer_load_dwordx4 v10, s[52:55], s3 offen lds
    v_mfma_f32_32x32x16_bf16 v[48:63], a[148:151], v[164:167], v[48:63]
    s_waitcnt lgkmcnt(8)
    ds_read_b64_tr_b16 a[144:145], v4 offset:24576
    ds_read_b64_tr_b16 a[146:147], v4 offset:25600
    v_mfma_f32_32x32x16_bf16 v[48:63], a[152:155], v[168:171], v[48:63]
    s_add_u32 m0, s74, 49152
    s_add_u32 s3, s19, s27
    ds_read_b64_tr_b16 a[148:149], v4 offset:26624
    ds_read_b64_tr_b16 a[150:151], v4 offset:27648
    buffer_load_dwordx4 v10, s[52:55], s3 offen lds
    v_mfma_f32_32x32x16_bf16 v[48:63], a[156:159], v[172:175], v[48:63]
    s_waitcnt lgkmcnt(8)
    ds_read_b64_tr_b16 a[152:153], v4 offset:28672
    ds_read_b64_tr_b16 a[154:155], v4 offset:29696
    v_mfma_f32_32x32x16_bf16 v[48:63], a[160:163], v[176:179], v[48:63]
    s_add_u32 m0, s74, 53248
    s_add_u32 s3, s20, s27
    ds_read_b64_tr_b16 a[156:157], v4 offset:30720
    ds_read_b64_tr_b16 a[158:159], v4 offset:31744
    buffer_load_dwordx4 v10, s[52:55], s3 offen lds
    v_mfma_f32_32x32x16_bf16 v[48:63], a[164:167], v[180:183], v[48:63]
    s_waitcnt lgkmcnt(8)
    ds_read_b64_tr_b16 a[160:161], v4 offset:32768
    ds_read_b64_tr_b16 a[162:163], v4 offset:33792
    v_mfma_f32_32x32x16_bf16 v[48:63], a[168:171], v[184:187], v[48:63]
    s_add_u32 s82, s76, 14336
    s_add_u32 m0, s74, 57344
    s_add_u32 s3, s21, s27
    ds_read_b64_tr_b16 a[164:165], v4 offset:34816
    ds_read_b64_tr_b16 a[166:167], v4 offset:35840
    buffer_load_dwordx4 v10, s[52:55], s3 offen lds
    v_mfma_f32_32x32x16_bf16 v[48:63], a[172:175], v[188:191], v[48:63]
    s_waitcnt lgkmcnt(8)
    ds_read_b64_tr_b16 a[168:169], v8 offset:0
    ds_read_b64_tr_b16 a[170:171], v8 offset:1024
    buffer_load_dwordx4 a[64:67], v1, s[56:59], s82 offen offset:0 sc1
    buffer_load_dwordx4 a[68:71], v1, s[56:59], s82 offen offset:1024 sc1
    v_mfma_f32_32x32x16_bf16 v[48:63], a[144:147], v[192:195], v[48:63]
    s_add_u32 m0, s74, 61440
    s_add_u32 s3, s22, s27
    ds_read_b64_tr_b16 a[172:173], v8 offset:2048
    ds_read_b64_tr_b16 a[174:175], v8 offset:3072
    buffer_load_dwordx4 v10, s[52:55], s3 offen lds
    v_mfma_f32_32x32x16_bf16 v[48:63], a[148:151], v[196:199], v[48:63]
    s_waitcnt lgkmcnt(8)
    ds_read_b64_tr_b16 a[144:145], v8 offset:4096
    ds_read_b64_tr_b16 a[146:147], v8 offset:5120
    v_mfma_f32_32x32x16_bf16 v[48:63], a[152:155], v[200:203], v[48:63]
    s_add_u32 m0, s74, 65536
    s_add_u32 s3, s23, s27
    ds_read_b64_tr_b16 a[148:149], v8 offset:6144
    ds_read_b64_tr_b16 a[150:151], v8 offset:7168
    buffer_load_dwordx4 v10, s[52:55], s3 offen lds
    v_mfma_f32_32x32x16_bf16 v[48:63], a[156:159], v[204:207], v[48:63]
    s_waitcnt lgkmcnt(8)
    ds_read_b64_tr_b16 a[152:153], v8 offset:8192
    ds_read_b64_tr_b16 a[154:155], v8 offset:9216
    v_mfma_f32_32x32x16_bf16 v[48:63], a[160:163], v[208:211], v[48:63]
    s_add_u32 m0, s74, 69632
    s_add_u32 s3, s24, s27
    ds_read_b64_tr_b16 a[156:157], v8 offset:10240
    ds_read_b64_tr_b16 a[158:159], v8 offset:11264
    buffer_load_dwordx4 v10, s[52:55], s3 offen lds
    v_mfma_f32_32x32x16_bf16 v[48:63], a[164:167], v[212:215], v[48:63]
    s_waitcnt lgkmcnt(8)
    ds_read_b64_tr_b16 a[160:161], v8 offset:12288
    ds_read_b64_tr_b16 a[162:163], v8 offset:13312
    v_mfma_f32_32x32x16_bf16 v[112:127], a[168:171], v[144:147], 0
    ds_read_b64_tr_b16 a[164:165], v8 offset:14336
    ds_read_b64_tr_b16 a[166:167], v8 offset:15360
    v_mfma_f32_32x32x16_bf16 v[112:127], a[172:175], v[148:151], v[112:127]
    s_waitcnt lgkmcnt(8)
    s_add_u32 s82, s76, 16384
    ds_read_b64_tr_b16 a[168:169], v8 offset:16384
    ds_read_b64_tr_b16 a[170:171], v8 offset:17408
    v_mfma_f32_32x32x16_bf16 v[112:127], a[144:147], v[152:155], v[112:127]
    ds_read_b64_tr_b16 a[172:173], v8 offset:18432
    ds_read_b64_tr_b16 a[174:175], v8 offset:19456
    buffer_load_dwordx4 a[72:75], v1, s[56:59], s82 offen offset:0 sc1
    buffer_load_dwordx4 a[76:79], v1, s[56:59], s82 offen offset:1024 sc1
    v_mfma_f32_32x32x16_bf16 v[112:127], a[148:151], v[156:159], v[112:127]
    s_waitcnt lgkmcnt(8)
    ds_read_b64_tr_b16 a[144:145], v8 offset:20480
    ds_read_b64_tr_b16 a[146:147], v8 offset:21504
    v_mfma_f32_32x32x16_bf16 v[112:127], a[152:155], v[160:163], v[112:127]
    ds_read_b64_tr_b16 a[148:149], v8 offset:22528
    ds_read_b64_tr_b16 a[150:151], v8 offset:23552
    v_mfma_f32_32x32x16_bf16 v[112:127], a[156:159], v[164:167], v[112:127]
    s_waitcnt lgkmcnt(8)
    ds_read_b64_tr_b16 a[152:153], v8 offset:24576
    ds_read_b64_tr_b16 a[154:155], v8 offset:25600
    v_mfma_f32_32x32x16_bf16 v[112:127], a[160:163], v[168:171], v[112:127]
    ds_read_b64_tr_b16 a[156:157], v8 offset:26624
    ds_read_b64_tr_b16 a[158:159], v8 offset:27648
    v_mfma_f32_32x32x16_bf16 v[112:127], a[164:167], v[172:175], v[112:127]
    s_waitcnt lgkmcnt(8)
    ds_read_b64_tr_b16 a[160:161], v8 offset:28672
    ds_read_b64_tr_b16 a[162:163], v8 offset:29696
    v_mfma_f32_32x32x16_bf16 v[112:127], a[168:171], v[176:179], v[112:127]
    ds_read_b64_tr_b16 a[164:165], v8 offset:30720
    ds_read_b64_tr_b16 a[166:167], v8 offset:31744
    v_mfma_f32_32x32x16_bf16 v[112:127], a[172:175], v[180:183], v[112:127]
    s_waitcnt lgkmcnt(8)
    ds_read_b64_tr_b16 a[168:169], v8 offset:32768
    ds_read_b64_tr_b16 a[170:171], v8 offset:33792
    v_mfma_f32_32x32x16_bf16 v[112:127], a[144:147], v[184:187], v[112:127]
    ds_read_b64_tr_b16 a[172:173], v8 offset:34816
    ds_read_b64_tr_b16 a[174:175], v8 offset:35840
    v_mfma_f32_32x32x16_bf16 v[112:127], a[148:151], v[188:191], v[112:127]
    s_waitcnt vmcnt(32)
    s_barrier
    s_waitcnt lgkmcnt(8)
    ds_read_b64_tr_b16 a[144:145], v2 offset:0
    ds_read_b64_tr_b16 a[146:147], v2 offset:1024
    v_mfma_f32_32x32x16_bf16 v[112:127], a[152:155], v[192:195], v[112:127]
    s_and_b32 s78, s66, 1
    s_mul_i32 s79, s78, 10
    s_lshr_b32 s80, s66, 2
    ds_read_b64_tr_b16 a[148:149], v2 offset:2048
    ds_read_b64_tr_b16 a[150:151], v2 offset:3072
    v_mfma_f32_32x32x16_bf16 v[112:127], a[156:159], v[196:199], v[112:127]
    s_waitcnt lgkmcnt(8)
    s_add_u32 s81, s80, 1
    s_and_b32 s81, s81, 3
    s_lshl_b32 s81, s81, 1
    ds_read_b64_tr_b16 a[152:153], v2 offset:4096
    ds_read_b64_tr_b16 a[154:155], v2 offset:5120
    v_mfma_f32_32x32x16_bf16 v[112:127], a[160:163], v[200:203], v[112:127]
    s_add_u32 s81, s81, s79
    s_lshl_b32 s81, s81, 11
    s_add_u32 s30, s81, s75
    ds_read_b64_tr_b16 a[156:157], v2 offset:6144
    ds_read_b64_tr_b16 a[158:159], v2 offset:7168
    v_mfma_f32_32x32x16_bf16 v[112:127], a[164:167], v[204:207], v[112:127]
    s_waitcnt lgkmcnt(8)
    s_add_u32 s81, s80, 2
    s_and_b32 s81, s81, 3
    s_lshl_b32 s81, s81, 1
    ds_read_b64_tr_b16 a[160:161], v2 offset:8192
    ds_read_b64_tr_b16 a[162:163], v2 offset:9216
    v_mfma_f32_32x32x16_bf16 v[112:127], a[168:171], v[208:211], v[112:127]
    s_waitcnt vmcnt(18)
    s_add_u32 s81, s81, s79
    s_lshl_b32 s81, s81, 11
    s_add_u32 s36, s81, s75
    ds_read_b64_tr_b16 a[164:165], v2 offset:10240
    ds_read_b64_tr_b16 a[166:167], v2 offset:11264
    v_mfma_f32_32x32x16_bf16 v[112:127], a[172:175], v[212:215], v[112:127]
    s_waitcnt lgkmcnt(8)
    s_barrier
    ds_read_b64_tr_b16 a[168:169], v2 offset:12288
    ds_read_b64_tr_b16 a[170:171], v2 offset:13312
    v_mfma_f32_32x32x16_bf16 v[32:47], a[144:147], a[8:11], v[32:47]
    s_and_b32 s96, s64, 1
    s_mul_i32 s96, s96, 18432
    ds_read_b64_tr_b16 a[172:173], v2 offset:14336
    ds_read_b64_tr_b16 a[174:175], v2 offset:15360
    v_mfma_f32_32x32x16_bf16 v[32:47], a[148:151], a[12:15], v[32:47]
    s_waitcnt lgkmcnt(8)
    ds_read_b64_tr_b16 a[144:145], v2 offset:16384
    ds_read_b64_tr_b16 a[146:147], v2 offset:17408
    v_lshrrev_b32 v250, 2, v0
    v_and_b32 v251, 3, v0
    v_lshlrev_b32 v251, 4, v251
    v_mfma_f32_32x32x16_bf16 v[32:47], a[152:155], a[16:19], v[32:47]
    ds_read_b64_tr_b16 a[148:149], v2 offset:18432
    ds_read_b64_tr_b16 a[150:151], v2 offset:19456
    v_mul_u32_u24 v250, 1152, v250
    v_add_u32 v11, v250, v251
    v_mfma_f32_32x32x16_bf16 v[32:47], a[156:159], a[20:23], v[32:47]
    s_waitcnt lgkmcnt(8)
    s_cmp_lt_u32 s64, 2
    s_cselect_b32 s3, s84, s85
    s_add_u32 s3, s3, s29
    s_add_u32 s3, s3, s96
    s_add_u32 m0, s74, 73728
    ds_read_b64_tr_b16 a[152:153], v2 offset:20480
    ds_read_b64_tr_b16 a[154:155], v2 offset:21504
    v_mfma_f32_32x32x16_bf16 v[32:47], a[160:163], a[24:27], v[32:47]
    s_add_u32 s81, s80, 3
    s_and_b32 s81, s81, 3
    s_lshl_b32 s81, s81, 1
    ds_read_b64_tr_b16 a[156:157], v2 offset:22528
    ds_read_b64_tr_b16 a[158:159], v2 offset:23552
    buffer_load_dwordx4 v11, s[52:55], s3 offen lds
    v_mfma_f32_32x32x16_bf16 v[32:47], a[164:167], a[28:31], v[32:47]
    s_waitcnt lgkmcnt(8)
    s_cmp_lt_u32 s64, 2
    s_cselect_b32 s3, s86, s87
    s_add_u32 s3, s3, s29
    s_add_u32 s3, s3, s96
    s_add_u32 m0, s74, 77824
    ds_read_b64_tr_b16 a[160:161], v6 offset:0
    ds_read_b64_tr_b16 a[162:163], v6 offset:1024
    v_mfma_f32_32x32x16_bf16 v[32:47], a[168:171], a[32:35], v[32:47]
    s_add_u32 s81, s81, s79
    s_lshl_b32 s81, s81, 11
    s_add_u32 s37, s81, s75
    ds_read_b64_tr_b16 a[164:165], v6 offset:2048
    ds_read_b64_tr_b16 a[166:167], v6 offset:3072
    buffer_load_dwordx4 v11, s[52:55], s3 offen lds
    v_mfma_f32_32x32x16_bf16 v[32:47], a[172:175], a[36:39], v[32:47]
    s_waitcnt lgkmcnt(8)
    s_cmp_lt_u32 s64, 2
    s_cselect_b32 s3, s88, s89
    s_add_u32 s3, s3, s29
    s_add_u32 s3, s3, s96
    s_add_u32 m0, s74, 81920
    ds_read_b64_tr_b16 a[168:169], v6 offset:4096
    ds_read_b64_tr_b16 a[170:171], v6 offset:5120
    v_mfma_f32_32x32x16_bf16 v[32:47], a[144:147], a[40:43], v[32:47]
    s_lshl_b32 s81, s80, 1
    s_add_u32 s81, s81, s79
    s_bfe_u32 s80, s66, 0x10001
    ds_read_b64_tr_b16 a[172:173], v6 offset:6144
    ds_read_b64_tr_b16 a[174:175], v6 offset:7168
    buffer_load_dwordx4 v11, s[52:55], s3 offen lds
    v_mfma_f32_32x32x16_bf16 v[32:47], a[148:151], a[44:47], v[32:47]
    s_waitcnt lgkmcnt(8)
    s_cmp_lt_u32 s64, 2
    s_cselect_b32 s3, s90, s91
    s_add_u32 s3, s3, s29
    s_add_u32 s3, s3, s96
    s_add_u32 m0, s74, 86016
    ds_read_b64_tr_b16 a[144:145], v6 offset:8192
    ds_read_b64_tr_b16 a[146:147], v6 offset:9216
    v_mfma_f32_32x32x16_bf16 v[32:47], a[152:155], a[48:51], v[32:47]
    s_add_u32 s32, s81, s80
    s_xor_b32 s80, s80, 1
    s_add_u32 s81, s81, s80
    ds_read_b64_tr_b16 a[148:149], v6 offset:10240
    ds_read_b64_tr_b16 a[150:151], v6 offset:11264
    buffer_load_dwordx4 v11, s[52:55], s3 offen lds
    v_mfma_f32_32x32x16_bf16 v[32:47], a[156:159], a[52:55], v[32:47]
    s_waitcnt lgkmcnt(8)
    s_cmp_lt_u32 s64, 2
    s_cselect_b32 s3, s92, s16
    s_add_u32 s3, s3, s29
    s_add_u32 s3, s3, s96
    s_add_u32 m0, s74, 90112
    ds_read_b64_tr_b16 a[152:153], v6 offset:12288
    ds_read_b64_tr_b16 a[154:155], v6 offset:13312
    v_mfma_f32_32x32x16_bf16 v[96:111], a[160:163], a[8:11], v[96:111]
    s_lshl_b32 s81, s81, 11
    s_add_u32 s39, s81, s75
    ds_read_b64_tr_b16 a[156:157], v6 offset:14336
    ds_read_b64_tr_b16 a[158:159], v6 offset:15360
    buffer_load_dwordx4 v11, s[52:55], s3 offen lds
    v_mfma_f32_32x32x16_bf16 v[96:111], a[164:167], a[12:15], v[96:111]
    s_waitcnt lgkmcnt(8)
    s_cmp_lt_u32 s64, 2
    s_cselect_b32 s3, s17, s18
    s_add_u32 s3, s3, s29
    s_add_u32 s3, s3, s96
    s_add_u32 m0, s74, 94208
    ds_read_b64_tr_b16 a[160:161], v6 offset:16384
    ds_read_b64_tr_b16 a[162:163], v6 offset:17408
    v_mfma_f32_32x32x16_bf16 v[96:111], a[168:171], a[16:19], v[96:111]
    s_add_u32 s81, s78, 8
    s_lshl_b32 s81, s81, 11
    s_add_u32 s31, s81, s75
    ds_read_b64_tr_b16 a[164:165], v6 offset:18432
    ds_read_b64_tr_b16 a[166:167], v6 offset:19456
    buffer_load_dwordx4 v11, s[52:55], s3 offen lds
    v_mfma_f32_32x32x16_bf16 v[96:111], a[172:175], a[20:23], v[96:111]
    s_waitcnt lgkmcnt(8)
    s_cmp_lt_u32 s64, 2
    s_cselect_b32 s3, s19, s20
    s_add_u32 s3, s3, s29
    s_add_u32 s3, s3, s96
    s_add_u32 m0, s74, 98304
    ds_read_b64_tr_b16 a[168:169], v6 offset:20480
    ds_read_b64_tr_b16 a[170:171], v6 offset:21504
    v_mfma_f32_32x32x16_bf16 v[96:111], a[144:147], a[24:27], v[96:111]
    ds_read_b64_tr_b16 a[172:173], v6 offset:22528
    ds_read_b64_tr_b16 a[174:175], v6 offset:23552
    buffer_load_dwordx4 v11, s[52:55], s3 offen lds
    v_mfma_f32_32x32x16_bf16 v[96:111], a[148:151], a[28:31], v[96:111]
    s_waitcnt lgkmcnt(8)
    s_cmp_lt_u32 s64, 2
    s_cselect_b32 s3, s21, s22
    s_add_u32 s3, s3, s29
    s_add_u32 s3, s3, s96
    s_add_u32 m0, s74, 102400
    ds_read_b64_tr_b16 a[144:145], v2 offset:24576
    ds_read_b64_tr_b16 a[146:147], v2 offset:25600
    v_mfma_f32_32x32x16_bf16 v[96:111], a[152:155], a[32:35], v[96:111]
    ds_read_b64_tr_b16 a[148:149], v2 offset:26624
    ds_read_b64_tr_b16 a[150:151], v2 offset:27648
    buffer_load_dwordx4 v11, s[52:55], s3 offen lds
    v_mfma_f32_32x32x16_bf16 v[96:111], a[156:159], a[36:39], v[96:111]
    s_waitcnt lgkmcnt(8)
    s_cmp_lt_u32 s64, 2
    s_cselect_b32 s3, s23, s24
    s_add_u32 s3, s3, s29
    s_add_u32 s3, s3, s96
    s_add_u32 m0, s74, 106496
    ds_read_b64_tr_b16 a[152:153], v2 offset:28672
    ds_read_b64_tr_b16 a[154:155], v2 offset:29696
    v_mfma_f32_32x32x16_bf16 v[96:111], a[160:163], a[40:43], v[96:111]
    ds_read_b64_tr_b16 a[156:157], v2 offset:30720
    ds_read_b64_tr_b16 a[158:159], v2 offset:31744
    buffer_load_dwordx4 v11, s[52:55], s3 offen lds
    v_mfma_f32_32x32x16_bf16 v[96:111], a[164:167], a[44:47], v[96:111]
    s_waitcnt lgkmcnt(8)
    ds_read_b64_tr_b16 a[160:161], v2 offset:32768
    ds_read_b64_tr_b16 a[162:163], v2 offset:33792
    v_mfma_f32_32x32x16_bf16 v[96:111], a[168:171], a[48:51], v[96:111]
    s_waitcnt vmcnt(21)
    ds_read_b64_tr_b16 a[164:165], v2 offset:34816
    ds_read_b64_tr_b16 a[166:167], v2 offset:35840
    v_mfma_f32_32x32x16_bf16 v[96:111], a[172:175], a[52:55], v[96:111]
    s_waitcnt lgkmcnt(8)
    ds_read_b64_tr_b16 a[168:169], v6 offset:24576
    ds_read_b64_tr_b16 a[170:171], v6 offset:25600
    v_mfma_f32_32x32x16_bf16 v[32:47], a[144:147], a[56:59], v[32:47]
    s_waitcnt vmcnt(14)
    ds_read_b64_tr_b16 a[172:173], v6 offset:26624
    ds_read_b64_tr_b16 a[174:175], v6 offset:27648
    v_mfma_f32_32x32x16_bf16 v[32:47], a[148:151], a[60:63], v[32:47]
    s_waitcnt lgkmcnt(8)
    ds_read_b64_tr_b16 a[144:145], v6 offset:28672
    ds_read_b64_tr_b16 a[146:147], v6 offset:29696
    v_mfma_f32_32x32x16_bf16 v[32:47], a[152:155], a[64:67], v[32:47]
    s_waitcnt vmcnt(9)
    ds_read_b64_tr_b16 a[148:149], v6 offset:30720
    ds_read_b64_tr_b16 a[150:151], v6 offset:31744
    v_mfma_f32_32x32x16_bf16 v[32:47], a[156:159], a[68:71], v[32:47]
    s_waitcnt lgkmcnt(8)
    ds_read_b64_tr_b16 a[152:153], v6 offset:32768
    ds_read_b64_tr_b16 a[154:155], v6 offset:33792
    v_mfma_f32_32x32x16_bf16 v[32:47], a[160:163], a[72:75], v[32:47]
    ds_read_b64_tr_b16 a[156:157], v6 offset:34816
    ds_read_b64_tr_b16 a[158:159], v6 offset:35840
    v_mfma_f32_32x32x16_bf16 v[32:47], a[164:167], a[76:79], v[32:47]
    s_barrier
    s_waitcnt lgkmcnt(8)
    ds_read_b64_tr_b16 a[160:161], v5 offset:0
    ds_read_b64_tr_b16 a[162:163], v5 offset:1024
    v_mfma_f32_32x32x16_bf16 v[96:111], a[168:171], a[56:59], v[96:111]
    ds_read_b64_tr_b16 a[164:165], v5 offset:2048
    ds_read_b64_tr_b16 a[166:167], v5 offset:3072
    v_mfma_f32_32x32x16_bf16 v[96:111], a[172:175], a[60:63], v[96:111]
    s_waitcnt lgkmcnt(8)
    ds_read_b64_tr_b16 a[168:169], v5 offset:4096
    ds_read_b64_tr_b16 a[170:171], v5 offset:5120
    v_mfma_f32_32x32x16_bf16 v[96:111], a[144:147], a[64:67], v[96:111]
    ds_read_b64_tr_b16 a[172:173], v5 offset:6144
    ds_read_b64_tr_b16 a[174:175], v5 offset:7168
    v_mfma_f32_32x32x16_bf16 v[96:111], a[148:151], a[68:71], v[96:111]
    s_waitcnt lgkmcnt(8)
    ds_read_b64_tr_b16 a[144:145], v5 offset:8192
    ds_read_b64_tr_b16 a[146:147], v5 offset:9216
    v_cvt_pk_bf16_f32 v216, v32, v33
    v_cvt_pk_bf16_f32 v217, v34, v35
    v_cvt_pk_bf16_f32 v218, v36, v37
    v_mfma_f32_32x32x16_bf16 v[96:111], a[152:155], a[72:75], v[96:111]
    ds_read_b64_tr_b16 a[148:149], v5 offset:10240
    ds_read_b64_tr_b16 a[150:151], v5 offset:11264
    v_cvt_pk_bf16_f32 v219, v38, v39
    v_cvt_pk_bf16_f32 v220, v40, v41
    v_cvt_pk_bf16_f32 v221, v42, v43
    v_cvt_pk_bf16_f32 v222, v44, v45
    v_mfma_f32_32x32x16_bf16 v[96:111], a[156:159], a[76:79], v[96:111]
    s_waitcnt lgkmcnt(8)
    s_barrier
    ds_read_b64_tr_b16 a[152:153], v5 offset:12288
    ds_read_b64_tr_b16 a[154:155], v5 offset:13312
    v_mfma_f32_32x32x16_bf16 v[16:31], a[160:163], a[8:11], v[16:31]
    s_add_u32 m0, s74, 0
    s_add_u32 s3, s84, s28
    ds_read_b64_tr_b16 a[156:157], v5 offset:14336
    ds_read_b64_tr_b16 a[158:159], v5 offset:15360
    buffer_load_dwordx4 v10, s[52:55], s3 offen lds
    v_cvt_pk_bf16_f32 v223, v46, v47
    v_mfma_f32_32x32x16_bf16 v[16:31], a[164:167], a[12:15], v[16:31]
    s_waitcnt lgkmcnt(8)
    s_add_u32 s34, s30, 0
    ds_read_b64_tr_b16 a[160:161], v5 offset:16384
    ds_read_b64_tr_b16 a[162:163], v5 offset:17408
    v_mfma_f32_32x32x16_bf16 v[16:31], a[168:171], a[16:19], v[16:31]
    s_add_u32 m0, s74, 4096
    s_add_u32 s3, s85, s28
    ds_read_b64_tr_b16 a[164:165], v5 offset:18432
    ds_read_b64_tr_b16 a[166:167], v5 offset:19456
    buffer_load_dwordx4 v10, s[52:55], s3 offen lds
    v_mfma_f32_32x32x16_bf16 v[16:31], a[172:175], a[20:23], v[16:31]
    s_waitcnt lgkmcnt(8)
    ds_read_b64_tr_b16 a[168:169], v5 offset:20480
    ds_read_b64_tr_b16 a[170:171], v5 offset:21504
    buffer_store_dwordx4 v[216:219], v1, s[56:59], s34 offen sc1
    v_cvt_pk_bf16_f32 v224, v96, v97
    v_mfma_f32_32x32x16_bf16 v[16:31], a[144:147], a[24:27], v[16:31]
    s_add_u32 m0, s74, 8192
    s_add_u32 s3, s86, s28
    ds_read_b64_tr_b16 a[172:173], v5 offset:22528
    ds_read_b64_tr_b16 a[174:175], v5 offset:23552
    buffer_load_dwordx4 v10, s[52:55], s3 offen lds
    v_cvt_pk_bf16_f32 v225, v98, v99
    v_cvt_pk_bf16_f32 v226, v100, v101
    v_mfma_f32_32x32x16_bf16 v[16:31], a[148:151], a[28:31], v[16:31]
    s_waitcnt lgkmcnt(8)
    ds_read_b64_tr_b16 a[144:145], v9 offset:0
    ds_read_b64_tr_b16 a[146:147], v9 offset:1024
    buffer_store_dwordx4 v[220:223], v1, s[56:59], s34 offen offset:1024 sc1
    v_mfma_f32_32x32x16_bf16 v[16:31], a[152:155], a[32:35], v[16:31]
    s_add_u32 m0, s74, 12288
    s_add_u32 s3, s87, s28
    ds_read_b64_tr_b16 a[148:149], v9 offset:2048
    ds_read_b64_tr_b16 a[150:151], v9 offset:3072
    buffer_load_dwordx4 v10, s[52:55], s3 offen lds
    v_cvt_pk_bf16_f32 v227, v102, v103
    v_cvt_pk_bf16_f32 v228, v104, v105
    v_mfma_f32_32x32x16_bf16 v[16:31], a[156:159], a[36:39], v[16:31]
    s_waitcnt lgkmcnt(8)
    ds_read_b64_tr_b16 a[152:153], v9 offset:4096
    ds_read_b64_tr_b16 a[154:155], v9 offset:5120
    v_lshrrev_b32 v250, 5, v0
    v_cvt_pk_bf16_f32 v229, v106, v107
    v_cvt_pk_bf16_f32 v230, v108, v109
    v_cvt_pk_bf16_f32 v231, v110, v111
    v_mfma_f32_32x32x16_bf16 v[16:31], a[160:163], a[40:43], v[16:31]
    s_add_u32 m0, s74, 16384
    s_add_u32 s3, s88, s28
    s_add_u32 s35, s30, 2048
    ds_read_b64_tr_b16 a[156:157], v9 offset:6144
    ds_read_b64_tr_b16 a[158:159], v9 offset:7168
    buffer_load_dwordx4 v10, s[52:55], s3 offen lds
    v_mfma_f32_32x32x16_bf16 v[16:31], a[164:167], a[44:47], v[16:31]
    s_waitcnt lgkmcnt(8)
    ds_read_b64_tr_b16 a[160:161], v9 offset:8192
    ds_read_b64_tr_b16 a[162:163], v9 offset:9216
    buffer_store_dwordx4 v[224:227], v1, s[56:59], s35 offen sc1
    v_mfma_f32_32x32x16_bf16 v[16:31], a[168:171], a[48:51], v[16:31]
    s_add_u32 m0, s74, 20480
    s_add_u32 s3, s89, s28
    ds_read_b64_tr_b16 a[164:165], v9 offset:10240
    ds_read_b64_tr_b16 a[166:167], v9 offset:11264
    buffer_load_dwordx4 v10, s[52:55], s3 offen lds
    v_lshlrev_b32 v250, 8, v250
    v_mfma_f32_32x32x16_bf16 v[16:31], a[172:175], a[52:55], v[16:31]
    s_waitcnt lgkmcnt(8)
    ds_read_b64_tr_b16 a[168:169], v9 offset:12288
    ds_read_b64_tr_b16 a[170:171], v9 offset:13312
    buffer_store_dwordx4 v[228:231], v1, s[56:59], s35 offen offset:1024 sc1
    v_mfma_f32_32x32x16_bf16 v[80:95], a[144:147], a[8:11], v[80:95]
    s_add_u32 m0, s74, 24576
    s_add_u32 s3, s90, s28
    ds_read_b64_tr_b16 a[172:173], v9 offset:14336
    ds_read_b64_tr_b16 a[174:175], v9 offset:15360
    buffer_load_dwordx4 v10, s[52:55], s3 offen lds
    v_mfma_f32_32x32x16_bf16 v[80:95], a[148:151], a[12:15], v[80:95]
    s_waitcnt lgkmcnt(8)
    ds_read_b64_tr_b16 a[144:145], v9 offset:16384
    ds_read_b64_tr_b16 a[146:147], v9 offset:17408
    v_bfe_u32 v251, v0, 2, 2
    v_mfma_f32_32x32x16_bf16 v[80:95], a[152:155], a[16:19], v[80:95]
    s_add_u32 m0, s74, 28672
    s_add_u32 s3, s91, s28
    ds_read_b64_tr_b16 a[148:149], v9 offset:18432
    ds_read_b64_tr_b16 a[150:151], v9 offset:19456
    buffer_load_dwordx4 v10, s[52:55], s3 offen lds
    v_mfma_f32_32x32x16_bf16 v[80:95], a[156:159], a[20:23], v[80:95]
    s_waitcnt lgkmcnt(8)
    ds_read_b64_tr_b16 a[152:153], v9 offset:20480
    ds_read_b64_tr_b16 a[154:155], v9 offset:21504
    v_lshlrev_b32 v251, 6, v251
    v_mfma_f32_32x32x16_bf16 v[80:95], a[160:163], a[24:27], v[80:95]
    s_add_u32 m0, s74, 32768
    s_add_u32 s3, s92, s28
    ds_read_b64_tr_b16 a[156:157], v9 offset:22528
    ds_read_b64_tr_b16 a[158:159], v9 offset:23552
    buffer_load_dwordx4 v10, s[52:55], s3 offen lds
    v_mfma_f32_32x32x16_bf16 v[80:95], a[164:167], a[28:31], v[80:95]
    s_waitcnt lgkmcnt(8)
    ds_read_b64_tr_b16 a[160:161], v5 offset:24576
    ds_read_b64_tr_b16 a[162:163], v5 offset:25600
    v_mfma_f32_32x32x16_bf16 v[80:95], a[168:171], a[32:35], v[80:95]
    ds_read_b64_tr_b16 a[164:165], v5 offset:26624
    ds_read_b64_tr_b16 a[166:167], v5 offset:27648
    v_add_u32 v250, v250, v251
    v_mfma_f32_32x32x16_bf16 v[80:95], a[172:175], a[36:39], v[80:95]
    s_waitcnt lgkmcnt(8)
    ds_read_b64_tr_b16 a[168:169], v5 offset:28672
    ds_read_b64_tr_b16 a[170:171], v5 offset:29696
    v_bfe_u32 v251, v0, 4, 1
    v_mfma_f32_32x32x16_bf16 v[80:95], a[144:147], a[40:43], v[80:95]
    ds_read_b64_tr_b16 a[172:173], v5 offset:30720
    ds_read_b64_tr_b16 a[174:175], v5 offset:31744
    v_mfma_f32_32x32x16_bf16 v[80:95], a[148:151], a[44:47], v[80:95]
    s_waitcnt lgkmcnt(8)
    ds_read_b64_tr_b16 a[144:145], v5 offset:32768
    ds_read_b64_tr_b16 a[146:147], v5 offset:33792
    v_lshlrev_b32 v251, 5, v251
    v_mfma_f32_32x32x16_bf16 v[80:95], a[152:155], a[48:51], v[80:95]
    ds_read_b64_tr_b16 a[148:149], v5 offset:34816
    ds_read_b64_tr_b16 a[150:151], v5 offset:35840
    v_add_u32 v250, v250, v251
    v_mfma_f32_32x32x16_bf16 v[80:95], a[156:159], a[52:55], v[80:95]
    s_waitcnt lgkmcnt(8)
    ds_read_b64_tr_b16 a[152:153], v9 offset:24576
    ds_read_b64_tr_b16 a[154:155], v9 offset:25600
    v_mfma_f32_32x32x16_bf16 v[16:31], a[160:163], a[56:59], v[16:31]
    ds_read_b64_tr_b16 a[156:157], v9 offset:26624
    ds_read_b64_tr_b16 a[158:159], v9 offset:27648
    v_and_b32 v251, 3, v0
    v_mfma_f32_32x32x16_bf16 v[16:31], a[164:167], a[60:63], v[16:31]
    s_waitcnt lgkmcnt(8)
    ds_read_b64_tr_b16 a[160:161], v9 offset:28672
    ds_read_b64_tr_b16 a[162:163], v9 offset:29696
    v_mfma_f32_32x32x16_bf16 v[16:31], a[168:171], a[64:67], v[16:31]
    ds_read_b64_tr_b16 a[164:165], v9 offset:30720
    ds_read_b64_tr_b16 a[166:167], v9 offset:31744
    v_lshlrev_b32 v251, 3, v251
    v_mfma_f32_32x32x16_bf16 v[16:31], a[172:175], a[68:71], v[16:31]
    s_waitcnt lgkmcnt(8)
    ds_read_b64_tr_b16 a[168:169], v9 offset:32768
    ds_read_b64_tr_b16 a[170:171], v9 offset:33792
    v_add_u32 v250, v250, v251
    v_mfma_f32_32x32x16_bf16 v[16:31], a[144:147], a[72:75], v[16:31]
    ds_read_b64_tr_b16 a[172:173], v9 offset:34816
    ds_read_b64_tr_b16 a[174:175], v9 offset:35840
    v_mfma_f32_32x32x16_bf16 v[16:31], a[148:151], a[76:79], v[16:31]
    s_barrier
    s_waitcnt lgkmcnt(8)
    ds_read_b64_tr_b16 a[144:145], v3 offset:0
    ds_read_b64_tr_b16 a[146:147], v3 offset:1024
    v_mfma_f32_32x32x16_bf16 v[80:95], a[152:155], a[56:59], v[80:95]
    ds_read_b64_tr_b16 a[148:149], v3 offset:2048
    ds_read_b64_tr_b16 a[150:151], v3 offset:3072
    v_add_u32 v248, 73728, v250
    v_mfma_f32_32x32x16_bf16 v[80:95], a[156:159], a[60:63], v[80:95]
    s_waitcnt lgkmcnt(8)
    ds_read_b64_tr_b16 a[152:153], v3 offset:4096
    ds_read_b64_tr_b16 a[154:155], v3 offset:5120
    v_mfma_f32_32x32x16_bf16 v[80:95], a[160:163], a[64:67], v[80:95]
    ds_read_b64_tr_b16 a[156:157], v3 offset:6144
    ds_read_b64_tr_b16 a[158:159], v3 offset:7168
    v_mfma_f32_32x32x16_bf16 v[80:95], a[164:167], a[68:71], v[80:95]
    s_waitcnt lgkmcnt(8)
    ds_read_b64_tr_b16 a[160:161], v3 offset:8192
    ds_read_b64_tr_b16 a[162:163], v3 offset:9216
    v_cvt_pk_bf16_f32 v216, v16, v17
    v_cvt_pk_bf16_f32 v217, v18, v19
    v_cvt_pk_bf16_f32 v218, v20, v21
    v_mfma_f32_32x32x16_bf16 v[80:95], a[168:171], a[72:75], v[80:95]
    ds_read_b64_tr_b16 a[164:165], v3 offset:10240
    ds_read_b64_tr_b16 a[166:167], v3 offset:11264
    v_cvt_pk_bf16_f32 v219, v22, v23
    v_cvt_pk_bf16_f32 v220, v24, v25
    v_cvt_pk_bf16_f32 v221, v26, v27
    v_cvt_pk_bf16_f32 v222, v28, v29
    v_mfma_f32_32x32x16_bf16 v[80:95], a[172:175], a[76:79], v[80:95]
    s_waitcnt lgkmcnt(8)
    s_barrier
    ds_read_b64_tr_b16 a[168:169], v3 offset:12288
    ds_read_b64_tr_b16 a[170:171], v3 offset:13312
    v_mfma_f32_32x32x16_bf16 v[48:63], a[144:147], a[8:11], v[48:63]
    s_add_u32 m0, s74, 110592
    s_add_u32 s3, s16, s28
    ds_read_b64_tr_b16 a[172:173], v3 offset:14336
    ds_read_b64_tr_b16 a[174:175], v3 offset:15360
    buffer_load_dwordx4 v10, s[52:55], s3 offen lds
    v_cvt_pk_bf16_f32 v223, v30, v31
    v_mfma_f32_32x32x16_bf16 v[48:63], a[148:151], a[12:15], v[48:63]
    s_waitcnt lgkmcnt(8)
    s_add_u32 s34, s36, 0
    ds_read_b64_tr_b16 a[144:145], v3 offset:16384
    ds_read_b64_tr_b16 a[146:147], v3 offset:17408
    v_mfma_f32_32x32x16_bf16 v[48:63], a[152:155], a[16:19], v[48:63]
    s_add_u32 m0, s74, 114688
    s_add_u32 s3, s17, s28
    ds_read_b64_tr_b16 a[148:149], v3 offset:18432
    ds_read_b64_tr_b16 a[150:151], v3 offset:19456
    buffer_load_dwordx4 v10, s[52:55], s3 offen lds
    v_mfma_f32_32x32x16_bf16 v[48:63], a[156:159], a[20:23], v[48:63]
    s_waitcnt lgkmcnt(8)
    ds_read_b64_tr_b16 a[152:153], v3 offset:20480
    ds_read_b64_tr_b16 a[154:155], v3 offset:21504
    buffer_store_dwordx4 v[216:219], v1, s[56:59], s34 offen sc1
    v_cvt_pk_bf16_f32 v224, v80, v81
    v_mfma_f32_32x32x16_bf16 v[48:63], a[160:163], a[24:27], v[48:63]
    s_add_u32 m0, s74, 118784
    s_add_u32 s3, s18, s28
    ds_read_b64_tr_b16 a[156:157], v3 offset:22528
    ds_read_b64_tr_b16 a[158:159], v3 offset:23552
    buffer_load_dwordx4 v10, s[52:55], s3 offen lds
    v_cvt_pk_bf16_f32 v225, v82, v83
    v_mfma_f32_32x32x16_bf16 v[48:63], a[164:167], a[28:31], v[48:63]
    s_waitcnt lgkmcnt(8)
    ds_read_b64_tr_b16 a[160:161], v3 offset:24576
    ds_read_b64_tr_b16 a[162:163], v3 offset:25600
    buffer_store_dwordx4 v[220:223], v1, s[56:59], s34 offen offset:1024 sc1
    v_cvt_pk_bf16_f32 v226, v84, v85
    v_mfma_f32_32x32x16_bf16 v[48:63], a[168:171], a[32:35], v[48:63]
    s_add_u32 m0, s74, 122880
    s_add_u32 s3, s19, s28
    ds_read_b64_tr_b16 a[164:165], v3 offset:26624
    ds_read_b64_tr_b16 a[166:167], v3 offset:27648
    buffer_load_dwordx4 v10, s[52:55], s3 offen lds
    v_cvt_pk_bf16_f32 v227, v86, v87
    v_cvt_pk_bf16_f32 v228, v88, v89
    v_mfma_f32_32x32x16_bf16 v[48:63], a[172:175], a[36:39], v[48:63]
    s_waitcnt lgkmcnt(8)
    ds_read_b64_tr_b16 a[168:169], v3 offset:28672
    ds_read_b64_tr_b16 a[170:171], v3 offset:29696
    v_cvt_pk_bf16_f32 v229, v90, v91
    v_cvt_pk_bf16_f32 v230, v92, v93
    v_cvt_pk_bf16_f32 v231, v94, v95
    v_mfma_f32_32x32x16_bf16 v[48:63], a[144:147], a[40:43], v[48:63]
    s_add_u32 m0, s74, 126976
    s_add_u32 s3, s20, s28
    s_add_u32 s35, s36, 2048
    ds_read_b64_tr_b16 a[172:173], v3 offset:30720
    ds_read_b64_tr_b16 a[174:175], v3 offset:31744
    buffer_load_dwordx4 v10, s[52:55], s3 offen lds
    v_mfma_f32_32x32x16_bf16 v[48:63], a[148:151], a[44:47], v[48:63]
    s_waitcnt lgkmcnt(8)
    ds_read_b64_tr_b16 a[144:145], v3 offset:32768
    ds_read_b64_tr_b16 a[146:147], v3 offset:33792
    buffer_store_dwordx4 v[224:227], v1, s[56:59], s35 offen sc1
    v_mfma_f32_32x32x16_bf16 v[48:63], a[152:155], a[48:51], v[48:63]
    s_add_u32 m0, s74, 131072
    s_add_u32 s3, s21, s28
    ds_read_b64_tr_b16 a[148:149], v3 offset:34816
    ds_read_b64_tr_b16 a[150:151], v3 offset:35840
    buffer_load_dwordx4 v10, s[52:55], s3 offen lds
    v_mfma_f32_32x32x16_bf16 v[48:63], a[156:159], a[52:55], v[48:63]
    s_waitcnt lgkmcnt(8)
    ds_read_b64_tr_b16 a[152:153], v7 offset:0
    ds_read_b64_tr_b16 a[154:155], v7 offset:1024
    buffer_store_dwordx4 v[228:231], v1, s[56:59], s35 offen offset:1024 sc1
    v_mfma_f32_32x32x16_bf16 v[48:63], a[160:163], a[56:59], v[48:63]
    s_add_u32 m0, s74, 135168
    s_add_u32 s3, s22, s28
    ds_read_b64_tr_b16 a[156:157], v7 offset:2048
    ds_read_b64_tr_b16 a[158:159], v7 offset:3072
    buffer_load_dwordx4 v10, s[52:55], s3 offen lds
    v_mfma_f32_32x32x16_bf16 v[48:63], a[164:167], a[60:63], v[48:63]
    s_waitcnt lgkmcnt(8)
    s_bfe_u32 s81, s66, 0x10001
    s_lshl_b32 s81, s81, 6
    s_xor_b32 s80, s81, 64
    ds_read_b64_tr_b16 a[160:161], v7 offset:4096
    ds_read_b64_tr_b16 a[162:163], v7 offset:5120
    v_mfma_f32_32x32x16_bf16 v[48:63], a[168:171], a[64:67], v[48:63]
    s_add_u32 m0, s74, 139264
    s_add_u32 s3, s23, s28
    ds_read_b64_tr_b16 a[164:165], v7 offset:6144
    ds_read_b64_tr_b16 a[166:167], v7 offset:7168
    buffer_load_dwordx4 v10, s[52:55], s3 offen lds
    v_mfma_f32_32x32x16_bf16 v[48:63], a[172:175], a[68:71], v[48:63]
    s_waitcnt lgkmcnt(8)
    ds_read_b64_tr_b16 a[168:169], v7 offset:8192
    ds_read_b64_tr_b16 a[170:171], v7 offset:9216
    v_xor_b32 v232, s80, v2
    v_mfma_f32_32x32x16_bf16 v[48:63], a[144:147], a[72:75], v[48:63]
    s_add_u32 m0, s74, 143360
    s_add_u32 s3, s24, s28
    ds_read_b64_tr_b16 a[172:173], v7 offset:10240
    ds_read_b64_tr_b16 a[174:175], v7 offset:11264
    buffer_load_dwordx4 v10, s[52:55], s3 offen lds
    v_mfma_f32_32x32x16_bf16 v[48:63], a[148:151], a[76:79], v[48:63]
    s_waitcnt lgkmcnt(8)
    ds_read_b64_tr_b16 a[144:145], v7 offset:12288
    ds_read_b64_tr_b16 a[146:147], v7 offset:13312
    v_xor_b32 v233, s80, v5
    v_mfma_f32_32x32x16_bf16 v[112:127], a[152:155], a[8:11], v[112:127]
    ds_read_b64_tr_b16 a[148:149], v7 offset:14336
    ds_read_b64_tr_b16 a[150:151], v7 offset:15360
    v_xor_b32 v234, s81, v2
    v_mfma_f32_32x32x16_bf16 v[112:127], a[156:159], a[12:15], v[112:127]
    s_waitcnt lgkmcnt(8)
    ds_read_b64_tr_b16 a[152:153], v7 offset:16384
    ds_read_b64_tr_b16 a[154:155], v7 offset:17408
    v_xor_b32 v235, s81, v5
    v_mfma_f32_32x32x16_bf16 v[112:127], a[160:163], a[16:19], v[112:127]
    ds_read_b64_tr_b16 a[156:157], v7 offset:18432
    ds_read_b64_tr_b16 a[158:159], v7 offset:19456
    v_mfma_f32_32x32x16_bf16 v[112:127], a[164:167], a[20:23], v[112:127]
    s_waitcnt lgkmcnt(8)
    ds_read_b64_tr_b16 a[160:161], v7 offset:20480
    ds_read_b64_tr_b16 a[162:163], v7 offset:21504
    v_cvt_pk_bf16_f32 v216, v48, v49
    v_cvt_pk_bf16_f32 v217, v50, v51
    v_cvt_pk_bf16_f32 v218, v52, v53
    v_mfma_f32_32x32x16_bf16 v[112:127], a[168:171], a[24:27], v[112:127]
    ds_read_b64_tr_b16 a[164:165], v7 offset:22528
    ds_read_b64_tr_b16 a[166:167], v7 offset:23552
    v_cvt_pk_bf16_f32 v219, v54, v55
    v_cvt_pk_bf16_f32 v220, v56, v57
    v_cvt_pk_bf16_f32 v221, v58, v59
    v_cvt_pk_bf16_f32 v222, v60, v61
    v_mfma_f32_32x32x16_bf16 v[112:127], a[172:175], a[28:31], v[112:127]
    s_waitcnt lgkmcnt(8)
    ds_read_b64_tr_b16 a[168:169], v7 offset:24576
    ds_read_b64_tr_b16 a[170:171], v7 offset:25600
    v_cvt_pk_bf16_f32 v223, v62, v63
    v_mfma_f32_32x32x16_bf16 v[112:127], a[144:147], a[32:35], v[112:127]
    s_lshl_b32 s80, s65, 2
    s_add_u32 s80, s80, s64
    s_add_u32 s34, s37, 0
    ds_read_b64_tr_b16 a[172:173], v7 offset:26624
    ds_read_b64_tr_b16 a[174:175], v7 offset:27648
    v_mfma_f32_32x32x16_bf16 v[112:127], a[148:151], a[36:39], v[112:127]
    s_waitcnt lgkmcnt(8)
    s_mul_i32 s81, s80, 18
    s_add_u32 s81, s81, s32
    s_lshl_b32 s81, s81, 11
    ds_read_b64_tr_b16 a[144:145], v7 offset:28672
    ds_read_b64_tr_b16 a[146:147], v7 offset:29696
    v_mfma_f32_32x32x16_bf16 v[112:127], a[152:155], a[40:43], v[112:127]
    s_lshr_b32 s79, s66, 1
    ds_read_b64_tr_b16 a[148:149], v7 offset:30720
    ds_read_b64_tr_b16 a[150:151], v7 offset:31744
    buffer_store_dwordx4 v[216:219], v1, s[56:59], s34 offen sc1
    v_mfma_f32_32x32x16_bf16 v[112:127], a[156:159], a[44:47], v[112:127]
    s_waitcnt lgkmcnt(8)
    s_lshr_b32 s16, s79, 1
    s_add_u32 s16, s16, 3
    s_and_b32 s16, s16, 3
    ds_read_b64_tr_b16 a[152:153], v7 offset:32768
    ds_read_b64_tr_b16 a[154:155], v7 offset:33792
    v_mfma_f32_32x32x16_bf16 v[112:127], a[160:163], a[48:51], v[112:127]
    s_lshl_b32 s16, s16, 1
    s_add_u32 s16, s16, 0
    s_mul_i32 s16, s16, 2359296
    ds_read_b64_tr_b16 a[156:157], v7 offset:34816
    ds_read_b64_tr_b16 a[158:159], v7 offset:35840
    v_mfma_f32_32x32x16_bf16 v[112:127], a[164:167], a[52:55], v[112:127]
    s_waitcnt vmcnt(27)
    s_barrier
    s_waitcnt lgkmcnt(8)
    ds_read_b64_tr_b16 a[160:161], v248 offset:0
    ds_read_b64_tr_b16 a[162:163], v248 offset:512
    v_mfma_f32_32x32x16_bf16 v[112:127], a[168:171], a[56:59], v[112:127]
    s_add_u32 s16, s16, s81
    s_lshr_b32 s17, s79, 1
    s_add_u32 s17, s17, 3
    s_and_b32 s17, s17, 3
    ds_read_b64_tr_b16 a[164:165], v248 offset:1024
    ds_read_b64_tr_b16 a[166:167], v248 offset:1536
    v_mfma_f32_32x32x16_bf16 v[112:127], a[172:175], a[60:63], v[112:127]
    s_waitcnt lgkmcnt(8)
    ds_read_b64_tr_b16 a[168:169], v248 offset:2048
    ds_read_b64_tr_b16 a[170:171], v248 offset:2560
    buffer_store_dwordx4 v[220:223], v1, s[56:59], s34 offen offset:1024 sc1
    v_mfma_f32_32x32x16_bf16 v[112:127], a[144:147], a[64:67], v[112:127]
    s_lshl_b32 s17, s17, 1
    s_add_u32 s17, s17, 1
    s_mul_i32 s17, s17, 2359296
    s_add_u32 s17, s17, s81
    ds_read_b64_tr_b16 a[172:173], v248 offset:3072
    ds_read_b64_tr_b16 a[174:175], v248 offset:3584
    v_mfma_f32_32x32x16_bf16 v[112:127], a[148:151], a[68:71], v[112:127]
    s_waitcnt lgkmcnt(8)
    s_lshr_b32 s18, s79, 1
    s_add_u32 s18, s18, 2
    s_and_b32 s18, s18, 3
    ds_read_b64_tr_b16 a[144:145], v248 offset:4096
    ds_read_b64_tr_b16 a[146:147], v248 offset:4608
    v_mfma_f32_32x32x16_bf16 v[112:127], a[152:155], a[72:75], v[112:127]
    ds_read_b64_tr_b16 a[148:149], v248 offset:5120
    ds_read_b64_tr_b16 a[150:151], v248 offset:5632
    v_mfma_f32_32x32x16_bf16 v[112:127], a[156:159], a[76:79], v[112:127]
    s_waitcnt lgkmcnt(8)
    s_lshl_b32 s18, s18, 1
    s_add_u32 s18, s18, 0
    s_mul_i32 s18, s18, 2359296
    ds_read_b64_tr_b16 a[152:153], v248 offset:6144
    ds_read_b64_tr_b16 a[154:155], v248 offset:6656
    v_mfma_f32_32x32x16_bf16 v[32:47], a[160:163], v[144:147], 0
    s_add_u32 s18, s18, s81
    s_lshr_b32 s19, s79, 1
    s_add_u32 s19, s19, 2
    s_and_b32 s19, s19, 3
    ds_read_b64_tr_b16 a[156:157], v248 offset:7168
    ds_read_b64_tr_b16 a[158:159], v248 offset:7680
    v_mfma_f32_32x32x16_bf16 v[32:47], a[164:167], v[148:151], v[32:47]
    s_waitcnt lgkmcnt(8)
    ds_read_b64_tr_b16 a[160:161], v248 offset:8192
    ds_read_b64_tr_b16 a[162:163], v248 offset:8704
    v_mfma_f32_32x32x16_bf16 v[32:47], a[168:171], v[152:155], v[32:47]
    s_lshl_b32 s19, s19, 1
    s_add_u32 s19, s19, 1
    s_mul_i32 s19, s19, 2359296
    s_add_u32 s19, s19, s81
    ds_read_b64_tr_b16 a[164:165], v248 offset:9216
    ds_read_b64_tr_b16 a[166:167], v248 offset:9728
    v_mfma_f32_32x32x16_bf16 v[32:47], a[172:175], v[156:159], v[32:47]
    s_waitcnt lgkmcnt(8)
    s_lshr_b32 s20, s79, 1
    s_add_u32 s20, s20, 1
    s_and_b32 s20, s20, 3
    ds_read_b64_tr_b16 a[168:169], v248 offset:10240
    ds_read_b64_tr_b16 a[170:171], v248 offset:10752
    v_cvt_pk_bf16_f32 v224, v112, v113
    v_mfma_f32_32x32x16_bf16 v[32:47], a[144:147], v[160:163], v[32:47]
    ds_read_b64_tr_b16 a[172:173], v248 offset:11264
    ds_read_b64_tr_b16 a[174:175], v248 offset:11776
    v_cvt_pk_bf16_f32 v225, v114, v115
    v_cvt_pk_bf16_f32 v226, v116, v117
    v_cvt_pk_bf16_f32 v227, v118, v119
    v_cvt_pk_bf16_f32 v228, v120, v121
    v_mfma_f32_32x32x16_bf16 v[32:47], a[148:151], v[164:167], v[32:47]
    s_waitcnt lgkmcnt(8)
    s_lshl_b32 s20, s20, 1
    s_add_u32 s20, s20, 0
    s_mul_i32 s20, s20, 2359296
    ds_read_b64_tr_b16 a[144:145], v248 offset:12288
    ds_read_b64_tr_b16 a[146:147], v248 offset:12800
    v_cvt_pk_bf16_f32 v229, v122, v123
    v_mfma_f32_32x32x16_bf16 v[32:47], a[152:155], v[168:171], v[32:47]
    s_add_u32 s20, s20, s81
    s_lshr_b32 s21, s79, 1
    s_add_u32 s21, s21, 1
    s_and_b32 s21, s21, 3
    ds_read_b64_tr_b16 a[148:149], v248 offset:13312
    ds_read_b64_tr_b16 a[150:151], v248 offset:13824
    v_cvt_pk_bf16_f32 v230, v124, v125
    v_mfma_f32_32x32x16_bf16 v[32:47], a[156:159], v[172:175], v[32:47]
    s_waitcnt lgkmcnt(8)
    ds_read_b64_tr_b16 a[152:153], v248 offset:14336
    ds_read_b64_tr_b16 a[154:155], v248 offset:14848
    v_cvt_pk_bf16_f32 v231, v126, v127
    v_mfma_f32_32x32x16_bf16 v[32:47], a[160:163], v[176:179], v[32:47]
    s_lshl_b32 s21, s21, 1
    s_add_u32 s21, s21, 1
    s_mul_i32 s21, s21, 2359296
    s_add_u32 s21, s21, s81
    s_add_u32 s35, s37, 2048
    ds_read_b64_tr_b16 a[156:157], v248 offset:15360
    ds_read_b64_tr_b16 a[158:159], v248 offset:15872
    v_mfma_f32_32x32x16_bf16 v[32:47], a[164:167], v[180:183], v[32:47]
    s_waitcnt lgkmcnt(8)
    s_xor_b32 s22, s79, 1
    s_mul_i32 s22, s22, 2359296
    s_add_u32 s22, s22, s81
    ds_read_b64_tr_b16 a[160:161], v248 offset:16384
    ds_read_b64_tr_b16 a[162:163], v248 offset:16896
    v_mfma_f32_32x32x16_bf16 v[32:47], a[168:171], v[184:187], v[32:47]
    s_lshl_b32 s81, s80, 3
    ds_read_b64_tr_b16 a[164:165], v248 offset:17408
    ds_read_b64_tr_b16 a[166:167], v248 offset:17920
    buffer_store_dwordx4 v[224:227], v1, s[56:59], s35 offen sc1
    v_and_b32 v244, 7, v0
    v_mfma_f32_32x32x16_bf16 v[32:47], a[172:175], v[188:191], v[32:47]
    s_waitcnt lgkmcnt(8)
    ds_read_b64_tr_b16 a[168:169], v248 offset:18432
    ds_read_b64_tr_b16 a[170:171], v248 offset:18944
    v_add_u32 v244, s81, v244
    v_bfe_u32 v245, v0, 3, 2
    v_mfma_f32_32x32x16_bf16 v[32:47], a[144:147], v[192:195], v[32:47]
    ds_read_b64_tr_b16 a[172:173], v248 offset:19456
    ds_read_b64_tr_b16 a[174:175], v248 offset:19968
    buffer_store_dwordx4 v[228:231], v1, s[56:59], s35 offen offset:1024 sc1
    v_add_u32 v246, 1, v245
    v_lshrrev_b32 v246, 1, v246
    v_mfma_f32_32x32x16_bf16 v[32:47], a[148:151], v[196:199], v[32:47]
    s_waitcnt lgkmcnt(8)
    ds_read_b64_tr_b16 a[144:145], v248 offset:20480
    ds_read_b64_tr_b16 a[146:147], v248 offset:20992
    v_lshlrev_b32 v246, 10, v246
    v_add_u32 v247, v246, v244
    v_mfma_f32_32x32x16_bf16 v[32:47], a[152:155], v[200:203], v[32:47]
    ds_read_b64_tr_b16 a[148:149], v248 offset:21504
    ds_read_b64_tr_b16 a[150:151], v248 offset:22016
    v_sub_u32 v246, v246, v244
    v_and_b32 v245, 1, v245
    v_mfma_f32_32x32x16_bf16 v[32:47], a[156:159], v[204:207], v[32:47]
    s_waitcnt lgkmcnt(8)
    ds_read_b64_tr_b16 a[152:153], v248 offset:22528
    ds_read_b64_tr_b16 a[154:155], v248 offset:23040
    v_cmp_eq_u32 vcc, 1, v245
    v_nop
    v_nop
    v_cndmask_b32 v247, v247, v246, vcc
    v_mfma_f32_32x32x16_bf16 v[32:47], a[160:163], v[208:211], v[32:47]
    ds_read_b64_tr_b16 a[156:157], v248 offset:23552
    ds_read_b64_tr_b16 a[158:159], v248 offset:24064
    v_bfe_u32 v245, v0, 3, 2
    v_lshlrev_b32 v246, 10, v245
    v_mfma_f32_32x32x16_bf16 v[32:47], a[164:167], v[212:215], v[32:47]
    s_waitcnt lgkmcnt(8)
    ds_read_b64_tr_b16 a[160:161], v248 offset:24576
    ds_read_b64_tr_b16 a[162:163], v248 offset:25088
    v_subrev_u32 v246, 0x600, v246
    v_mfma_f32_32x32x16_bf16 v[32:47], a[168:171], a[8:11], v[32:47]
    ds_read_b64_tr_b16 a[164:165], v248 offset:25600
    ds_read_b64_tr_b16 a[166:167], v248 offset:26112
    v_cmp_le_u32 vcc, 2, v245
    v_nop
    v_nop
    v_cndmask_b32 v246, v247, v246, vcc
    v_mfma_f32_32x32x16_bf16 v[32:47], a[172:175], a[12:15], v[32:47]
    s_waitcnt lgkmcnt(8)
    ds_read_b64_tr_b16 a[168:169], v248 offset:26624
    ds_read_b64_tr_b16 a[170:171], v248 offset:27136
    v_mfma_f32_32x32x16_bf16 v[32:47], a[144:147], a[16:19], v[32:47]
    ds_read_b64_tr_b16 a[172:173], v248 offset:27648
    ds_read_b64_tr_b16 a[174:175], v248 offset:28160
    v_cmp_eq_u32 vcc, 0, v244
    v_nop
    v_nop
    v_cndmask_b32 v244, v247, v246, vcc
    v_mfma_f32_32x32x16_bf16 v[32:47], a[148:151], a[20:23], v[32:47]
    s_waitcnt lgkmcnt(8)
    ds_read_b64_tr_b16 a[144:145], v248 offset:28672
    ds_read_b64_tr_b16 a[146:147], v248 offset:29184
    v_sub_u32 v245, 2048, v244
    v_and_b32 v245, 0x7ff, v245
    v_mfma_f32_32x32x16_bf16 v[32:47], a[152:155], a[24:27], v[32:47]
    s_lshl_b32 s81, s32, 6
    ds_read_b64_tr_b16 a[148:149], v248 offset:29696
    ds_read_b64_tr_b16 a[150:151], v248 offset:30208
    v_mul_u32_u24 v246, 1152, v244
    v_add_u32 v246, s81, v246
    v_mfma_f32_32x32x16_bf16 v[32:47], a[156:159], a[28:31], v[32:47]
    s_waitcnt lgkmcnt(8)
    ds_read_b64_tr_b16 a[152:153], v248 offset:30720
    ds_read_b64_tr_b16 a[154:155], v248 offset:31232
    v_lshrrev_b32 v247, 5, v0
    v_lshlrev_b32 v238, 4, v247
    v_mfma_f32_32x32x16_bf16 v[32:47], a[160:163], a[32:35], v[32:47]
    ds_read_b64_tr_b16 a[156:157], v248 offset:31744
    ds_read_b64_tr_b16 a[158:159], v248 offset:32256
    v_add_u32 v238, v246, v238
    v_lshlrev_b32 v237, 3, v247
    v_add_u32 v237, v246, v237
    v_mfma_f32_32x32x16_bf16 v[32:47], a[164:167], a[36:39], v[32:47]
    s_waitcnt lgkmcnt(8)
    s_lshl_b32 s81, s32, 7
    s_cmp_lt_u32 s32, 9
    s_cselect_b32 s24, 0, 1
    ds_read_b64_tr_b16 a[160:161], v248 offset:32768
    ds_read_b64_tr_b16 a[162:163], v248 offset:33280
    v_mfma_f32_32x32x16_bf16 v[32:47], a[168:171], a[40:43], v[32:47]
    ds_read_b64_tr_b16 a[164:165], v248 offset:33792
    ds_read_b64_tr_b16 a[166:167], v248 offset:34304
    v_mfma_f32_32x32x16_bf16 v[32:47], a[172:175], a[44:47], v[32:47]
    s_waitcnt lgkmcnt(8)
    s_sub_u32 s80, 2196, s81
    s_cmp_lt_u32 s32, 9
    s_cselect_b32 s81, s81, s80
    s_cselect_b32 s80, 1, -1
    ds_read_b64_tr_b16 a[168:169], v248 offset:34816
    ds_read_b64_tr_b16 a[170:171], v248 offset:35328
    v_mfma_f32_32x32x16_bf16 v[32:47], a[144:147], a[48:51], v[32:47]
    ds_read_b64_tr_b16 a[172:173], v248 offset:35840
    ds_read_b64_tr_b16 a[174:175], v248 offset:36352
    v_mfma_f32_32x32x16_bf16 v[32:47], a[148:151], a[52:55], v[32:47]
    s_waitcnt vmcnt(17)
    s_barrier
    s_waitcnt lgkmcnt(8)
    ds_read_b64_tr_b16 a[144:145], v232 offset:0
    ds_read_b64_tr_b16 a[146:147], v232 offset:1024
    v_mfma_f32_32x32x16_bf16 v[32:47], a[152:155], a[56:59], v[32:47]
    ds_read_b64_tr_b16 a[148:149], v232 offset:2048
    ds_read_b64_tr_b16 a[150:151], v232 offset:3072
    v_mov_b32 v246, s24
    v_cmp_eq_u32 vcc, 1, v246
    v_nop
    v_nop
    v_cndmask_b32 v244, v244, v245, vcc
    v_mfma_f32_32x32x16_bf16 v[32:47], a[156:159], a[60:63], v[32:47]
    s_waitcnt lgkmcnt(8)
    ds_read_b64_tr_b16 a[152:153], v232 offset:4096
    ds_read_b64_tr_b16 a[154:155], v232 offset:5120
    v_mov_b32 v240, 4
    v_mul_u32_u24 v244, 1280, v244
    v_mfma_f32_32x32x16_bf16 v[32:47], a[160:163], a[64:67], v[32:47]
    ds_read_b64_tr_b16 a[156:157], v232 offset:6144
    ds_read_b64_tr_b16 a[158:159], v232 offset:7168
    v_add_u32 v244, s81, v244
    v_lshlrev_b32 v247, 4, v247
    v_mul_lo_u32 v247, v247, s80
    v_mfma_f32_32x32x16_bf16 v[32:47], a[164:167], a[68:71], v[32:47]
    s_waitcnt lgkmcnt(8)
    ds_read_b64_tr_b16 a[160:161], v232 offset:8192
    ds_read_b64_tr_b16 a[162:163], v232 offset:9216
    v_add_u32 v244, v244, v247
    v_add_u32 v239, 44040192, v244
    v_mfma_f32_32x32x16_bf16 v[32:47], a[168:171], a[72:75], v[32:47]
    s_waitcnt vmcnt(0)
    s_barrier
    ds_read_b64_tr_b16 a[164:165], v232 offset:10240
    ds_read_b64_tr_b16 a[166:167], v232 offset:11264
    v_mfma_f32_32x32x16_bf16 v[32:47], a[172:175], a[76:79], v[32:47]
    s_waitcnt lgkmcnt(8)
    ds_read_b64_tr_b16 a[168:169], v232 offset:12288
    ds_read_b64_tr_b16 a[170:171], v232 offset:13312
    buffer_store_dword v240, v253, s[56:59], s1 offen sc1
    v_mfma_f32_32x32x16_bf16 v[64:79], a[144:147], v[144:147], 0
    s_lshl_b32 s82, s65, 11
    s_add_u32 s82, s82, 48234496
    ds_read_b64_tr_b16 a[172:173], v232 offset:14336
    ds_read_b64_tr_b16 a[174:175], v232 offset:15360
    v_mfma_f32_32x32x16_bf16 v[64:79], a[148:151], v[148:151], v[64:79]
    s_waitcnt lgkmcnt(8)
    s_and_b32 s29, s66, 1
    s_lshl_b32 s29, 0x5555, s29
    ds_read_b64_tr_b16 a[144:145], v232 offset:16384
    ds_read_b64_tr_b16 a[146:147], v232 offset:17408
    v_mfma_f32_32x32x16_bf16 v[64:79], a[152:155], v[152:155], v[64:79]
    ds_read_b64_tr_b16 a[148:149], v232 offset:18432
    ds_read_b64_tr_b16 a[150:151], v232 offset:19456
    v_lshlrev_b32 v242, 7, v0
    v_mov_b32 v241, 0x40000000
    v_mfma_f32_32x32x16_bf16 v[64:79], a[156:159], v[156:159], v[64:79]
    s_waitcnt lgkmcnt(8)
    ds_read_b64_tr_b16 a[152:153], v232 offset:20480
    ds_read_b64_tr_b16 a[154:155], v232 offset:21504
    v_cvt_pk_bf16_f32 v216, v32, v33
    v_cvt_pk_bf16_f32 v217, v34, v35
    v_mfma_f32_32x32x16_bf16 v[64:79], a[160:163], v[160:163], v[64:79]
    ds_read_b64_tr_b16 a[156:157], v232 offset:22528
    ds_read_b64_tr_b16 a[158:159], v232 offset:23552
    v_cmp_gt_u32 vcc, 16, v0
    v_nop
    v_nop
    v_cndmask_b32 v242, v241, v242, vcc
    v_mfma_f32_32x32x16_bf16 v[64:79], a[164:167], v[164:167], v[64:79]
    s_waitcnt lgkmcnt(8)
    ds_read_b64_tr_b16 a[160:161], v232 offset:24576
    ds_read_b64_tr_b16 a[162:163], v232 offset:25600
    v_cvt_pk_bf16_f32 v218, v36, v37
    v_cvt_pk_bf16_f32 v219, v38, v39
    v_cvt_pk_bf16_f32 v220, v40, v41
    v_mfma_f32_32x32x16_bf16 v[64:79], a[168:171], v[168:171], v[64:79]
    ds_read_b64_tr_b16 a[164:165], v232 offset:26624
    ds_read_b64_tr_b16 a[166:167], v232 offset:27648
    buffer_load_dwordx2 v[24:25], v237, s[40:43], 0 offen offset:0
    v_cvt_pk_bf16_f32 v221, v42, v43
    v_cvt_pk_bf16_f32 v222, v44, v45
    v_mfma_f32_32x32x16_bf16 v[64:79], a[172:175], v[172:175], v[64:79]
    s_waitcnt lgkmcnt(8)
    ds_read_b64_tr_b16 a[168:169], v232 offset:28672
    ds_read_b64_tr_b16 a[170:171], v232 offset:29696
    buffer_load_dwordx2 v[26:27], v237, s[40:43], 0 offen offset:16
    v_cvt_pk_bf16_f32 v223, v46, v47
    v_mfma_f32_32x32x16_bf16 v[64:79], a[144:147], v[176:179], v[64:79]
    s_mov_b32 s34, s31
    ds_read_b64_tr_b16 a[172:173], v232 offset:30720
    ds_read_b64_tr_b16 a[174:175], v232 offset:31744
    buffer_load_dwordx2 v[28:29], v237, s[40:43], 0 offen offset:32
    v_mfma_f32_32x32x16_bf16 v[64:79], a[148:151], v[180:183], v[64:79]
    s_waitcnt lgkmcnt(8)
    ds_read_b64_tr_b16 a[144:145], v232 offset:32768
    ds_read_b64_tr_b16 a[146:147], v232 offset:33792
    buffer_load_dwordx2 v[30:31], v237, s[40:43], 0 offen offset:48
    v_mfma_f32_32x32x16_bf16 v[64:79], a[152:155], v[184:187], v[64:79]
    ds_read_b64_tr_b16 a[148:149], v232 offset:34816
    ds_read_b64_tr_b16 a[150:151], v232 offset:35840
    buffer_store_dwordx4 v[216:219], v1, s[56:59], s34 offen sc1
    v_mfma_f32_32x32x16_bf16 v[64:79], a[156:159], v[188:191], v[64:79]
    s_barrier
    s_waitcnt lgkmcnt(8)
    ds_read_b64_tr_b16 a[152:153], v233 offset:0
    ds_read_b64_tr_b16 a[154:155], v233 offset:1024
    v_mfma_f32_32x32x16_bf16 v[64:79], a[160:163], v[192:195], v[64:79]
    ds_read_b64_tr_b16 a[156:157], v233 offset:2048
    ds_read_b64_tr_b16 a[158:159], v233 offset:3072
    buffer_store_dwordx4 v[220:223], v1, s[56:59], s34 offen offset:1024 sc1
    v_mfma_f32_32x32x16_bf16 v[64:79], a[164:167], v[196:199], v[64:79]
    s_waitcnt lgkmcnt(8)
    ds_read_b64_tr_b16 a[160:161], v233 offset:4096
    ds_read_b64_tr_b16 a[162:163], v233 offset:5120
    v_mfma_f32_32x32x16_bf16 v[64:79], a[168:171], v[200:203], v[64:79]
    ds_read_b64_tr_b16 a[164:165], v233 offset:6144
    ds_read_b64_tr_b16 a[166:167], v233 offset:7168
    v_mfma_f32_32x32x16_bf16 v[64:79], a[172:175], v[204:207], v[64:79]
    s_waitcnt lgkmcnt(8)
    ds_read_b64_tr_b16 a[168:169], v233 offset:8192
    ds_read_b64_tr_b16 a[170:171], v233 offset:9216
    v_mfma_f32_32x32x16_bf16 v[64:79], a[144:147], v[208:211], v[64:79]
    ds_read_b64_tr_b16 a[172:173], v233 offset:10240
    ds_read_b64_tr_b16 a[174:175], v233 offset:11264
    v_mfma_f32_32x32x16_bf16 v[64:79], a[148:151], v[212:215], v[64:79]
    s_waitcnt lgkmcnt(8)
    ds_read_b64_tr_b16 a[144:145], v233 offset:12288
    ds_read_b64_tr_b16 a[146:147], v233 offset:13312
    v_mfma_f32_32x32x16_bf16 v[64:79], a[152:155], a[8:11], v[64:79]
    ds_read_b64_tr_b16 a[148:149], v233 offset:14336
    ds_read_b64_tr_b16 a[150:151], v233 offset:15360
    v_mfma_f32_32x32x16_bf16 v[64:79], a[156:159], a[12:15], v[64:79]
    s_waitcnt lgkmcnt(8)
    ds_read_b64_tr_b16 a[152:153], v233 offset:16384
    ds_read_b64_tr_b16 a[154:155], v233 offset:17408
    v_mfma_f32_32x32x16_bf16 v[64:79], a[160:163], a[16:19], v[64:79]
    ds_read_b64_tr_b16 a[156:157], v233 offset:18432
    ds_read_b64_tr_b16 a[158:159], v233 offset:19456
    v_mfma_f32_32x32x16_bf16 v[64:79], a[164:167], a[20:23], v[64:79]
    s_waitcnt lgkmcnt(8)
    ds_read_b64_tr_b16 a[160:161], v233 offset:20480
    ds_read_b64_tr_b16 a[162:163], v233 offset:21504
    v_mfma_f32_32x32x16_bf16 v[64:79], a[168:171], a[24:27], v[64:79]
    ds_read_b64_tr_b16 a[164:165], v233 offset:22528
    ds_read_b64_tr_b16 a[166:167], v233 offset:23552
    v_mfma_f32_32x32x16_bf16 v[64:79], a[172:175], a[28:31], v[64:79]
    s_waitcnt lgkmcnt(8)
    ds_read_b64_tr_b16 a[168:169], v233 offset:24576
    ds_read_b64_tr_b16 a[170:171], v233 offset:25600
    v_mfma_f32_32x32x16_bf16 v[64:79], a[144:147], a[32:35], v[64:79]
    ds_read_b64_tr_b16 a[172:173], v233 offset:26624
    ds_read_b64_tr_b16 a[174:175], v233 offset:27648
    v_mfma_f32_32x32x16_bf16 v[64:79], a[148:151], a[36:39], v[64:79]
    s_waitcnt lgkmcnt(8)
    ds_read_b64_tr_b16 a[144:145], v233 offset:28672
    ds_read_b64_tr_b16 a[146:147], v233 offset:29696
    v_mfma_f32_32x32x16_bf16 v[64:79], a[152:155], a[40:43], v[64:79]
    ds_read_b64_tr_b16 a[148:149], v233 offset:30720
    ds_read_b64_tr_b16 a[150:151], v233 offset:31744
    v_mfma_f32_32x32x16_bf16 v[64:79], a[156:159], a[44:47], v[64:79]
    s_waitcnt lgkmcnt(8)
    ds_read_b64_tr_b16 a[152:153], v233 offset:32768
    ds_read_b64_tr_b16 a[154:155], v233 offset:33792
    v_mfma_f32_32x32x16_bf16 v[64:79], a[160:163], a[48:51], v[64:79]
    ds_read_b64_tr_b16 a[156:157], v233 offset:34816
    ds_read_b64_tr_b16 a[158:159], v233 offset:35840
    v_mfma_f32_32x32x16_bf16 v[64:79], a[164:167], a[52:55], v[64:79]
    s_waitcnt lgkmcnt(8)
    ds_read_b64_tr_b16 a[160:161], v234 offset:0
    ds_read_b64_tr_b16 a[162:163], v234 offset:1024
    v_mfma_f32_32x32x16_bf16 v[64:79], a[168:171], a[56:59], v[64:79]
    ds_read_b64_tr_b16 a[164:165], v234 offset:2048
    ds_read_b64_tr_b16 a[166:167], v234 offset:3072
    v_mfma_f32_32x32x16_bf16 v[64:79], a[172:175], a[60:63], v[64:79]
    s_waitcnt lgkmcnt(8)
    ds_read_b64_tr_b16 a[168:169], v234 offset:4096
    ds_read_b64_tr_b16 a[170:171], v234 offset:5120
    v_mfma_f32_32x32x16_bf16 v[64:79], a[144:147], a[64:67], v[64:79]
    ds_read_b64_tr_b16 a[172:173], v234 offset:6144
    ds_read_b64_tr_b16 a[174:175], v234 offset:7168
    v_mfma_f32_32x32x16_bf16 v[64:79], a[148:151], a[68:71], v[64:79]
    s_waitcnt lgkmcnt(8)
    ds_read_b64_tr_b16 a[144:145], v234 offset:8192
    ds_read_b64_tr_b16 a[146:147], v234 offset:9216
    v_mfma_f32_32x32x16_bf16 v[64:79], a[152:155], a[72:75], v[64:79]
    ds_read_b64_tr_b16 a[148:149], v234 offset:10240
    ds_read_b64_tr_b16 a[150:151], v234 offset:11264
    v_mfma_f32_32x32x16_bf16 v[64:79], a[156:159], a[76:79], v[64:79]
    s_waitcnt lgkmcnt(8)
    ds_read_b64_tr_b16 a[152:153], v234 offset:12288
    ds_read_b64_tr_b16 a[154:155], v234 offset:13312
    v_mfma_f32_32x32x16_bf16 v[128:143], a[160:163], v[144:147], 0
    ds_read_b64_tr_b16 a[156:157], v234 offset:14336
    ds_read_b64_tr_b16 a[158:159], v234 offset:15360
    v_mfma_f32_32x32x16_bf16 v[128:143], a[164:167], v[148:151], v[128:143]
    s_waitcnt lgkmcnt(8)
    ds_read_b64_tr_b16 a[160:161], v234 offset:16384
    ds_read_b64_tr_b16 a[162:163], v234 offset:17408
    v_mfma_f32_32x32x16_bf16 v[128:143], a[168:171], v[152:155], v[128:143]
    ds_read_b64_tr_b16 a[164:165], v234 offset:18432
    ds_read_b64_tr_b16 a[166:167], v234 offset:19456
    v_mfma_f32_32x32x16_bf16 v[128:143], a[172:175], v[156:159], v[128:143]
    s_waitcnt lgkmcnt(8)
    ds_read_b64_tr_b16 a[168:169], v234 offset:20480
    ds_read_b64_tr_b16 a[170:171], v234 offset:21504
    v_cvt_pk_bf16_f32 v216, v64, v65
    v_cvt_pk_bf16_f32 v217, v66, v67
    v_mfma_f32_32x32x16_bf16 v[128:143], a[144:147], v[160:163], v[128:143]
    ds_read_b64_tr_b16 a[172:173], v234 offset:22528
    ds_read_b64_tr_b16 a[174:175], v234 offset:23552
    v_cvt_pk_bf16_f32 v218, v68, v69
    v_cvt_pk_bf16_f32 v219, v70, v71
    v_mfma_f32_32x32x16_bf16 v[128:143], a[148:151], v[164:167], v[128:143]
    s_waitcnt lgkmcnt(8)
    ds_read_b64_tr_b16 a[144:145], v234 offset:24576
    ds_read_b64_tr_b16 a[146:147], v234 offset:25600
    v_cvt_pk_bf16_f32 v220, v72, v73
    v_cvt_pk_bf16_f32 v221, v74, v75
    v_mfma_f32_32x32x16_bf16 v[128:143], a[152:155], v[168:171], v[128:143]
    ds_read_b64_tr_b16 a[148:149], v234 offset:26624
    ds_read_b64_tr_b16 a[150:151], v234 offset:27648
    v_cvt_pk_bf16_f32 v222, v76, v77
    v_cvt_pk_bf16_f32 v223, v78, v79
    v_mfma_f32_32x32x16_bf16 v[128:143], a[156:159], v[172:175], v[128:143]
    s_waitcnt lgkmcnt(8)
    s_mov_b32 s34, s39
    ds_read_b64_tr_b16 a[152:153], v234 offset:28672
    ds_read_b64_tr_b16 a[154:155], v234 offset:29696
    v_mfma_f32_32x32x16_bf16 v[128:143], a[160:163], v[176:179], v[128:143]
    ds_read_b64_tr_b16 a[156:157], v234 offset:30720
    ds_read_b64_tr_b16 a[158:159], v234 offset:31744
    buffer_store_dwordx4 v[216:219], v1, s[56:59], s34 offen sc1
    v_mfma_f32_32x32x16_bf16 v[128:143], a[164:167], v[180:183], v[128:143]
    s_waitcnt lgkmcnt(8)
    ds_read_b64_tr_b16 a[160:161], v234 offset:32768
    ds_read_b64_tr_b16 a[162:163], v234 offset:33792
    v_mfma_f32_32x32x16_bf16 v[128:143], a[168:171], v[184:187], v[128:143]
    ds_read_b64_tr_b16 a[164:165], v234 offset:34816
    ds_read_b64_tr_b16 a[166:167], v234 offset:35840
    v_mfma_f32_32x32x16_bf16 v[128:143], a[172:175], v[188:191], v[128:143]
    s_waitcnt lgkmcnt(8)
    ds_read_b64_tr_b16 a[168:169], v235 offset:0
    ds_read_b64_tr_b16 a[170:171], v235 offset:1024
    buffer_store_dwordx4 v[220:223], v1, s[56:59], s34 offen offset:1024 sc1
    v_mfma_f32_32x32x16_bf16 v[128:143], a[144:147], v[192:195], v[128:143]
    ds_read_b64_tr_b16 a[172:173], v235 offset:2048
    ds_read_b64_tr_b16 a[174:175], v235 offset:3072
    buffer_load_dword v241, v242, s[56:59], s82 offen sc1
    v_mfma_f32_32x32x16_bf16 v[128:143], a[148:151], v[196:199], v[128:143]
    s_waitcnt lgkmcnt(8)
    ds_read_b64_tr_b16 a[144:145], v235 offset:4096
    ds_read_b64_tr_b16 a[146:147], v235 offset:5120
    v_mfma_f32_32x32x16_bf16 v[128:143], a[152:155], v[200:203], v[128:143]
    ds_read_b64_tr_b16 a[148:149], v235 offset:6144
    ds_read_b64_tr_b16 a[150:151], v235 offset:7168
    v_mfma_f32_32x32x16_bf16 v[128:143], a[156:159], v[204:207], v[128:143]
    s_waitcnt lgkmcnt(8)
    ds_read_b64_tr_b16 a[152:153], v235 offset:8192
    ds_read_b64_tr_b16 a[154:155], v235 offset:9216
    v_mfma_f32_32x32x16_bf16 v[128:143], a[160:163], v[208:211], v[128:143]
    ds_read_b64_tr_b16 a[156:157], v235 offset:10240
    ds_read_b64_tr_b16 a[158:159], v235 offset:11264
    v_mfma_f32_32x32x16_bf16 v[128:143], a[164:167], v[212:215], v[128:143]
    s_waitcnt lgkmcnt(8)
    ds_read_b64_tr_b16 a[160:161], v235 offset:12288
    ds_read_b64_tr_b16 a[162:163], v235 offset:13312
    v_mfma_f32_32x32x16_bf16 v[128:143], a[168:171], a[8:11], v[128:143]
    ds_read_b64_tr_b16 a[164:165], v235 offset:14336
    ds_read_b64_tr_b16 a[166:167], v235 offset:15360
    v_mfma_f32_32x32x16_bf16 v[128:143], a[172:175], a[12:15], v[128:143]
    s_waitcnt lgkmcnt(8)
    s_lshr_b32 s81, s66, 1
    s_and_b32 s78, s66, 1
    s_add_u32 s78, s78, 8
    s_and_b32 s79, s81, 1
    s_bfe_u32 s80, s81, 0x20001
    s_lshl_b32 s81, s65, 2
    ds_read_b64_tr_b16 a[168:169], v235 offset:16384
    ds_read_b64_tr_b16 a[170:171], v235 offset:17408
    v_mfma_f32_32x32x16_bf16 v[128:143], a[144:147], a[16:19], v[128:143]
    s_add_u32 s80, s80, s81
    s_mul_i32 s81, s80, 18
    s_add_u32 s81, s81, s78
    s_lshl_b32 s81, s81, 1
    s_add_u32 s81, s81, s79
    s_lshl_b32 s81, s81, 10
    s_add_u32 s84, s81, 0
    ds_read_b64_tr_b16 a[172:173], v235 offset:18432
    ds_read_b64_tr_b16 a[174:175], v235 offset:19456
    v_mfma_f32_32x32x16_bf16 v[128:143], a[148:151], a[20:23], v[128:143]
    s_waitcnt lgkmcnt(8)
    s_waitcnt vmcnt(0)
    s_add_u32 s85, s81, 2359296
    s_add_u32 s86, s81, 4718592
    s_add_u32 s87, s81, 7077888
    s_add_u32 s88, s81, 9437184
    ds_read_b64_tr_b16 a[144:145], v235 offset:20480
    ds_read_b64_tr_b16 a[146:147], v235 offset:21504
    v_mfma_f32_32x32x16_bf16 v[128:143], a[152:155], a[24:27], v[128:143]
    s_add_u32 s89, s81, 11796480
    s_add_u32 s90, s81, 14155776
    s_add_u32 s91, s81, 16515072
    ds_read_b64_tr_b16 a[148:149], v235 offset:22528
    ds_read_b64_tr_b16 a[150:151], v235 offset:23552
    v_bfe_u32 v222, v0, 3, 2
    v_mov_b32 v223, 0x40000000
    v_mov_b32 v225, 0
    v_cmp_le_u32 vcc, 4, v241
    s_nop 0
    s_and_b32 s83, vcc_lo, 0xffff
    s_cmp_eq_u32 s83, 0xffff
    s_cbranch_scc1 L_gA_ok
    s_mov_b32 s93, 0
L_gA:
    buffer_load_dword v241, v242, s[56:59], s82 offen sc1
    s_waitcnt vmcnt(0)
    v_cmp_le_u32 vcc, 4, v241
    s_nop 0
    s_and_b32 s83, vcc_lo, 0xffff
    s_cmp_eq_u32 s83, 0xffff
    s_cbranch_scc1 L_gA_ok
    s_add_u32 s93, s93, 1
    s_cmp_gt_u32 s93, 0x40000
    s_cbranch_scc1 L_gA_ok
    s_sleep 1
    s_branch L_gA
L_gA_ok:
    v_mfma_f32_32x32x16_bf16 v[128:143], a[156:159], a[28:31], v[128:143]
    s_waitcnt lgkmcnt(8)
    ds_read_b64_tr_b16 a[152:153], v235 offset:24576
    ds_read_b64_tr_b16 a[154:155], v235 offset:25600
    buffer_load_dwordx4 v[80:83], v1, s[56:59], s16 offen sc1
    v_cmp_eq_u32 vcc, s64, v222
    v_nop
    v_nop
    v_cndmask_b32 v225, v223, v225, vcc
    v_add_u32 v221, v225, v1
    v_mfma_f32_32x32x16_bf16 v[128:143], a[160:163], a[32:35], v[128:143]
    s_lshl_b32 s81, s80, 3
    ds_read_b64_tr_b16 a[156:157], v235 offset:26624
    ds_read_b64_tr_b16 a[158:159], v235 offset:27648
    buffer_load_dwordx4 v[84:87], v1, s[56:59], s16 offen offset:1024 sc1
    v_and_b32 v222, 7, v0
    v_add_u32 v222, s81, v222
    v_bfe_u32 v223, v0, 3, 2
    v_add_u32 v224, 1, v223
    v_lshrrev_b32 v224, 1, v224
    v_mfma_f32_32x32x16_bf16 v[128:143], a[164:167], a[36:39], v[128:143]
    s_waitcnt lgkmcnt(8)
    ds_read_b64_tr_b16 a[160:161], v235 offset:28672
    ds_read_b64_tr_b16 a[162:163], v235 offset:29696
    buffer_load_dwordx4 v[88:91], v1, s[56:59], s17 offen sc1
    v_lshlrev_b32 v224, 10, v224
    v_add_u32 v220, v224, v222
    v_sub_u32 v224, v224, v222
    v_and_b32 v223, 1, v223
    v_mfma_f32_32x32x16_bf16 v[128:143], a[168:171], a[40:43], v[128:143]
    ds_read_b64_tr_b16 a[164:165], v235 offset:30720
    ds_read_b64_tr_b16 a[166:167], v235 offset:31744
    buffer_load_dwordx4 v[92:95], v1, s[56:59], s17 offen offset:1024 sc1
    v_cmp_eq_u32 vcc, 1, v223
    v_nop
    v_nop
    v_cndmask_b32 v220, v220, v224, vcc
    v_bfe_u32 v223, v0, 3, 2
    v_lshlrev_b32 v224, 10, v223
    v_mfma_f32_32x32x16_bf16 v[128:143], a[172:175], a[44:47], v[128:143]
    s_waitcnt lgkmcnt(8)
    ds_read_b64_tr_b16 a[168:169], v235 offset:32768
    ds_read_b64_tr_b16 a[170:171], v235 offset:33792
    buffer_load_dwordx4 v[96:99], v1, s[56:59], s18 offen sc1
    v_subrev_u32 v224, 0x600, v224
    v_cmp_le_u32 vcc, 2, v223
    v_nop
    v_nop
    v_cndmask_b32 v224, v220, v224, vcc
    v_mfma_f32_32x32x16_bf16 v[128:143], a[144:147], a[48:51], v[128:143]
    ds_read_b64_tr_b16 a[172:173], v235 offset:34816
    ds_read_b64_tr_b16 a[174:175], v235 offset:35840
    buffer_load_dwordx4 v[100:103], v1, s[56:59], s18 offen offset:1024 sc1
    v_cmp_eq_u32 vcc, 0, v222
    v_nop
    v_nop
    v_cndmask_b32 v222, v220, v224, vcc
    v_sub_u32 v223, 2048, v222
    v_and_b32 v223, 0x7ff, v223
    v_mfma_f32_32x32x16_bf16 v[128:143], a[148:151], a[52:55], v[128:143]
    s_waitcnt lgkmcnt(8)
    s_lshl_b32 s81, s78, 6
    s_lshl_b32 s80, s79, 5
    s_add_u32 s81, s81, s80
    buffer_load_dwordx4 v[104:107], v1, s[56:59], s19 offen sc1
    v_mov_b32 v240, 5
    v_mul_u32_u24 v224, 1152, v222
    v_add_u32 v224, s81, v224
    v_add_u32 v224, v224, v225
    v_mfma_f32_32x32x16_bf16 v[128:143], a[152:155], a[56:59], v[128:143]
    buffer_load_dwordx4 v[108:111], v1, s[56:59], s19 offen offset:1024 sc1
    v_lshrrev_b32 v208, 5, v0
    v_lshlrev_b32 v220, 4, v208
    v_add_u32 v220, v224, v220
    v_lshlrev_b32 v208, 3, v208
    v_add_u32 v224, v224, v208
    v_mfma_f32_32x32x16_bf16 v[128:143], a[156:159], a[60:63], v[128:143]
    s_waitcnt lgkmcnt(4)
    buffer_load_dwordx4 v[112:115], v1, s[56:59], s20 offen sc1
    buffer_load_dwordx2 v[208:209], v224, s[40:43], 0 offen
    buffer_load_dwordx2 v[210:211], v224, s[40:43], 0 offen offset:16
    v_mfma_f32_32x32x16_bf16 v[128:143], a[160:163], a[64:67], v[128:143]
    s_barrier
    s_lshl_b32 s81, s81, 1
    s_cmp_lt_u32 s78, 9
    s_cselect_b32 s26, 0, 1
    buffer_load_dwordx4 v[116:119], v1, s[56:59], s20 offen offset:1024 sc1
    v_mfma_f32_32x32x16_bf16 v[128:143], a[164:167], a[68:71], v[128:143]
    s_waitcnt lgkmcnt(0)
    s_sub_u32 s80, 2292, s81
    s_cmp_lt_u32 s78, 9
    s_cselect_b32 s81, s81, s80
    s_cselect_b32 s80, 1, -1
    buffer_load_dwordx4 v[120:123], v1, s[56:59], s21 offen sc1
    buffer_store_dword v240, v253, s[56:59], s1 offen sc1
    v_mfma_f32_32x32x16_bf16 v[128:143], a[168:171], a[72:75], v[128:143]
    buffer_load_dwordx4 v[124:127], v1, s[56:59], s21 offen offset:1024 sc1
    v_mov_b32 v224, s26
    v_cmp_eq_u32 vcc, 1, v224
    v_nop
    v_nop
    v_cndmask_b32 v222, v222, v223, vcc
    v_mul_u32_u24 v222, 1280, v222
    v_add_u32 v222, s81, v222
    v_add_u32 v222, v222, v225
    v_lshrrev_b32 v223, 5, v0
    v_lshlrev_b32 v223, 4, v223
    v_mul_lo_u32 v223, v223, s80
    v_add_u32 v222, v222, v223
    v_mfma_f32_32x32x16_bf16 v[128:143], a[172:175], a[76:79], v[128:143]
    s_lshl_b32 s80, s80, 5
    v_add_u32 v223, s80, v222
    v_add_u32 v222, 44040192, v222
    v_add_u32 v223, 44040192, v223
    buffer_load_dwordx4 v[48:51], v239, s[56:59], 0 offen offset:0 sc1
    buffer_load_dwordx4 v[52:55], v239, s[56:59], 0 offen offset:32 sc1
    buffer_load_dwordx4 v[56:59], v239, s[56:59], 0 offen offset:64 sc1
    buffer_load_dwordx4 v[60:63], v239, s[56:59], 0 offen offset:96 sc1
    buffer_load_dword v241, v242, s[56:59], s82 offen sc1
    s_nop 7
    s_nop 3
    s_waitcnt vmcnt(1)
    s_mov_b32 s76, 0x3f80
    s_mov_b32 s77, 0x3f800000
    s_cmp_eq_u32 s24, 0
    s_cbranch_scc1 L_oyd
    v_add_f32 v128, v128, v63
    v_add_f32 v129, v129, v62
    v_add_f32 v130, v130, v61
    v_add_f32 v131, v131, v60
    v_add_f32 v132, v132, v59
    v_add_f32 v133, v133, v58
    v_add_f32 v134, v134, v57
    v_add_f32 v135, v135, v56
    v_add_f32 v136, v136, v55
    v_add_f32 v137, v137, v54
    v_add_f32 v138, v138, v53
    v_add_f32 v139, v139, v52
    v_add_f32 v140, v140, v51
    v_add_f32 v141, v141, v50
    v_add_f32 v142, v142, v49
    v_add_f32 v143, v143, v48
    s_branch L_oyj
L_oyd:
    v_add_f32 v128, v128, v48
    v_add_f32 v129, v129, v49
    v_add_f32 v130, v130, v50
    v_add_f32 v131, v131, v51
    v_add_f32 v132, v132, v52
    v_add_f32 v133, v133, v53
    v_add_f32 v134, v134, v54
    v_add_f32 v135, v135, v55
    v_add_f32 v136, v136, v56
    v_add_f32 v137, v137, v57
    v_add_f32 v138, v138, v58
    v_add_f32 v139, v139, v59
    v_add_f32 v140, v140, v60
    v_add_f32 v141, v141, v61
    v_add_f32 v142, v142, v62
    v_add_f32 v143, v143, v63
L_oyj:
    v_dot2_f32_bf16 v128, v24, s76, v128
    v_dot2_f32_bf16 v129, v24, s77, v129
    v_dot2_f32_bf16 v130, v25, s76, v130
    v_dot2_f32_bf16 v131, v25, s77, v131
    v_dot2_f32_bf16 v132, v26, s76, v132
    v_dot2_f32_bf16 v133, v26, s77, v133
    v_dot2_f32_bf16 v134, v27, s76, v134
    v_dot2_f32_bf16 v135, v27, s77, v135
    v_dot2_f32_bf16 v136, v28, s76, v136
    v_dot2_f32_bf16 v137, v28, s77, v137
    v_dot2_f32_bf16 v138, v29, s76, v138
    v_dot2_f32_bf16 v139, v29, s77, v139
    v_dot2_f32_bf16 v140, v30, s76, v140
    v_dot2_f32_bf16 v141, v30, s77, v141
    v_dot2_f32_bf16 v142, v31, s76, v142
    v_dot2_f32_bf16 v143, v31, s77, v143
    v_dot2_f32_bf16 v128, v80, s76, v128
    v_dot2_f32_bf16 v129, v80, s77, v129
    v_dot2_f32_bf16 v130, v81, s76, v130
    v_dot2_f32_bf16 v131, v81, s77, v131
    v_dot2_f32_bf16 v132, v82, s76, v132
    v_dot2_f32_bf16 v133, v82, s77, v133
    v_dot2_f32_bf16 v134, v83, s76, v134
    v_dot2_f32_bf16 v135, v83, s77, v135
    v_dot2_f32_bf16 v136, v84, s76, v136
    v_dot2_f32_bf16 v137, v84, s77, v137
    v_dot2_f32_bf16 v138, v85, s76, v138
    v_dot2_f32_bf16 v139, v85, s77, v139
    v_dot2_f32_bf16 v140, v86, s76, v140
    v_dot2_f32_bf16 v141, v86, s77, v141
    v_dot2_f32_bf16 v142, v87, s76, v142
    v_dot2_f32_bf16 v143, v87, s77, v143
    v_dot2_f32_bf16 v128, v88, s76, v128
    v_dot2_f32_bf16 v129, v88, s77, v129
    v_dot2_f32_bf16 v130, v89, s76, v130
    v_dot2_f32_bf16 v131, v89, s77, v131
    v_dot2_f32_bf16 v132, v90, s76, v132
    v_dot2_f32_bf16 v133, v90, s77, v133
    v_dot2_f32_bf16 v134, v91, s76, v134
    v_dot2_f32_bf16 v135, v91, s77, v135
    v_dot2_f32_bf16 v136, v92, s76, v136
    v_dot2_f32_bf16 v137, v92, s77, v137
    v_dot2_f32_bf16 v138, v93, s76, v138
    v_dot2_f32_bf16 v139, v93, s77, v139
    v_dot2_f32_bf16 v140, v94, s76, v140
    v_dot2_f32_bf16 v141, v94, s77, v141
    v_dot2_f32_bf16 v142, v95, s76, v142
    v_dot2_f32_bf16 v143, v95, s77, v143
    v_dot2_f32_bf16 v128, v96, s76, v128
    v_dot2_f32_bf16 v129, v96, s77, v129
    v_dot2_f32_bf16 v130, v97, s76, v130
    v_dot2_f32_bf16 v131, v97, s77, v131
    v_dot2_f32_bf16 v132, v98, s76, v132
    v_dot2_f32_bf16 v133, v98, s77, v133
    v_dot2_f32_bf16 v134, v99, s76, v134
    v_dot2_f32_bf16 v135, v99, s77, v135
    v_dot2_f32_bf16 v136, v100, s76, v136
    v_dot2_f32_bf16 v137, v100, s77, v137
    v_dot2_f32_bf16 v138, v101, s76, v138
    v_dot2_f32_bf16 v139, v101, s77, v139
    v_dot2_f32_bf16 v140, v102, s76, v140
    v_dot2_f32_bf16 v141, v102, s77, v141
    v_dot2_f32_bf16 v142, v103, s76, v142
    v_dot2_f32_bf16 v143, v103, s77, v143
    v_dot2_f32_bf16 v128, v104, s76, v128
    v_dot2_f32_bf16 v129, v104, s77, v129
    v_dot2_f32_bf16 v130, v105, s76, v130
    v_dot2_f32_bf16 v131, v105, s77, v131
    v_dot2_f32_bf16 v132, v106, s76, v132
    v_dot2_f32_bf16 v133, v106, s77, v133
    v_dot2_f32_bf16 v134, v107, s76, v134
    v_dot2_f32_bf16 v135, v107, s77, v135
    v_dot2_f32_bf16 v136, v108, s76, v136
    v_dot2_f32_bf16 v137, v108, s77, v137
    v_dot2_f32_bf16 v138, v109, s76, v138
    v_dot2_f32_bf16 v139, v109, s77, v139
    v_dot2_f32_bf16 v140, v110, s76, v140
    v_dot2_f32_bf16 v141, v110, s77, v141
    v_dot2_f32_bf16 v142, v111, s76, v142
    v_dot2_f32_bf16 v143, v111, s77, v143
    v_dot2_f32_bf16 v128, v112, s76, v128
    v_dot2_f32_bf16 v129, v112, s77, v129
    v_dot2_f32_bf16 v130, v113, s76, v130
    v_dot2_f32_bf16 v131, v113, s77, v131
    v_dot2_f32_bf16 v132, v114, s76, v132
    v_dot2_f32_bf16 v133, v114, s77, v133
    v_dot2_f32_bf16 v134, v115, s76, v134
    v_dot2_f32_bf16 v135, v115, s77, v135
    v_dot2_f32_bf16 v136, v116, s76, v136
    v_dot2_f32_bf16 v137, v116, s77, v137
    v_dot2_f32_bf16 v138, v117, s76, v138
    v_dot2_f32_bf16 v139, v117, s77, v139
    v_dot2_f32_bf16 v140, v118, s76, v140
    v_dot2_f32_bf16 v141, v118, s77, v141
    v_dot2_f32_bf16 v142, v119, s76, v142
    v_dot2_f32_bf16 v143, v119, s77, v143
    v_dot2_f32_bf16 v128, v120, s76, v128
    v_dot2_f32_bf16 v129, v120, s77, v129
    v_dot2_f32_bf16 v130, v121, s76, v130
    v_dot2_f32_bf16 v131, v121, s77, v131
    v_dot2_f32_bf16 v132, v122, s76, v132
    v_dot2_f32_bf16 v133, v122, s77, v133
    v_dot2_f32_bf16 v134, v123, s76, v134
    v_dot2_f32_bf16 v135, v123, s77, v135
    v_dot2_f32_bf16 v136, v124, s76, v136
    v_dot2_f32_bf16 v137, v124, s77, v137
    v_dot2_f32_bf16 v138, v125, s76, v138
    v_dot2_f32_bf16 v139, v125, s77, v139
    v_dot2_f32_bf16 v140, v126, s76, v140
    v_dot2_f32_bf16 v141, v126, s77, v141
    v_dot2_f32_bf16 v142, v127, s76, v142
    v_dot2_f32_bf16 v143, v127, s77, v143
    s_waitcnt vmcnt(0)
    v_cmp_le_u32 vcc, 5, v241
    s_nop 0
    s_and_b32 s83, vcc_lo, s29
    s_cmp_eq_u32 s83, s29
    s_cbranch_scc1 L_f5_ok
    s_mov_b32 s93, 0
L_f5:
    buffer_load_dword v241, v242, s[56:59], s82 offen sc1
    s_waitcnt vmcnt(0)
    v_cmp_le_u32 vcc, 5, v241
    s_nop 0
    s_and_b32 s83, vcc_lo, s29
    s_cmp_eq_u32 s83, s29
    s_cbranch_scc1 L_f5_ok
    s_add_u32 s93, s93, 1
    s_cmp_gt_u32 s93, 0x40000
    s_cbranch_scc1 L_f5_ok
    s_sleep 1
    s_branch L_f5
L_f5_ok:
    buffer_load_dwordx4 v[16:19], v1, s[56:59], s22 offen sc1
    buffer_load_dwordx4 v[20:23], v1, s[56:59], s22 offen offset:1024 sc1
    buffer_load_dwordx4 v[176:179], v221, s[56:59], s84 offen sc1
    buffer_load_dwordx4 v[180:183], v221, s[56:59], s85 offen sc1
    buffer_load_dwordx4 v[184:187], v221, s[56:59], s86 offen sc1
    buffer_load_dwordx4 v[188:191], v221, s[56:59], s87 offen sc1
    buffer_load_dwordx4 v[192:195], v221, s[56:59], s88 offen sc1
    buffer_load_dwordx4 v[196:199], v221, s[56:59], s89 offen sc1
    buffer_load_dwordx4 v[200:203], v221, s[56:59], s90 offen sc1
    buffer_load_dwordx4 v[204:207], v221, s[56:59], s91 offen sc1
    buffer_load_dwordx4 v[212:215], v222, s[56:59], 0 offen sc1
    buffer_load_dwordx4 v[216:219], v223, s[56:59], 0 offen sc1
    s_waitcnt vmcnt(10)
    v_dot2_f32_bf16 v128, v16, s76, v128
    v_dot2_f32_bf16 v129, v16, s77, v129
    v_dot2_f32_bf16 v130, v17, s76, v130
    v_dot2_f32_bf16 v131, v17, s77, v131
    v_dot2_f32_bf16 v132, v18, s76, v132
    v_dot2_f32_bf16 v133, v18, s77, v133
    v_dot2_f32_bf16 v134, v19, s76, v134
    v_dot2_f32_bf16 v135, v19, s77, v135
    v_dot2_f32_bf16 v136, v20, s76, v136
    v_dot2_f32_bf16 v137, v20, s77, v137
    v_dot2_f32_bf16 v138, v21, s76, v138
    v_dot2_f32_bf16 v139, v21, s77, v139
    v_dot2_f32_bf16 v140, v22, s76, v140
    v_dot2_f32_bf16 v141, v22, s77, v141
    v_dot2_f32_bf16 v142, v23, s76, v142
    v_dot2_f32_bf16 v143, v23, s77, v143
    s_nop 2
    v_cvt_pk_bf16_f32 v24, v128, v129
    v_cvt_pk_bf16_f32 v25, v130, v131
    v_cvt_pk_bf16_f32 v26, v132, v133
    v_cvt_pk_bf16_f32 v27, v134, v135
    v_cvt_pk_bf16_f32 v28, v136, v137
    v_cvt_pk_bf16_f32 v29, v138, v139
    v_cvt_pk_bf16_f32 v30, v140, v141
    v_cvt_pk_bf16_f32 v31, v142, v143
    s_nop 1
    v_permlane32_swap_b32 v24, v26
    v_permlane32_swap_b32 v25, v27
    v_permlane32_swap_b32 v28, v30
    v_permlane32_swap_b32 v29, v31
    buffer_store_dwordx4 v[24:27], v238, s[60:63], 0 offen
    buffer_store_dwordx4 v[28:31], v238, s[60:63], 0 offen offset:32
    s_waitcnt vmcnt(2)
    s_cmp_eq_u32 s26, 0
    s_cbranch_scc1 L_rvD
    v_swap_b32 v212, v215
    v_swap_b32 v213, v214
    v_swap_b32 v216, v219
    v_swap_b32 v217, v218
L_rvD:
    s_mov_b32 s76, 0x3f80
    s_mov_b32 s77, 0x3f800000
    v_dot2_f32_bf16 v212, v208, s76, v212
    v_dot2_f32_bf16 v213, v208, s77, v213
    v_dot2_f32_bf16 v214, v209, s76, v214
    v_dot2_f32_bf16 v215, v209, s77, v215
    v_dot2_f32_bf16 v216, v210, s76, v216
    v_dot2_f32_bf16 v217, v210, s77, v217
    v_dot2_f32_bf16 v218, v211, s76, v218
    v_dot2_f32_bf16 v219, v211, s77, v219
    v_dot2_f32_bf16 v212, v176, s76, v212
    v_dot2_f32_bf16 v213, v176, s77, v213
    v_dot2_f32_bf16 v214, v177, s76, v214
    v_dot2_f32_bf16 v215, v177, s77, v215
    v_dot2_f32_bf16 v216, v178, s76, v216
    v_dot2_f32_bf16 v217, v178, s77, v217
    v_dot2_f32_bf16 v218, v179, s76, v218
    v_dot2_f32_bf16 v219, v179, s77, v219
    v_dot2_f32_bf16 v212, v180, s76, v212
    v_dot2_f32_bf16 v213, v180, s77, v213
    v_dot2_f32_bf16 v214, v181, s76, v214
    v_dot2_f32_bf16 v215, v181, s77, v215
    v_dot2_f32_bf16 v216, v182, s76, v216
    v_dot2_f32_bf16 v217, v182, s77, v217
    v_dot2_f32_bf16 v218, v183, s76, v218
    v_dot2_f32_bf16 v219, v183, s77, v219
    v_dot2_f32_bf16 v212, v184, s76, v212
    v_dot2_f32_bf16 v213, v184, s77, v213
    v_dot2_f32_bf16 v214, v185, s76, v214
    v_dot2_f32_bf16 v215, v185, s77, v215
    v_dot2_f32_bf16 v216, v186, s76, v216
    v_dot2_f32_bf16 v217, v186, s77, v217
    v_dot2_f32_bf16 v218, v187, s76, v218
    v_dot2_f32_bf16 v219, v187, s77, v219
    v_dot2_f32_bf16 v212, v188, s76, v212
    v_dot2_f32_bf16 v213, v188, s77, v213
    v_dot2_f32_bf16 v214, v189, s76, v214
    v_dot2_f32_bf16 v215, v189, s77, v215
    v_dot2_f32_bf16 v216, v190, s76, v216
    v_dot2_f32_bf16 v217, v190, s77, v217
    v_dot2_f32_bf16 v218, v191, s76, v218
    v_dot2_f32_bf16 v219, v191, s77, v219
    v_dot2_f32_bf16 v212, v192, s76, v212
    v_dot2_f32_bf16 v213, v192, s77, v213
    v_dot2_f32_bf16 v214, v193, s76, v214
    v_dot2_f32_bf16 v215, v193, s77, v215
    v_dot2_f32_bf16 v216, v194, s76, v216
    v_dot2_f32_bf16 v217, v194, s77, v217
    v_dot2_f32_bf16 v218, v195, s76, v218
    v_dot2_f32_bf16 v219, v195, s77, v219
    v_dot2_f32_bf16 v212, v196, s76, v212
    v_dot2_f32_bf16 v213, v196, s77, v213
    v_dot2_f32_bf16 v214, v197, s76, v214
    v_dot2_f32_bf16 v215, v197, s77, v215
    v_dot2_f32_bf16 v216, v198, s76, v216
    v_dot2_f32_bf16 v217, v198, s77, v217
    v_dot2_f32_bf16 v218, v199, s76, v218
    v_dot2_f32_bf16 v219, v199, s77, v219
    v_dot2_f32_bf16 v212, v200, s76, v212
    v_dot2_f32_bf16 v213, v200, s77, v213
    v_dot2_f32_bf16 v214, v201, s76, v214
    v_dot2_f32_bf16 v215, v201, s77, v215
    v_dot2_f32_bf16 v216, v202, s76, v216
    v_dot2_f32_bf16 v217, v202, s77, v217
    v_dot2_f32_bf16 v218, v203, s76, v218
    v_dot2_f32_bf16 v219, v203, s77, v219
    v_dot2_f32_bf16 v212, v204, s76, v212
    v_dot2_f32_bf16 v213, v204, s77, v213
    v_dot2_f32_bf16 v214, v205, s76, v214
    v_dot2_f32_bf16 v215, v205, s77, v215
    v_dot2_f32_bf16 v216, v206, s76, v216
    v_dot2_f32_bf16 v217, v206, s77, v217
    v_dot2_f32_bf16 v218, v207, s76, v218
    v_dot2_f32_bf16 v219, v207, s77, v219
    s_nop 2
    v_cvt_pk_bf16_f32 v208, v212, v213
    v_cvt_pk_bf16_f32 v209, v214, v215
    v_cvt_pk_bf16_f32 v210, v216, v217
    v_cvt_pk_bf16_f32 v211, v218, v219
    s_nop 1
    v_permlane32_swap_b32 v208, v210
    v_permlane32_swap_b32 v209, v211
    buffer_store_dwordx4 v[208:211], v220, s[60:63], 0 offen
L_end:
    s_endpgm

.section .rodata,"a"
.p2align 6
.amdhsa_kernel parallel_sum__spectral_fnet__geglu_ffn__prompt_kernel
  .amdhsa_next_free_vgpr 512
  .amdhsa_next_free_sgpr 102
  .amdhsa_accum_offset 256
  .amdhsa_group_segment_fixed_size 0
  .amdhsa_kernarg_size 96
  .amdhsa_user_sgpr_count 2
  .amdhsa_user_sgpr_kernarg_segment_ptr 1
  .amdhsa_system_sgpr_workgroup_id_x 1
.end_amdhsa_kernel
.text
```
